```python
import torch

def _softmax(x, axis=-1):
    return torch.softmax(x, dim=axis)

def _gelu(x):
    return torch.nn.functional.gelu(x, approximate='tanh')

def _silu(x):
    return torch.nn.functional.silu(x)

def _sigmoid(x):
    return torch.sigmoid(x)

def _layernorm(x, axis=-1, eps=1e-05):
    m = x.mean(dim=axis, keepdim=True)
    v = x.var(dim=axis, keepdim=True, unbiased=False)
    return (x - m) / torch.sqrt(v + eps)

def _scatter_add(tgt, idx, src, axis=0):
    return tgt.clone().index_add_(axis, idx, src)

def _segment_sum(src, seg, n):
    out = torch.zeros((n,) + src.shape[1:], dtype=src.dtype)
    return out.index_add_(0, seg, src)

def _pad(x, pw):
    flat = tuple((v for pair in reversed(pw) for v in pair))
    return torch.nn.functional.pad(x, flat)
kernel_name = 'adaLN_cond__sliding_block__glu_gated_glu__prompt'

def setup_inputs():

    _w = lambda a: (lambda t: t.to(torch.bfloat16) if t.is_floating_point() else t)(torch.as_tensor(a))

    def _A_setup():
        B, S, D = (1, 2048, 640)
        return {'x': _w((lambda *s: torch.randn(*s, dtype=torch.bfloat16) * 0.05)(B, S, D)), 'wqkv': _w((lambda *s: torch.randn(*s, dtype=torch.bfloat16) * 0.05)(D, 3 * D)), 'wo': _w((lambda *s: torch.randn(*s, dtype=torch.bfloat16) * 0.05)(D, D))}
    _A_in = _A_setup()

    def _B_setup():
        B, S, D, F = (1, 2048, 640, 1536)
        return {'x': _w((lambda *s: torch.randn(*s, dtype=torch.bfloat16) * 0.05)(B, S, D)), 'w_gate': _w((lambda *s: torch.randn(*s, dtype=torch.bfloat16) * 0.05)(D, F)), 'w_up': _w((lambda *s: torch.randn(*s, dtype=torch.bfloat16) * 0.05)(D, F)), 'w_down': _w((lambda *s: torch.randn(*s, dtype=torch.bfloat16) * 0.05)(F, D))}
    _B_in = _B_setup()
    return {'A_x': _A_in['x'], 'A_wqkv': _A_in['wqkv'], 'A_wo': _A_in['wo'], 'B_x': _B_in['x'], 'B_w_gate': _B_in['w_gate'], 'B_w_up': _B_in['w_up'], 'B_w_down': _B_in['w_down'], 'c': _w((lambda *s: torch.randn(*s, dtype=torch.bfloat16) * 0.1)(1, 640) * 8.0), 'w_mod': _w((lambda *s: torch.randn(*s, dtype=torch.bfloat16) * 0.1)(640, 6 * 640) * 640 ** (-0.5) * 8.0)}

def reference(A_x, A_wqkv, A_wo, B_x, B_w_gate, B_w_up, B_w_down, c, w_mod):

    def _A_ref(x, wqkv, wo):
        B, S, D = x.shape
        H = 32
        Dh = D // H
        W = 256
        qkv = (lambda x, *d: x.permute(*d))((x @ wqkv).reshape(B, S, 3, H, Dh), 2, 0, 3, 1, 4)
        q, k, v = (qkv[0], qkv[1], qkv[2])
        scores = torch.einsum('bhqd,bhkd->bhqk', q, k) * Dh ** (-0.5)
        idx = torch.arange(S)
        mask = (idx[:, None] - idx[None, :] >= 0) & (idx[:, None] - idx[None, :] < W)
        scores = torch.where(mask[None, None], scores, -1000000000.0)
        p = _softmax(scores, axis=-1)
        o = torch.einsum('bhqk,bhkd->bhqd', p, v)
        return (lambda x, *d: x.permute(*d))(o, 0, 2, 1, 3).reshape(B, S, D) @ wo

    def _B_ref(x, w_gate, w_up, w_down):
        g = torch.einsum('bsd,df->bsf', x, w_gate)
        u = torch.einsum('bsd,df->bsf', x, w_up)
        h = _sigmoid(g) * u
        return torch.einsum('bsf,fd->bsd', h, w_down)
    x = A_x
    mod = (_silu(c) @ w_mod).reshape(c.shape[0], 6, 1, -1)
    sa, ca, ga, sb, cb, gb = (mod[:, 0].clone(), mod[:, 1].clone(), mod[:, 2].clone(), mod[:, 3].clone(), mod[:, 4].clone(), mod[:, 5].clone())
    h = _layernorm(x, axis=-1) * (1 + ca) + sa
    x = x + ga * _A_ref(h, A_wqkv, A_wo)
    h = _layernorm(x, axis=-1) * (1 + cb) + sb
    x = x + gb * _B_ref(h, B_w_gate, B_w_up, B_w_down)
    return x
```

```asm
; @launch grid=(256,1,1) block=(256,1,1) lds=163840
.amdgcn_target "amdgcn-amd-amdhsa--gfx950"
.text
.globl adaLN_cond__sliding_block__glu_gated_glu__prompt_kernel
.p2align 8
.type adaLN_cond__sliding_block__glu_gated_glu__prompt_kernel,@function
adaLN_cond__sliding_block__glu_gated_glu__prompt_kernel:
    s_cmp_ge_u32 s2, 256
    s_cbranch_scc1 L_end
    s_load_dwordx16 s[4:19], s[0:1], 0
    s_load_dwordx8 s[20:27], s[0:1], 64
    s_getpc_b64 s[58:59]
L_c00:
    s_lshr_b32 s100, s2, 3
    s_and_b32 s100, s100, 7
    v_lshl_add_u32 v204, v0, 3, s100
    v_lshlrev_b32 v204, 7, v204
    v_cmp_gt_u32 vcc, 20, v0
    s_nop 0
    s_and_saveexec_b64 s[60:61], vcc
    s_cbranch_execz L_c01
    global_load_dword v205, v204, s[58:59]
L_c01:
    s_mov_b64 exec, -1
    s_and_b32 s44, s2, 7
    s_lshl_b32 s44, s44, 1
    s_lshr_b32 s60, s2, 7
    s_add_u32 s44, s44, s60
    s_lshr_b32 s45, s2, 3
    s_and_b32 s45, s45, 15
    v_lshrrev_b32 v2, 6, v0
    v_and_b32 v1, 63, v0
    v_readfirstlane_b32 s46, v2
    s_and_b32 s50, s45, 1
    s_lshr_b32 s51, s45, 1
    s_mov_b32 s56, 0
    s_mov_b32 s57, -1
    s_and_b32 s52, s46, 1
    s_lshr_b32 s53, s46, 1
    v_lshlrev_b32 v2, 4, v1
    s_waitcnt lgkmcnt(0)
    s_load_dword s48, s[26:27], 0
    s_mov_b32 s28, s26
    s_mov_b32 s29, s27
    s_mov_b32 s30, 0x10000000
    s_mov_b32 s31, 0x20000
L_c0:
    s_mov_b32 s62, 0x3f2ff1f0
    s_mov_b32 s63, 0x7f6ff5f4
    s_lshl_b32 s60, s45, 2
    s_lshr_b64 s[62:63], s[62:63], s60
    s_and_b32 s62, s62, 15
    s_lshl_b32 s62, s62, 3
    s_and_b32 s63, s2, 7
    s_add_u32 s62, s62, s63
    s_lshr_b32 s63, s2, 7
    s_lshl_b32 s63, s63, 6
    s_add_u32 s49, s62, s63
    s_sub_u32 s63, s49, 0
    s_cmp_ge_u32 s63, 40
    s_cbranch_scc1 L_nogemv0
    s_and_b32 s101, s49, 1
    s_lshr_b32 s49, s49, 1
    s_mov_b32 s32, s18
    s_mov_b32 s33, s19
    s_mov_b32 s34, 0x500
    s_mov_b32 s35, 0x20000
    s_mov_b32 s36, s20
    s_mov_b32 s37, s21
    s_mov_b32 s38, 0x4b0000
    s_mov_b32 s39, 0x20000
    v_lshlrev_b32 v83, 3, v0
    buffer_load_dwordx2 v[84:85], v83, s[32:35], 0 offen
    v_lshrrev_b32 v87, 3, v0
    v_mul_u32_u24 v88, 76800, v87
    v_and_b32 v89, 7, v0
    v_lshl_add_u32 v88, v89, 4, v88
    s_lshl_b32 s64, s49, 7
    s_mul_i32 s66, s101, 2457600
    s_add_u32 s64, s64, s66
    buffer_load_dwordx4 v[40:43], v88, s[36:39], s64 offen nt
    s_add_u32 s64, s64, 7680
    buffer_load_dwordx4 v[44:47], v88, s[36:39], s64 offen nt
    s_add_u32 s64, s64, 7680
    buffer_load_dwordx4 v[48:51], v88, s[36:39], s64 offen nt
    s_add_u32 s64, s64, 7680
    buffer_load_dwordx4 v[52:55], v88, s[36:39], s64 offen nt
    s_add_u32 s64, s64, 7680
    buffer_load_dwordx4 v[56:59], v88, s[36:39], s64 offen nt
    s_add_u32 s64, s64, 7680
    buffer_load_dwordx4 v[60:63], v88, s[36:39], s64 offen nt
    s_add_u32 s64, s64, 7680
    buffer_load_dwordx4 v[64:67], v88, s[36:39], s64 offen nt
    s_add_u32 s64, s64, 7680
    buffer_load_dwordx4 v[68:71], v88, s[36:39], s64 offen nt
    s_add_u32 s64, s64, 7680
    buffer_load_dwordx4 v[72:75], v88, s[36:39], s64 offen nt
    s_add_u32 s64, s64, 7680
    buffer_load_dwordx4 v[76:79], v88, s[36:39], s64 offen nt
    s_cmp_lg_u32 s46, 0
    s_cbranch_scc1 Lx1
    s_mov_b32 s96, s4
    s_mov_b32 s97, s5
    s_mov_b32 s98, 0x280000
    s_mov_b32 s99, 0x20000
    v_and_b32 v240, 7, v1
    v_lshrrev_b32 v241, 3, v1
    v_mul_u32_u24 v242, 1280, v240
    v_lshl_add_u32 v242, v241, 4, v242
    s_lshl_b32 s68, s44, 4
    s_add_u32 s68, s68, s45
    s_mul_i32 s68, s68, 10240
    buffer_load_dwordx4 v[160:163], v242, s[96:99], s68 offen offset:0 nt
    buffer_load_dwordx4 v[164:167], v242, s[96:99], s68 offen offset:128 nt
    buffer_load_dwordx4 v[168:171], v242, s[96:99], s68 offen offset:256 nt
    buffer_load_dwordx4 v[172:175], v242, s[96:99], s68 offen offset:384 nt
    buffer_load_dwordx4 v[176:179], v242, s[96:99], s68 offen offset:512 nt
    buffer_load_dwordx4 v[180:183], v242, s[96:99], s68 offen offset:640 nt
    buffer_load_dwordx4 v[184:187], v242, s[96:99], s68 offen offset:768 nt
    buffer_load_dwordx4 v[188:191], v242, s[96:99], s68 offen offset:896 nt
    buffer_load_dwordx4 v[192:195], v242, s[96:99], s68 offen offset:1024 nt
    buffer_load_dwordx4 v[196:199], v242, s[96:99], s68 offen offset:1152 nt
Lx1:
    v_lshrrev_b32 v32, 2, v1
    v_and_b32 v33, 3, v1
    v_mul_u32_u24 v20, 160, v32
    v_lshl_add_u32 v20, v33, 3, v20
    v_mov_b32 v5, v20
    v_add_u32 v6, 51200, v20
    v_and_b32 v34, 7, v32
    v_lshlrev_b32 v34, 1, v34
    v_lshrrev_b32 v35, 5, v1
    v_add_u32 v34, v34, v35
    v_mul_u32_u24 v34, 80, v34
    v_lshl_add_u32 v34, v33, 3, v34
    v_add_u32 v7, 102400, v34
    v_lshrrev_b32 v34, 4, v1
    v_and_b32 v36, 15, v1
    s_lshl_b32 s60, s46, 5
    v_add_u32 v37, s60, v36
    v_mul_u32_u24 v37, 48, v37
    v_add_u32 v37, 0, v37
    v_add_u32 v38, 0, v34
    v_mul_u32_u24 v3, 13108, v38
    v_lshrrev_b32 v3, 16, v3
    v_mul_u32_u24 v4, 5, v3
    v_sub_u32 v4, v38, v4
    v_mul_u32_u24 v39, 6144, v3
    v_lshl_add_u32 v39, v4, 3, v39
    v_add_u32 v10, v39, v37
    v_add_u32 v15, 73728, v10
    v_add_u32 v38, 4, v34
    v_mul_u32_u24 v3, 13108, v38
    v_lshrrev_b32 v3, 16, v3
    v_mul_u32_u24 v4, 5, v3
    v_sub_u32 v4, v38, v4
    v_mul_u32_u24 v39, 6144, v3
    v_lshl_add_u32 v39, v4, 3, v39
    v_add_u32 v11, v39, v37
    v_add_u32 v16, 73728, v11
    v_add_u32 v38, 8, v34
    v_mul_u32_u24 v3, 13108, v38
    v_lshrrev_b32 v3, 16, v3
    v_mul_u32_u24 v4, 5, v3
    v_sub_u32 v4, v38, v4
    v_mul_u32_u24 v39, 6144, v3
    v_lshl_add_u32 v39, v4, 3, v39
    v_add_u32 v12, v39, v37
    v_cmp_lt_u32 s[58:59], 1, v3
    v_add_u32 v39, 40, v37
    s_nop 0
    v_cndmask_b32 v17, v12, v39, s[58:59]
    v_add_u32 v17, 73728, v17
    v_add_u32 v38, 12, v34
    v_mul_u32_u24 v3, 13108, v38
    v_lshrrev_b32 v3, 16, v3
    v_mul_u32_u24 v4, 5, v3
    v_sub_u32 v4, v38, v4
    v_mul_u32_u24 v39, 6144, v3
    v_lshl_add_u32 v39, v4, 3, v39
    v_add_u32 v13, v39, v37
    v_add_u32 v38, 16, v34
    v_mul_u32_u24 v3, 13108, v38
    v_lshrrev_b32 v3, 16, v3
    v_mul_u32_u24 v4, 5, v3
    v_sub_u32 v4, v38, v4
    v_mul_u32_u24 v39, 6144, v3
    v_lshl_add_u32 v39, v4, 3, v39
    v_add_u32 v14, v39, v37
    v_and_b32 v37, 31, v1
    v_add_u32 v38, s60, v37
    v_mul_u32_u24 v38, 48, v38
    v_lshl_add_u32 v21, v35, 4, v38
    v_lshl_add_u32 v22, v35, 3, v38
    v_add_u32 v22, 32, v22
    v_bfe_u32 v38, v1, 2, 2
    v_lshl_add_u32 v38, v35, 2, v38
    v_add_u32 v38, s60, v38
    v_mul_u32_u24 v38, 48, v38
    v_bfe_u32 v39, v1, 4, 1
    v_lshl_add_u32 v38, v39, 5, v38
    v_lshl_add_u32 v38, v33, 3, v38
    v_add_u32 v23, 36864, v38
    v_mul_u32_u24 v24, 20480, v39
    v_lshl_add_u32 v24, v36, 4, v24
    v_lshl_add_u32 v24, v35, 8, v24
    v_mul_u32_u24 v25, 1280, v36
    v_lshl_add_u32 v25, v34, 3, v25
    v_min_u32 v26, 19, v1
    v_lshlrev_b32 v26, 4, v26
    v_lshlrev_b32 v38, 2, v35
    v_sub_u32 v38, v37, v38
    v_mov_b32 v39, 0xf149f2ca
    v_cmp_le_i32 s[62:63], 0, v38
    v_cmp_le_i32 s[64:65], 1, v38
    v_cmp_le_i32 s[66:67], 2, v38
    v_cmp_le_i32 s[68:69], 3, v38
    v_cndmask_b32 v208, v39, 0, s[62:63]
    v_cndmask_b32 v224, 0, v39, s[62:63]
    v_cndmask_b32 v209, v39, 0, s[64:65]
    v_cndmask_b32 v225, 0, v39, s[64:65]
    v_cndmask_b32 v210, v39, 0, s[66:67]
    v_cndmask_b32 v226, 0, v39, s[66:67]
    v_cndmask_b32 v211, v39, 0, s[68:69]
    v_cndmask_b32 v227, 0, v39, s[68:69]
    v_cmp_le_i32 s[62:63], 8, v38
    v_cmp_le_i32 s[64:65], 9, v38
    v_cmp_le_i32 s[66:67], 10, v38
    v_cmp_le_i32 s[68:69], 11, v38
    v_cndmask_b32 v212, v39, 0, s[62:63]
    v_cndmask_b32 v228, 0, v39, s[62:63]
    v_cndmask_b32 v213, v39, 0, s[64:65]
    v_cndmask_b32 v229, 0, v39, s[64:65]
    v_cndmask_b32 v214, v39, 0, s[66:67]
    v_cndmask_b32 v230, 0, v39, s[66:67]
    v_cndmask_b32 v215, v39, 0, s[68:69]
    v_cndmask_b32 v231, 0, v39, s[68:69]
    v_cmp_le_i32 s[62:63], 16, v38
    v_cmp_le_i32 s[64:65], 17, v38
    v_cmp_le_i32 s[66:67], 18, v38
    v_cmp_le_i32 s[68:69], 19, v38
    v_cndmask_b32 v216, v39, 0, s[62:63]
    v_cndmask_b32 v232, 0, v39, s[62:63]
    v_cndmask_b32 v217, v39, 0, s[64:65]
    v_cndmask_b32 v233, 0, v39, s[64:65]
    v_cndmask_b32 v218, v39, 0, s[66:67]
    v_cndmask_b32 v234, 0, v39, s[66:67]
    v_cndmask_b32 v219, v39, 0, s[68:69]
    v_cndmask_b32 v235, 0, v39, s[68:69]
    v_cmp_le_i32 s[62:63], 24, v38
    v_cmp_le_i32 s[64:65], 25, v38
    v_cmp_le_i32 s[66:67], 26, v38
    v_cmp_le_i32 s[68:69], 27, v38
    v_cndmask_b32 v220, v39, 0, s[62:63]
    v_cndmask_b32 v236, 0, v39, s[62:63]
    v_cndmask_b32 v221, v39, 0, s[64:65]
    v_cndmask_b32 v237, 0, v39, s[64:65]
    v_cndmask_b32 v222, v39, 0, s[66:67]
    v_cndmask_b32 v238, 0, v39, s[66:67]
    v_cndmask_b32 v223, v39, 0, s[68:69]
    v_cndmask_b32 v239, 0, v39, s[68:69]
    s_lshl_b32 s71, s44, 1
    s_add_u32 s71, s71, s50
    s_lshl_b32 s71, s71, 2
    s_add_u32 s71, s71, s46
    s_mul_i32 s71, s71, 20480
    s_mul_i32 s61, s51, 160
    s_add_u32 s71, s71, s61
    s_waitcnt vmcnt(10)
    v_lshlrev_b32 v90, 16, v84
    v_and_b32 v91, 0xffff0000, v84
    v_lshlrev_b32 v92, 16, v85
    v_and_b32 v93, 0xffff0000, v85
    v_mul_f32 v94, 0xbfb8aa3b, v90
    v_mul_f32 v95, 0xbfb8aa3b, v91
    v_mul_f32 v96, 0xbfb8aa3b, v92
    v_mul_f32 v97, 0xbfb8aa3b, v93
    v_exp_f32 v94, v94
    v_exp_f32 v95, v95
    v_exp_f32 v96, v96
    v_exp_f32 v97, v97
    v_add_f32 v94, 1.0, v94
    v_add_f32 v95, 1.0, v95
    v_add_f32 v96, 1.0, v96
    v_add_f32 v97, 1.0, v97
    v_rcp_f32 v94, v94
    v_rcp_f32 v95, v95
    v_rcp_f32 v96, v96
    v_rcp_f32 v97, v97
    v_mul_f32 v90, v90, v94
    v_mul_f32 v91, v91, v95
    v_mul_f32 v92, v92, v96
    v_mul_f32 v93, v93, v97
    v_cvt_pk_bf16_f32 v94, v90, v91
    v_cvt_pk_bf16_f32 v95, v92, v93
    v_lshlrev_b32 v96, 16, v94
    v_and_b32 v97, 0xffff0000, v94
    v_lshlrev_b32 v98, 16, v95
    v_and_b32 v99, 0xffff0000, v95
    v_lshlrev_b32 v83, 4, v0
    v_add_u32 v83, 158720, v83
    ds_write_b128 v83, v[96:99]
    v_mul_u32_u24 v83, 40, v87
    s_mul_i32 s66, s101, 1280
    s_add_u32 s66, s66, 158720
    v_add_u32 v83, s66, v83
    s_waitcnt lgkmcnt(0)
    s_barrier
    ds_read_b64 v[100:101], v83 offset:0
    ds_read_b64 v[102:103], v83 offset:8
    ds_read_b64 v[104:105], v83 offset:16
    ds_read_b64 v[106:107], v83 offset:24
    ds_read_b64 v[108:109], v83 offset:32
    v_mov_b32 v90, 0
    v_mov_b32 v91, 0
    v_mov_b32 v92, 0
    v_mov_b32 v93, 0
    v_mov_b32 v94, 0
    v_mov_b32 v95, 0
    v_mov_b32 v96, 0
    v_mov_b32 v97, 0
    s_waitcnt vmcnt(9)
    v_lshlrev_b32 v120, 16, v40
    v_and_b32 v121, 0xffff0000, v40
    s_waitcnt lgkmcnt(4)
    v_pk_fma_f32 v[90:91], v[120:121], v[100:101], v[90:91] op_sel:[0,0,0] op_sel_hi:[1,0,1]
    v_lshlrev_b32 v122, 16, v41
    v_and_b32 v123, 0xffff0000, v41
    v_pk_fma_f32 v[92:93], v[122:123], v[100:101], v[92:93] op_sel:[0,0,0] op_sel_hi:[1,0,1]
    v_lshlrev_b32 v120, 16, v42
    v_and_b32 v121, 0xffff0000, v42
    v_pk_fma_f32 v[94:95], v[120:121], v[100:101], v[94:95] op_sel:[0,0,0] op_sel_hi:[1,0,1]
    v_lshlrev_b32 v122, 16, v43
    v_and_b32 v123, 0xffff0000, v43
    v_pk_fma_f32 v[96:97], v[122:123], v[100:101], v[96:97] op_sel:[0,0,0] op_sel_hi:[1,0,1]
    s_waitcnt vmcnt(8)
    v_lshlrev_b32 v120, 16, v44
    v_and_b32 v121, 0xffff0000, v44
    v_pk_fma_f32 v[90:91], v[120:121], v[100:101], v[90:91] op_sel:[0,1,0] op_sel_hi:[1,1,1]
    v_lshlrev_b32 v122, 16, v45
    v_and_b32 v123, 0xffff0000, v45
    v_pk_fma_f32 v[92:93], v[122:123], v[100:101], v[92:93] op_sel:[0,1,0] op_sel_hi:[1,1,1]
    v_lshlrev_b32 v120, 16, v46
    v_and_b32 v121, 0xffff0000, v46
    v_pk_fma_f32 v[94:95], v[120:121], v[100:101], v[94:95] op_sel:[0,1,0] op_sel_hi:[1,1,1]
    v_lshlrev_b32 v122, 16, v47
    v_and_b32 v123, 0xffff0000, v47
    v_pk_fma_f32 v[96:97], v[122:123], v[100:101], v[96:97] op_sel:[0,1,0] op_sel_hi:[1,1,1]
    s_waitcnt vmcnt(7)
    v_lshlrev_b32 v120, 16, v48
    v_and_b32 v121, 0xffff0000, v48
    s_waitcnt lgkmcnt(3)
    v_pk_fma_f32 v[90:91], v[120:121], v[102:103], v[90:91] op_sel:[0,0,0] op_sel_hi:[1,0,1]
    v_lshlrev_b32 v122, 16, v49
    v_and_b32 v123, 0xffff0000, v49
    v_pk_fma_f32 v[92:93], v[122:123], v[102:103], v[92:93] op_sel:[0,0,0] op_sel_hi:[1,0,1]
    v_lshlrev_b32 v120, 16, v50
    v_and_b32 v121, 0xffff0000, v50
    v_pk_fma_f32 v[94:95], v[120:121], v[102:103], v[94:95] op_sel:[0,0,0] op_sel_hi:[1,0,1]
    v_lshlrev_b32 v122, 16, v51
    v_and_b32 v123, 0xffff0000, v51
    v_pk_fma_f32 v[96:97], v[122:123], v[102:103], v[96:97] op_sel:[0,0,0] op_sel_hi:[1,0,1]
    s_waitcnt vmcnt(6)
    v_lshlrev_b32 v120, 16, v52
    v_and_b32 v121, 0xffff0000, v52
    v_pk_fma_f32 v[90:91], v[120:121], v[102:103], v[90:91] op_sel:[0,1,0] op_sel_hi:[1,1,1]
    v_lshlrev_b32 v122, 16, v53
    v_and_b32 v123, 0xffff0000, v53
    v_pk_fma_f32 v[92:93], v[122:123], v[102:103], v[92:93] op_sel:[0,1,0] op_sel_hi:[1,1,1]
    v_lshlrev_b32 v120, 16, v54
    v_and_b32 v121, 0xffff0000, v54
    v_pk_fma_f32 v[94:95], v[120:121], v[102:103], v[94:95] op_sel:[0,1,0] op_sel_hi:[1,1,1]
    v_lshlrev_b32 v122, 16, v55
    v_and_b32 v123, 0xffff0000, v55
    v_pk_fma_f32 v[96:97], v[122:123], v[102:103], v[96:97] op_sel:[0,1,0] op_sel_hi:[1,1,1]
    s_waitcnt vmcnt(5)
    v_lshlrev_b32 v120, 16, v56
    v_and_b32 v121, 0xffff0000, v56
    s_waitcnt lgkmcnt(2)
    v_pk_fma_f32 v[90:91], v[120:121], v[104:105], v[90:91] op_sel:[0,0,0] op_sel_hi:[1,0,1]
    v_lshlrev_b32 v122, 16, v57
    v_and_b32 v123, 0xffff0000, v57
    v_pk_fma_f32 v[92:93], v[122:123], v[104:105], v[92:93] op_sel:[0,0,0] op_sel_hi:[1,0,1]
    v_lshlrev_b32 v120, 16, v58
    v_and_b32 v121, 0xffff0000, v58
    v_pk_fma_f32 v[94:95], v[120:121], v[104:105], v[94:95] op_sel:[0,0,0] op_sel_hi:[1,0,1]
    v_lshlrev_b32 v122, 16, v59
    v_and_b32 v123, 0xffff0000, v59
    v_pk_fma_f32 v[96:97], v[122:123], v[104:105], v[96:97] op_sel:[0,0,0] op_sel_hi:[1,0,1]
    s_waitcnt vmcnt(4)
    v_lshlrev_b32 v120, 16, v60
    v_and_b32 v121, 0xffff0000, v60
    v_pk_fma_f32 v[90:91], v[120:121], v[104:105], v[90:91] op_sel:[0,1,0] op_sel_hi:[1,1,1]
    v_lshlrev_b32 v122, 16, v61
    v_and_b32 v123, 0xffff0000, v61
    v_pk_fma_f32 v[92:93], v[122:123], v[104:105], v[92:93] op_sel:[0,1,0] op_sel_hi:[1,1,1]
    v_lshlrev_b32 v120, 16, v62
    v_and_b32 v121, 0xffff0000, v62
    v_pk_fma_f32 v[94:95], v[120:121], v[104:105], v[94:95] op_sel:[0,1,0] op_sel_hi:[1,1,1]
    v_lshlrev_b32 v122, 16, v63
    v_and_b32 v123, 0xffff0000, v63
    v_pk_fma_f32 v[96:97], v[122:123], v[104:105], v[96:97] op_sel:[0,1,0] op_sel_hi:[1,1,1]
    s_waitcnt vmcnt(3)
    v_lshlrev_b32 v120, 16, v64
    v_and_b32 v121, 0xffff0000, v64
    s_waitcnt lgkmcnt(1)
    v_pk_fma_f32 v[90:91], v[120:121], v[106:107], v[90:91] op_sel:[0,0,0] op_sel_hi:[1,0,1]
    v_lshlrev_b32 v122, 16, v65
    v_and_b32 v123, 0xffff0000, v65
    v_pk_fma_f32 v[92:93], v[122:123], v[106:107], v[92:93] op_sel:[0,0,0] op_sel_hi:[1,0,1]
    v_lshlrev_b32 v120, 16, v66
    v_and_b32 v121, 0xffff0000, v66
    v_pk_fma_f32 v[94:95], v[120:121], v[106:107], v[94:95] op_sel:[0,0,0] op_sel_hi:[1,0,1]
    v_lshlrev_b32 v122, 16, v67
    v_and_b32 v123, 0xffff0000, v67
    v_pk_fma_f32 v[96:97], v[122:123], v[106:107], v[96:97] op_sel:[0,0,0] op_sel_hi:[1,0,1]
    s_waitcnt vmcnt(2)
    v_lshlrev_b32 v120, 16, v68
    v_and_b32 v121, 0xffff0000, v68
    v_pk_fma_f32 v[90:91], v[120:121], v[106:107], v[90:91] op_sel:[0,1,0] op_sel_hi:[1,1,1]
    v_lshlrev_b32 v122, 16, v69
    v_and_b32 v123, 0xffff0000, v69
    v_pk_fma_f32 v[92:93], v[122:123], v[106:107], v[92:93] op_sel:[0,1,0] op_sel_hi:[1,1,1]
    v_lshlrev_b32 v120, 16, v70
    v_and_b32 v121, 0xffff0000, v70
    v_pk_fma_f32 v[94:95], v[120:121], v[106:107], v[94:95] op_sel:[0,1,0] op_sel_hi:[1,1,1]
    v_lshlrev_b32 v122, 16, v71
    v_and_b32 v123, 0xffff0000, v71
    v_pk_fma_f32 v[96:97], v[122:123], v[106:107], v[96:97] op_sel:[0,1,0] op_sel_hi:[1,1,1]
    s_waitcnt vmcnt(1)
    v_lshlrev_b32 v120, 16, v72
    v_and_b32 v121, 0xffff0000, v72
    s_waitcnt lgkmcnt(0)
    v_pk_fma_f32 v[90:91], v[120:121], v[108:109], v[90:91] op_sel:[0,0,0] op_sel_hi:[1,0,1]
    v_lshlrev_b32 v122, 16, v73
    v_and_b32 v123, 0xffff0000, v73
    v_pk_fma_f32 v[92:93], v[122:123], v[108:109], v[92:93] op_sel:[0,0,0] op_sel_hi:[1,0,1]
    v_lshlrev_b32 v120, 16, v74
    v_and_b32 v121, 0xffff0000, v74
    v_pk_fma_f32 v[94:95], v[120:121], v[108:109], v[94:95] op_sel:[0,0,0] op_sel_hi:[1,0,1]
    v_lshlrev_b32 v122, 16, v75
    v_and_b32 v123, 0xffff0000, v75
    v_pk_fma_f32 v[96:97], v[122:123], v[108:109], v[96:97] op_sel:[0,0,0] op_sel_hi:[1,0,1]
    s_waitcnt vmcnt(0)
    v_lshlrev_b32 v120, 16, v76
    v_and_b32 v121, 0xffff0000, v76
    v_pk_fma_f32 v[90:91], v[120:121], v[108:109], v[90:91] op_sel:[0,1,0] op_sel_hi:[1,1,1]
    v_lshlrev_b32 v122, 16, v77
    v_and_b32 v123, 0xffff0000, v77
    v_pk_fma_f32 v[92:93], v[122:123], v[108:109], v[92:93] op_sel:[0,1,0] op_sel_hi:[1,1,1]
    v_lshlrev_b32 v120, 16, v78
    v_and_b32 v121, 0xffff0000, v78
    v_pk_fma_f32 v[94:95], v[120:121], v[108:109], v[94:95] op_sel:[0,1,0] op_sel_hi:[1,1,1]
    v_lshlrev_b32 v122, 16, v79
    v_and_b32 v123, 0xffff0000, v79
    v_pk_fma_f32 v[96:97], v[122:123], v[108:109], v[96:97] op_sel:[0,1,0] op_sel_hi:[1,1,1]
    v_add_f32_dpp v100, v90, v90 row_ror:8 row_mask:0xf bank_mask:0xf
    v_add_f32_dpp v101, v91, v91 row_ror:8 row_mask:0xf bank_mask:0xf
    v_add_f32_dpp v102, v92, v92 row_ror:8 row_mask:0xf bank_mask:0xf
    v_add_f32_dpp v103, v93, v93 row_ror:8 row_mask:0xf bank_mask:0xf
    v_add_f32_dpp v104, v94, v94 row_ror:8 row_mask:0xf bank_mask:0xf
    v_add_f32_dpp v105, v95, v95 row_ror:8 row_mask:0xf bank_mask:0xf
    v_add_f32_dpp v106, v96, v96 row_ror:8 row_mask:0xf bank_mask:0xf
    v_add_f32_dpp v107, v97, v97 row_ror:8 row_mask:0xf bank_mask:0xf
    v_permlane16_swap_b32 v100, v104
    v_permlane16_swap_b32 v101, v105
    v_permlane16_swap_b32 v102, v106
    v_permlane16_swap_b32 v103, v107
    v_add_f32 v100, v100, v104
    v_add_f32 v101, v101, v105
    v_add_f32 v102, v102, v106
    v_add_f32 v103, v103, v107
    s_nop 0
    v_permlane32_swap_b32 v100, v102
    v_permlane32_swap_b32 v101, v103
    v_bfe_u32 v83, v1, 4, 1
    v_lshlrev_b32 v83, 4, v83
    v_bfe_u32 v84, v1, 5, 1
    v_lshl_add_u32 v83, v84, 3, v83
    v_lshl_add_u32 v83, v89, 5, v83
    s_lshl_b32 s64, s46, 8
    s_add_u32 s64, s64, 162816
    v_add_u32 v83, s64, v83
    v_add_f32 v100, v100, v102
    v_add_f32 v101, v101, v103
    ds_write_b64 v83, v[100:101]
    v_and_b32 v83, 15, v1
    v_lshlrev_b32 v83, 4, v83
    v_add_u32 v84, 162816, v83
    s_mul_i32 s47, s48, 1664525
    s_add_u32 s47, s47, 1013904223
    s_bfe_u32 s40, s47, 524288
    s_bfe_u32 s41, s47, 524296
    s_bfe_u32 s42, s47, 524304
    s_bfe_u32 s43, s47, 524312
    s_waitcnt lgkmcnt(0)
    s_barrier
    s_cmp_lg_u32 s46, 3
    s_cbranch_scc1 L_nogemv
    ds_read_b128 v[100:103], v84 offset:0
    ds_read_b128 v[104:107], v84 offset:256
    ds_read_b128 v[108:111], v84 offset:512
    ds_read_b128 v[112:115], v84 offset:768
    s_lshl_b32 s64, s49, 8
    s_mul_i32 s65, s101, 15360
    s_add_u32 s64, s64, s65
    s_add_u32 s64, s64, 65536
    v_mov_b32 v85, 0xff
    s_waitcnt lgkmcnt(2)
    v_add_f32 v100, v100, v104
    s_waitcnt lgkmcnt(0)
    v_add_f32 v108, v108, v112
    v_add_f32 v101, v101, v105
    v_add_f32 v109, v109, v113
    v_add_f32 v102, v102, v106
    v_add_f32 v110, v110, v114
    v_add_f32 v103, v103, v107
    v_add_f32 v111, v111, v115
    v_add_f32 v100, v100, v108
    v_add_f32 v101, v101, v109
    v_add_f32 v102, v102, v110
    v_add_f32 v103, v103, v111
    v_bfi_b32 v100, v85, s40, v100
    v_bfi_b32 v101, v85, s41, v101
    v_bfi_b32 v102, v85, s42, v102
    v_bfi_b32 v103, v85, s43, v103
    s_mov_b64 exec, 0xffff
    buffer_store_dwordx4 v[100:103], v83, s[28:31], s64 offen sc1
    s_mov_b64 exec, -1
    s_nop 1
    s_branch L_nogemv
L_nogemv0:
    s_cmp_lg_u32 s46, 0
    s_cbranch_scc1 Lx2
    s_mov_b32 s96, s4
    s_mov_b32 s97, s5
    s_mov_b32 s98, 0x280000
    s_mov_b32 s99, 0x20000
    v_and_b32 v240, 7, v1
    v_lshrrev_b32 v241, 3, v1
    v_mul_u32_u24 v242, 1280, v240
    v_lshl_add_u32 v242, v241, 4, v242
    s_lshl_b32 s68, s44, 4
    s_add_u32 s68, s68, s45
    s_mul_i32 s68, s68, 10240
    buffer_load_dwordx4 v[160:163], v242, s[96:99], s68 offen offset:0 nt
    buffer_load_dwordx4 v[164:167], v242, s[96:99], s68 offen offset:128 nt
    buffer_load_dwordx4 v[168:171], v242, s[96:99], s68 offen offset:256 nt
    buffer_load_dwordx4 v[172:175], v242, s[96:99], s68 offen offset:384 nt
    buffer_load_dwordx4 v[176:179], v242, s[96:99], s68 offen offset:512 nt
    buffer_load_dwordx4 v[180:183], v242, s[96:99], s68 offen offset:640 nt
    buffer_load_dwordx4 v[184:187], v242, s[96:99], s68 offen offset:768 nt
    buffer_load_dwordx4 v[188:191], v242, s[96:99], s68 offen offset:896 nt
    buffer_load_dwordx4 v[192:195], v242, s[96:99], s68 offen offset:1024 nt
    buffer_load_dwordx4 v[196:199], v242, s[96:99], s68 offen offset:1152 nt
Lx2:
    v_lshrrev_b32 v32, 2, v1
    v_and_b32 v33, 3, v1
    v_mul_u32_u24 v20, 160, v32
    v_lshl_add_u32 v20, v33, 3, v20
    v_mov_b32 v5, v20
    v_add_u32 v6, 51200, v20
    v_and_b32 v34, 7, v32
    v_lshlrev_b32 v34, 1, v34
    v_lshrrev_b32 v35, 5, v1
    v_add_u32 v34, v34, v35
    v_mul_u32_u24 v34, 80, v34
    v_lshl_add_u32 v34, v33, 3, v34
    v_add_u32 v7, 102400, v34
    v_lshrrev_b32 v34, 4, v1
    v_and_b32 v36, 15, v1
    s_lshl_b32 s60, s46, 5
    v_add_u32 v37, s60, v36
    v_mul_u32_u24 v37, 48, v37
    v_add_u32 v37, 0, v37
    v_add_u32 v38, 0, v34
    v_mul_u32_u24 v3, 13108, v38
    v_lshrrev_b32 v3, 16, v3
    v_mul_u32_u24 v4, 5, v3
    v_sub_u32 v4, v38, v4
    v_mul_u32_u24 v39, 6144, v3
    v_lshl_add_u32 v39, v4, 3, v39
    v_add_u32 v10, v39, v37
    v_add_u32 v15, 73728, v10
    v_add_u32 v38, 4, v34
    v_mul_u32_u24 v3, 13108, v38
    v_lshrrev_b32 v3, 16, v3
    v_mul_u32_u24 v4, 5, v3
    v_sub_u32 v4, v38, v4
    v_mul_u32_u24 v39, 6144, v3
    v_lshl_add_u32 v39, v4, 3, v39
    v_add_u32 v11, v39, v37
    v_add_u32 v16, 73728, v11
    v_add_u32 v38, 8, v34
    v_mul_u32_u24 v3, 13108, v38
    v_lshrrev_b32 v3, 16, v3
    v_mul_u32_u24 v4, 5, v3
    v_sub_u32 v4, v38, v4
    v_mul_u32_u24 v39, 6144, v3
    v_lshl_add_u32 v39, v4, 3, v39
    v_add_u32 v12, v39, v37
    v_cmp_lt_u32 s[58:59], 1, v3
    v_add_u32 v39, 40, v37
    s_nop 0
    v_cndmask_b32 v17, v12, v39, s[58:59]
    v_add_u32 v17, 73728, v17
    v_add_u32 v38, 12, v34
    v_mul_u32_u24 v3, 13108, v38
    v_lshrrev_b32 v3, 16, v3
    v_mul_u32_u24 v4, 5, v3
    v_sub_u32 v4, v38, v4
    v_mul_u32_u24 v39, 6144, v3
    v_lshl_add_u32 v39, v4, 3, v39
    v_add_u32 v13, v39, v37
    v_add_u32 v38, 16, v34
    v_mul_u32_u24 v3, 13108, v38
    v_lshrrev_b32 v3, 16, v3
    v_mul_u32_u24 v4, 5, v3
    v_sub_u32 v4, v38, v4
    v_mul_u32_u24 v39, 6144, v3
    v_lshl_add_u32 v39, v4, 3, v39
    v_add_u32 v14, v39, v37
    v_and_b32 v37, 31, v1
    v_add_u32 v38, s60, v37
    v_mul_u32_u24 v38, 48, v38
    v_lshl_add_u32 v21, v35, 4, v38
    v_lshl_add_u32 v22, v35, 3, v38
    v_add_u32 v22, 32, v22
    v_bfe_u32 v38, v1, 2, 2
    v_lshl_add_u32 v38, v35, 2, v38
    v_add_u32 v38, s60, v38
    v_mul_u32_u24 v38, 48, v38
    v_bfe_u32 v39, v1, 4, 1
    v_lshl_add_u32 v38, v39, 5, v38
    v_lshl_add_u32 v38, v33, 3, v38
    v_add_u32 v23, 36864, v38
    v_mul_u32_u24 v24, 20480, v39
    v_lshl_add_u32 v24, v36, 4, v24
    v_lshl_add_u32 v24, v35, 8, v24
    v_mul_u32_u24 v25, 1280, v36
    v_lshl_add_u32 v25, v34, 3, v25
    v_min_u32 v26, 19, v1
    v_lshlrev_b32 v26, 4, v26
    v_lshlrev_b32 v38, 2, v35
    v_sub_u32 v38, v37, v38
    v_mov_b32 v39, 0xf149f2ca
    v_cmp_le_i32 s[62:63], 0, v38
    v_cmp_le_i32 s[64:65], 1, v38
    v_cmp_le_i32 s[66:67], 2, v38
    v_cmp_le_i32 s[68:69], 3, v38
    v_cndmask_b32 v208, v39, 0, s[62:63]
    v_cndmask_b32 v224, 0, v39, s[62:63]
    v_cndmask_b32 v209, v39, 0, s[64:65]
    v_cndmask_b32 v225, 0, v39, s[64:65]
    v_cndmask_b32 v210, v39, 0, s[66:67]
    v_cndmask_b32 v226, 0, v39, s[66:67]
    v_cndmask_b32 v211, v39, 0, s[68:69]
    v_cndmask_b32 v227, 0, v39, s[68:69]
    v_cmp_le_i32 s[62:63], 8, v38
    v_cmp_le_i32 s[64:65], 9, v38
    v_cmp_le_i32 s[66:67], 10, v38
    v_cmp_le_i32 s[68:69], 11, v38
    v_cndmask_b32 v212, v39, 0, s[62:63]
    v_cndmask_b32 v228, 0, v39, s[62:63]
    v_cndmask_b32 v213, v39, 0, s[64:65]
    v_cndmask_b32 v229, 0, v39, s[64:65]
    v_cndmask_b32 v214, v39, 0, s[66:67]
    v_cndmask_b32 v230, 0, v39, s[66:67]
    v_cndmask_b32 v215, v39, 0, s[68:69]
    v_cndmask_b32 v231, 0, v39, s[68:69]
    v_cmp_le_i32 s[62:63], 16, v38
    v_cmp_le_i32 s[64:65], 17, v38
    v_cmp_le_i32 s[66:67], 18, v38
    v_cmp_le_i32 s[68:69], 19, v38
    v_cndmask_b32 v216, v39, 0, s[62:63]
    v_cndmask_b32 v232, 0, v39, s[62:63]
    v_cndmask_b32 v217, v39, 0, s[64:65]
    v_cndmask_b32 v233, 0, v39, s[64:65]
    v_cndmask_b32 v218, v39, 0, s[66:67]
    v_cndmask_b32 v234, 0, v39, s[66:67]
    v_cndmask_b32 v219, v39, 0, s[68:69]
    v_cndmask_b32 v235, 0, v39, s[68:69]
    v_cmp_le_i32 s[62:63], 24, v38
    v_cmp_le_i32 s[64:65], 25, v38
    v_cmp_le_i32 s[66:67], 26, v38
    v_cmp_le_i32 s[68:69], 27, v38
    v_cndmask_b32 v220, v39, 0, s[62:63]
    v_cndmask_b32 v236, 0, v39, s[62:63]
    v_cndmask_b32 v221, v39, 0, s[64:65]
    v_cndmask_b32 v237, 0, v39, s[64:65]
    v_cndmask_b32 v222, v39, 0, s[66:67]
    v_cndmask_b32 v238, 0, v39, s[66:67]
    v_cndmask_b32 v223, v39, 0, s[68:69]
    v_cndmask_b32 v239, 0, v39, s[68:69]
    s_lshl_b32 s71, s44, 1
    s_add_u32 s71, s71, s50
    s_lshl_b32 s71, s71, 2
    s_add_u32 s71, s71, s46
    s_mul_i32 s71, s71, 20480
    s_mul_i32 s61, s51, 160
    s_add_u32 s71, s71, s61
L_nogemv:
    s_cmp_lg_u32 s46, 0
    s_cbranch_scc1 L_p0_dma
    s_setprio 3
    s_waitcnt lgkmcnt(0)
    s_mul_i32 s47, s48, 1664525
    s_add_u32 s47, s47, 1013904223
    s_bfe_u32 s40, s47, 524288
    s_bfe_u32 s41, s47, 524296
    s_bfe_u32 s42, s47, 524304
    s_bfe_u32 s43, s47, 524312
    s_getreg_b32 s72, hwreg(HW_REG_XCC_ID, 0, 4)
    s_lshl_b32 s73, s44, 8
    s_add_u32 s73, s73, 24576
    s_lshl_b32 s61, s45, 4
    v_mov_b32 v8, s61
    v_mov_b32 v18, s47
    v_mov_b32 v19, s72
    s_mov_b64 exec, 1
    buffer_store_dwordx2 v[18:19], v8, s[28:31], s73 offen sc1
    s_mov_b64 exec, -1
    s_mov_b32 s88, 1073741824
    s_mov_b32 s89, 1073741824
    s_mov_b32 s90, 1073741824
    s_mov_b32 s91, 1073741824
    s_mov_b32 s92, 1073741824
    s_mov_b32 s93, 1073741824
    s_mov_b32 s94, 1073741824
    s_mov_b32 s95, 1073741824
    s_mov_b32 s36, s8
    s_mov_b32 s37, s9
    s_mov_b32 s38, 0xc8000
    s_mov_b32 s39, 0x20000
    s_mov_b32 s96, s4
    s_mov_b32 s97, s5
    s_mov_b32 s98, 0x280000
    s_mov_b32 s99, 0x20000
    v_mov_b32 v250, 0
    v_mov_b32 v251, 0
    v_mov_b32 v252, 0
    v_mov_b32 v253, 0
    v_mov_b32 v254, 0
    v_mov_b32 v37, 0
    v_mov_b32 v38, 0
    v_mov_b32 v39, 0
    v_mov_b32 v8, 0x3f803f80
    v_mov_b32 v3, 0
    v_mov_b32 v4, 0
    s_waitcnt vmcnt(10)
    v_dot2_f32_bf16 v3, v160, v8, v3
    v_dot2_f32_bf16 v4, v160, v160, v4
    v_dot2_f32_bf16 v3, v161, v8, v3
    v_dot2_f32_bf16 v4, v161, v161, v4
    v_dot2_f32_bf16 v3, v162, v8, v3
    v_dot2_f32_bf16 v4, v162, v162, v4
    v_dot2_f32_bf16 v3, v163, v8, v3
    v_dot2_f32_bf16 v4, v163, v163, v4
    s_waitcnt vmcnt(9)
    v_dot2_f32_bf16 v3, v164, v8, v3
    v_dot2_f32_bf16 v4, v164, v164, v4
    v_dot2_f32_bf16 v3, v165, v8, v3
    v_dot2_f32_bf16 v4, v165, v165, v4
    v_dot2_f32_bf16 v3, v166, v8, v3
    v_dot2_f32_bf16 v4, v166, v166, v4
    v_dot2_f32_bf16 v3, v167, v8, v3
    v_dot2_f32_bf16 v4, v167, v167, v4
    s_waitcnt vmcnt(8)
    v_dot2_f32_bf16 v3, v168, v8, v3
    v_dot2_f32_bf16 v4, v168, v168, v4
    v_dot2_f32_bf16 v3, v169, v8, v3
    v_dot2_f32_bf16 v4, v169, v169, v4
    v_dot2_f32_bf16 v3, v170, v8, v3
    v_dot2_f32_bf16 v4, v170, v170, v4
    v_dot2_f32_bf16 v3, v171, v8, v3
    v_dot2_f32_bf16 v4, v171, v171, v4
    s_waitcnt vmcnt(7)
    v_dot2_f32_bf16 v3, v172, v8, v3
    v_dot2_f32_bf16 v4, v172, v172, v4
    v_dot2_f32_bf16 v3, v173, v8, v3
    v_dot2_f32_bf16 v4, v173, v173, v4
    v_dot2_f32_bf16 v3, v174, v8, v3
    v_dot2_f32_bf16 v4, v174, v174, v4
    v_dot2_f32_bf16 v3, v175, v8, v3
    v_dot2_f32_bf16 v4, v175, v175, v4
    s_waitcnt vmcnt(6)
    v_dot2_f32_bf16 v3, v176, v8, v3
    v_dot2_f32_bf16 v4, v176, v176, v4
    v_dot2_f32_bf16 v3, v177, v8, v3
    v_dot2_f32_bf16 v4, v177, v177, v4
    v_dot2_f32_bf16 v3, v178, v8, v3
    v_dot2_f32_bf16 v4, v178, v178, v4
    v_dot2_f32_bf16 v3, v179, v8, v3
    v_dot2_f32_bf16 v4, v179, v179, v4
    s_waitcnt vmcnt(5)
    v_dot2_f32_bf16 v3, v180, v8, v3
    v_dot2_f32_bf16 v4, v180, v180, v4
    v_dot2_f32_bf16 v3, v181, v8, v3
    v_dot2_f32_bf16 v4, v181, v181, v4
    v_dot2_f32_bf16 v3, v182, v8, v3
    v_dot2_f32_bf16 v4, v182, v182, v4
    v_dot2_f32_bf16 v3, v183, v8, v3
    v_dot2_f32_bf16 v4, v183, v183, v4
    s_waitcnt vmcnt(4)
    v_dot2_f32_bf16 v3, v184, v8, v3
    v_dot2_f32_bf16 v4, v184, v184, v4
    v_dot2_f32_bf16 v3, v185, v8, v3
    v_dot2_f32_bf16 v4, v185, v185, v4
    v_dot2_f32_bf16 v3, v186, v8, v3
    v_dot2_f32_bf16 v4, v186, v186, v4
    v_dot2_f32_bf16 v3, v187, v8, v3
    v_dot2_f32_bf16 v4, v187, v187, v4
    s_waitcnt vmcnt(3)
    v_dot2_f32_bf16 v3, v188, v8, v3
    v_dot2_f32_bf16 v4, v188, v188, v4
    v_dot2_f32_bf16 v3, v189, v8, v3
    v_dot2_f32_bf16 v4, v189, v189, v4
    v_dot2_f32_bf16 v3, v190, v8, v3
    v_dot2_f32_bf16 v4, v190, v190, v4
    v_dot2_f32_bf16 v3, v191, v8, v3
    v_dot2_f32_bf16 v4, v191, v191, v4
    s_waitcnt vmcnt(2)
    v_dot2_f32_bf16 v3, v192, v8, v3
    v_dot2_f32_bf16 v4, v192, v192, v4
    v_dot2_f32_bf16 v3, v193, v8, v3
    v_dot2_f32_bf16 v4, v193, v193, v4
    v_dot2_f32_bf16 v3, v194, v8, v3
    v_dot2_f32_bf16 v4, v194, v194, v4
    v_dot2_f32_bf16 v3, v195, v8, v3
    v_dot2_f32_bf16 v4, v195, v195, v4
    s_waitcnt vmcnt(1)
    v_dot2_f32_bf16 v3, v196, v8, v3
    v_dot2_f32_bf16 v4, v196, v196, v4
    v_dot2_f32_bf16 v3, v197, v8, v3
    v_dot2_f32_bf16 v4, v197, v197, v4
    v_dot2_f32_bf16 v3, v198, v8, v3
    v_dot2_f32_bf16 v4, v198, v198, v4
    v_dot2_f32_bf16 v3, v199, v8, v3
    v_dot2_f32_bf16 v4, v199, v199, v4
    s_lshl_b32 s68, s44, 3
    s_add_u32 s68, s68, s51
    s_mul_i32 s68, s68, 20480
    s_lshl_b32 s69, s50, 7
    s_add_u32 s68, s68, s69
    s_add_u32 s68, s68, 1048576
    v_lshlrev_b32 v243, 8, v1
    buffer_load_dword v244, v243, s[28:31], s68 offen
    v_and_b32 v245, 15, v1
    v_lshlrev_b32 v245, 8, v245
    v_add_u32 v245, s68, v245
    v_add_u32 v245, 16384, v245
    v_bfe_u32 v246, v1, 1, 3
    v_min_u32 v246, 5, v246
    v_lshlrev_b32 v246, 12, v246
    v_and_b32 v247, 1, v1
    v_lshl_add_u32 v246, v247, 7, v246
    s_lshl_b32 s69, s44, 8
    s_add_u32 s69, s69, 4096
    v_add_u32 v246, s69, v246
    v_cmp_lt_u32 s[58:59], 15, v1
    s_nop 1
    v_cndmask_b32 v245, v245, v246, s[58:59]
    buffer_load_dword v248, v245, s[28:31], 0 offen
    v_add_f32_dpp v8, v3, v3 row_ror:8 row_mask:0xf bank_mask:0xf
    v_add_f32_dpp v9, v4, v4 row_ror:8 row_mask:0xf bank_mask:0xf
    v_mov_b32 v3, v8
    v_mov_b32 v4, v9
    v_mov_b32 v8, v3
    v_mov_b32 v9, v4
    s_nop 0
    v_permlane16_swap_b32 v3, v8
    v_permlane16_swap_b32 v4, v9
    v_add_f32 v3, v3, v8
    v_add_f32 v4, v4, v9
    v_mov_b32 v8, v3
    v_mov_b32 v9, v4
    s_nop 0
    v_permlane32_swap_b32 v3, v8
    v_permlane32_swap_b32 v4, v9
    v_add_f32 v3, v3, v8
    v_add_f32 v4, v4, v9
    v_mul_f32 v3, 0x3acccccd, v3
    v_mul_f32 v8, v3, v3
    v_mov_b32 v9, 0x3acccccd
    v_fma_f32 v4, v4, v9, -v8
    v_max_f32 v4, 0, v4
    v_add_f32 v4, 0x3727c5ac, v4
    v_rsq_f32 v4, v4
    s_nop 0
    v_mul_f32 v3, v3, v4
    v_sub_f32 v3, 0, v3
    v_mov_b32 v8, v4
    v_mov_b32 v9, v4
    v_mov_b32 v18, v3
    v_mov_b32 v19, v3
    v_lshlrev_b32 v80, 16, v160
    v_and_b32 v81, 0xffff0000, v160
    v_pk_fma_f32 v[80:81], v[80:81], v[8:9], v[18:19]
    v_lshlrev_b32 v82, 16, v161
    v_and_b32 v83, 0xffff0000, v161
    v_pk_fma_f32 v[82:83], v[82:83], v[8:9], v[18:19]
    v_lshlrev_b32 v84, 16, v162
    v_and_b32 v85, 0xffff0000, v162
    v_pk_fma_f32 v[84:85], v[84:85], v[8:9], v[18:19]
    v_lshlrev_b32 v86, 16, v163
    v_and_b32 v87, 0xffff0000, v163
    v_pk_fma_f32 v[86:87], v[86:87], v[8:9], v[18:19]
    v_lshlrev_b32 v88, 16, v164
    v_and_b32 v89, 0xffff0000, v164
    v_pk_fma_f32 v[88:89], v[88:89], v[8:9], v[18:19]
    v_lshlrev_b32 v90, 16, v165
    v_and_b32 v91, 0xffff0000, v165
    v_pk_fma_f32 v[90:91], v[90:91], v[8:9], v[18:19]
    v_lshlrev_b32 v92, 16, v166
    v_and_b32 v93, 0xffff0000, v166
    v_pk_fma_f32 v[92:93], v[92:93], v[8:9], v[18:19]
    v_lshlrev_b32 v94, 16, v167
    v_and_b32 v95, 0xffff0000, v167
    v_pk_fma_f32 v[94:95], v[94:95], v[8:9], v[18:19]
    v_lshlrev_b32 v96, 16, v168
    v_and_b32 v97, 0xffff0000, v168
    v_pk_fma_f32 v[96:97], v[96:97], v[8:9], v[18:19]
    v_lshlrev_b32 v98, 16, v169
    v_and_b32 v99, 0xffff0000, v169
    v_pk_fma_f32 v[98:99], v[98:99], v[8:9], v[18:19]
    v_lshlrev_b32 v100, 16, v170
    v_and_b32 v101, 0xffff0000, v170
    v_pk_fma_f32 v[100:101], v[100:101], v[8:9], v[18:19]
    v_lshlrev_b32 v102, 16, v171
    v_and_b32 v103, 0xffff0000, v171
    v_pk_fma_f32 v[102:103], v[102:103], v[8:9], v[18:19]
    v_lshlrev_b32 v104, 16, v172
    v_and_b32 v105, 0xffff0000, v172
    v_pk_fma_f32 v[104:105], v[104:105], v[8:9], v[18:19]
    v_lshlrev_b32 v106, 16, v173
    v_and_b32 v107, 0xffff0000, v173
    v_pk_fma_f32 v[106:107], v[106:107], v[8:9], v[18:19]
    v_lshlrev_b32 v108, 16, v174
    v_and_b32 v109, 0xffff0000, v174
    v_pk_fma_f32 v[108:109], v[108:109], v[8:9], v[18:19]
    v_lshlrev_b32 v110, 16, v175
    v_and_b32 v111, 0xffff0000, v175
    v_pk_fma_f32 v[110:111], v[110:111], v[8:9], v[18:19]
    v_lshlrev_b32 v112, 16, v176
    v_and_b32 v113, 0xffff0000, v176
    v_pk_fma_f32 v[112:113], v[112:113], v[8:9], v[18:19]
    v_lshlrev_b32 v114, 16, v177
    v_and_b32 v115, 0xffff0000, v177
    v_pk_fma_f32 v[114:115], v[114:115], v[8:9], v[18:19]
    v_lshlrev_b32 v116, 16, v178
    v_and_b32 v117, 0xffff0000, v178
    v_pk_fma_f32 v[116:117], v[116:117], v[8:9], v[18:19]
    v_lshlrev_b32 v118, 16, v179
    v_and_b32 v119, 0xffff0000, v179
    v_pk_fma_f32 v[118:119], v[118:119], v[8:9], v[18:19]
    v_lshlrev_b32 v120, 16, v180
    v_and_b32 v121, 0xffff0000, v180
    v_pk_fma_f32 v[120:121], v[120:121], v[8:9], v[18:19]
    v_lshlrev_b32 v122, 16, v181
    v_and_b32 v123, 0xffff0000, v181
    v_pk_fma_f32 v[122:123], v[122:123], v[8:9], v[18:19]
    v_lshlrev_b32 v124, 16, v182
    v_and_b32 v125, 0xffff0000, v182
    v_pk_fma_f32 v[124:125], v[124:125], v[8:9], v[18:19]
    v_lshlrev_b32 v126, 16, v183
    v_and_b32 v127, 0xffff0000, v183
    v_pk_fma_f32 v[126:127], v[126:127], v[8:9], v[18:19]
    v_lshlrev_b32 v128, 16, v184
    v_and_b32 v129, 0xffff0000, v184
    v_pk_fma_f32 v[128:129], v[128:129], v[8:9], v[18:19]
    v_lshlrev_b32 v130, 16, v185
    v_and_b32 v131, 0xffff0000, v185
    v_pk_fma_f32 v[130:131], v[130:131], v[8:9], v[18:19]
    v_lshlrev_b32 v132, 16, v186
    v_and_b32 v133, 0xffff0000, v186
    v_pk_fma_f32 v[132:133], v[132:133], v[8:9], v[18:19]
    v_lshlrev_b32 v134, 16, v187
    v_and_b32 v135, 0xffff0000, v187
    v_pk_fma_f32 v[134:135], v[134:135], v[8:9], v[18:19]
    v_lshlrev_b32 v136, 16, v188
    v_and_b32 v137, 0xffff0000, v188
    v_pk_fma_f32 v[136:137], v[136:137], v[8:9], v[18:19]
    v_lshlrev_b32 v138, 16, v189
    v_and_b32 v139, 0xffff0000, v189
    v_pk_fma_f32 v[138:139], v[138:139], v[8:9], v[18:19]
    v_lshlrev_b32 v140, 16, v190
    v_and_b32 v141, 0xffff0000, v190
    v_pk_fma_f32 v[140:141], v[140:141], v[8:9], v[18:19]
    v_lshlrev_b32 v142, 16, v191
    v_and_b32 v143, 0xffff0000, v191
    v_pk_fma_f32 v[142:143], v[142:143], v[8:9], v[18:19]
    v_lshlrev_b32 v144, 16, v192
    v_and_b32 v145, 0xffff0000, v192
    v_pk_fma_f32 v[144:145], v[144:145], v[8:9], v[18:19]
    v_lshlrev_b32 v146, 16, v193
    v_and_b32 v147, 0xffff0000, v193
    v_pk_fma_f32 v[146:147], v[146:147], v[8:9], v[18:19]
    v_lshlrev_b32 v148, 16, v194
    v_and_b32 v149, 0xffff0000, v194
    v_pk_fma_f32 v[148:149], v[148:149], v[8:9], v[18:19]
    v_lshlrev_b32 v150, 16, v195
    v_and_b32 v151, 0xffff0000, v195
    v_pk_fma_f32 v[150:151], v[150:151], v[8:9], v[18:19]
    v_lshlrev_b32 v152, 16, v196
    v_and_b32 v153, 0xffff0000, v196
    v_pk_fma_f32 v[152:153], v[152:153], v[8:9], v[18:19]
    v_lshlrev_b32 v154, 16, v197
    v_and_b32 v155, 0xffff0000, v197
    v_pk_fma_f32 v[154:155], v[154:155], v[8:9], v[18:19]
    v_lshlrev_b32 v156, 16, v198
    v_and_b32 v157, 0xffff0000, v198
    v_pk_fma_f32 v[156:157], v[156:157], v[8:9], v[18:19]
    v_lshlrev_b32 v158, 16, v199
    v_and_b32 v159, 0xffff0000, v199
    v_pk_fma_f32 v[158:159], v[158:159], v[8:9], v[18:19]
    s_mov_b32 s61, 65536
    s_mov_b32 s62, 69632
    s_mov_b32 s63, 80896
    s_mov_b32 s64, 84992
    v_and_b32 v242, 15, v1
    v_lshlrev_b32 v242, 4, v242
    v_add_u32 v243, 153600, v2
    s_waitcnt vmcnt(1)
    v_cndmask_b32 v244, 0, 1.0, s[56:57]
    v_lshlrev_b32 v245, 5, v241
    v_add_u32 v245, 153600, v245
    v_lshlrev_b32 v246, 8, v241
    v_lshl_add_u32 v246, v240, 4, v246
    s_lshl_b32 s60, s44, 3
    s_add_u32 s60, s60, s51
    s_mul_i32 s60, s60, 20480
    s_lshl_b32 s65, s50, 7
    s_add_u32 s60, s60, s65
    s_add_u32 s60, s60, 1048576
    s_mov_b32 s54, 32768
Lm3:
    buffer_load_dwordx4 v[40:43], v2, s[28:31], s61 offen offset:0 sc1
    buffer_load_dwordx4 v[160:163], v2, s[28:31], s63 offen offset:0 sc1
    buffer_load_dwordx4 v[44:47], v2, s[28:31], s61 offen offset:1024 sc1
    buffer_load_dwordx4 v[164:167], v2, s[28:31], s63 offen offset:1024 sc1
    buffer_load_dwordx4 v[48:51], v2, s[28:31], s61 offen offset:2048 sc1
    buffer_load_dwordx4 v[168:171], v2, s[28:31], s63 offen offset:2048 sc1
    buffer_load_dwordx4 v[52:55], v2, s[28:31], s61 offen offset:3072 sc1
    buffer_load_dwordx4 v[172:175], v2, s[28:31], s63 offen offset:3072 sc1
    buffer_load_dwordx4 v[56:59], v2, s[28:31], s62 offen offset:0 sc1
    buffer_load_dwordx4 v[176:179], v2, s[28:31], s64 offen offset:0 sc1
    s_waitcnt vmcnt(10)
    buffer_load_dwordx2 v[248:249], v242, s[28:31], s73 offen sc1
    s_waitcnt vmcnt(10)
    v_xor_b32 v40, s40, v40
    v_xor_b32 v41, s41, v41
    v_xor_b32 v42, s42, v42
    v_xor_b32 v43, s43, v43
    v_or_b32 v247, v40, v41
    v_or3_b32 v247, v42, v43, v247
    s_waitcnt vmcnt(9)
    v_xor_b32 v160, s40, v160
    v_xor_b32 v161, s41, v161
    v_xor_b32 v162, s42, v162
    v_xor_b32 v163, s43, v163
    v_or3_b32 v247, v160, v161, v247
    v_or3_b32 v247, v162, v163, v247
    s_waitcnt vmcnt(8)
    v_xor_b32 v44, s40, v44
    v_xor_b32 v45, s41, v45
    v_xor_b32 v46, s42, v46
    v_xor_b32 v47, s43, v47
    v_or3_b32 v247, v44, v45, v247
    v_or3_b32 v247, v46, v47, v247
    s_waitcnt vmcnt(7)
    v_xor_b32 v164, s40, v164
    v_xor_b32 v165, s41, v165
    v_xor_b32 v166, s42, v166
    v_xor_b32 v167, s43, v167
    v_or3_b32 v247, v164, v165, v247
    v_or3_b32 v247, v166, v167, v247
    s_waitcnt vmcnt(6)
    v_xor_b32 v48, s40, v48
    v_xor_b32 v49, s41, v49
    v_xor_b32 v50, s42, v50
    v_xor_b32 v51, s43, v51
    v_or3_b32 v247, v48, v49, v247
    v_or3_b32 v247, v50, v51, v247
    s_waitcnt vmcnt(5)
    v_xor_b32 v168, s40, v168
    v_xor_b32 v169, s41, v169
    v_xor_b32 v170, s42, v170
    v_xor_b32 v171, s43, v171
    v_or3_b32 v247, v168, v169, v247
    v_or3_b32 v247, v170, v171, v247
    s_waitcnt vmcnt(4)
    v_xor_b32 v52, s40, v52
    v_xor_b32 v53, s41, v53
    v_xor_b32 v54, s42, v54
    v_xor_b32 v55, s43, v55
    v_or3_b32 v247, v52, v53, v247
    v_or3_b32 v247, v54, v55, v247
    s_waitcnt vmcnt(3)
    v_xor_b32 v172, s40, v172
    v_xor_b32 v173, s41, v173
    v_xor_b32 v174, s42, v174
    v_xor_b32 v175, s43, v175
    v_or3_b32 v247, v172, v173, v247
    v_or3_b32 v247, v174, v175, v247
    s_waitcnt vmcnt(2)
    v_xor_b32 v56, s40, v56
    v_xor_b32 v57, s41, v57
    v_xor_b32 v58, s42, v58
    v_xor_b32 v59, s43, v59
    v_or3_b32 v247, v56, v57, v247
    v_or3_b32 v247, v58, v59, v247
    s_waitcnt vmcnt(1)
    v_xor_b32 v176, s40, v176
    v_xor_b32 v177, s41, v177
    v_xor_b32 v178, s42, v178
    v_xor_b32 v179, s43, v179
    v_or3_b32 v247, v176, v177, v247
    v_or3_b32 v247, v178, v179, v247
    v_and_b32 v247, 0xff, v247
    s_waitcnt vmcnt(0)
    v_bitop3_b32 v247, v247, v248, s47 bitop3:0xf6
    v_cmp_ne_u32 vcc, 0, v247
    s_cbranch_vccz Lmd4
    s_sub_u32 s54, s54, 1
    s_cbranch_scc0 Lm3
Lmd4:
    v_pk_add_f32 v[40:41], v[40:41], v[160:161]
    v_pk_add_f32 v[42:43], v[42:43], v[162:163]
    v_cvt_pk_bf16_f32 v40, v40, v41
    v_cvt_pk_bf16_f32 v42, v42, v43
    v_and_b32 v41, 0xffff0000, v40
    v_lshlrev_b32 v40, 16, v40
    v_and_b32 v43, 0xffff0000, v42
    v_lshlrev_b32 v42, 16, v42
    ds_write_b128 v243, v[40:43] offset:0
    v_pk_add_f32 v[44:45], v[44:45], v[164:165]
    v_pk_add_f32 v[46:47], v[46:47], v[166:167]
    v_cvt_pk_bf16_f32 v44, v44, v45
    v_cvt_pk_bf16_f32 v46, v46, v47
    v_and_b32 v45, 0xffff0000, v44
    v_lshlrev_b32 v44, 16, v44
    v_and_b32 v47, 0xffff0000, v46
    v_lshlrev_b32 v46, 16, v46
    ds_write_b128 v243, v[44:47] offset:1024
    v_pk_add_f32 v[48:49], v[48:49], v[168:169]
    v_pk_add_f32 v[50:51], v[50:51], v[170:171]
    v_cvt_pk_bf16_f32 v48, v48, v49
    v_cvt_pk_bf16_f32 v50, v50, v51
    v_and_b32 v49, 0xffff0000, v48
    v_lshlrev_b32 v48, 16, v48
    v_and_b32 v51, 0xffff0000, v50
    v_lshlrev_b32 v50, 16, v50
    v_add_f32 v48, v244, v48
    v_add_f32 v49, v244, v49
    v_add_f32 v50, v244, v50
    v_add_f32 v51, v244, v51
    v_cvt_pk_bf16_f32 v48, v48, v49
    v_cvt_pk_bf16_f32 v50, v50, v51
    v_and_b32 v49, 0xffff0000, v48
    v_lshlrev_b32 v48, 16, v48
    v_and_b32 v51, 0xffff0000, v50
    v_lshlrev_b32 v50, 16, v50
    ds_write_b128 v243, v[48:51] offset:2048
    v_pk_add_f32 v[52:53], v[52:53], v[172:173]
    v_pk_add_f32 v[54:55], v[54:55], v[174:175]
    v_cvt_pk_bf16_f32 v52, v52, v53
    v_cvt_pk_bf16_f32 v54, v54, v55
    v_and_b32 v53, 0xffff0000, v52
    v_lshlrev_b32 v52, 16, v52
    v_and_b32 v55, 0xffff0000, v54
    v_lshlrev_b32 v54, 16, v54
    v_add_f32 v52, 1.0, v52
    v_add_f32 v53, 1.0, v53
    v_add_f32 v54, 1.0, v54
    v_add_f32 v55, 1.0, v55
    v_cvt_pk_bf16_f32 v52, v52, v53
    v_cvt_pk_bf16_f32 v54, v54, v55
    v_and_b32 v53, 0xffff0000, v52
    v_lshlrev_b32 v52, 16, v52
    v_and_b32 v55, 0xffff0000, v54
    v_lshlrev_b32 v54, 16, v54
    ds_write_b128 v243, v[52:55] offset:3072
    v_pk_add_f32 v[56:57], v[56:57], v[176:177]
    v_pk_add_f32 v[58:59], v[58:59], v[178:179]
    v_cvt_pk_bf16_f32 v56, v56, v57
    v_cvt_pk_bf16_f32 v58, v58, v59
    v_and_b32 v57, 0xffff0000, v56
    v_lshlrev_b32 v56, 16, v56
    v_and_b32 v59, 0xffff0000, v58
    v_lshlrev_b32 v58, 16, v58
    v_add_f32 v56, 1.0, v56
    v_add_f32 v57, 1.0, v57
    v_add_f32 v58, 1.0, v58
    v_add_f32 v59, 1.0, v59
    v_cvt_pk_bf16_f32 v56, v56, v57
    v_cvt_pk_bf16_f32 v58, v58, v59
    v_and_b32 v57, 0xffff0000, v56
    v_lshlrev_b32 v56, 16, v56
    v_and_b32 v59, 0xffff0000, v58
    v_lshlrev_b32 v58, 16, v58
    ds_write_b128 v243, v[56:59] offset:4096
    v_cmp_ne_u32 vcc, s72, v249
    s_nop 0
    s_cmp_eq_u64 vcc, 0
    s_cselect_b32 s55, 1, 0
    v_mov_b32 v248, s55
    v_mov_b32 v249, 161792
    ds_write_b32 v249, v248
    s_waitcnt lgkmcnt(0)
    ds_read_b128 v[160:163], v245 offset:0
    ds_read_b128 v[164:167], v245 offset:16
    ds_read_b128 v[168:171], v245 offset:2560
    ds_read_b128 v[172:175], v245 offset:2576
    ds_read_b128 v[176:179], v245 offset:256
    ds_read_b128 v[180:183], v245 offset:272
    ds_read_b128 v[184:187], v245 offset:2816
    ds_read_b128 v[188:191], v245 offset:2832
    ds_read_b128 v[192:195], v245 offset:512
    ds_read_b128 v[196:199], v245 offset:528
    ds_read_b128 v[200:203], v245 offset:3072
    ds_read_b128 v[204:207], v245 offset:3088
    s_waitcnt lgkmcnt(8)
    v_pk_fma_f32 v[80:81], v[80:81], v[168:169], v[160:161]
    v_pk_fma_f32 v[82:83], v[82:83], v[170:171], v[162:163]
    v_pk_fma_f32 v[84:85], v[84:85], v[172:173], v[164:165]
    v_pk_fma_f32 v[86:87], v[86:87], v[174:175], v[166:167]
    v_cvt_pk_bf16_f32 v40, v80, v81
    v_cvt_pk_bf16_f32 v41, v82, v83
    v_cvt_pk_bf16_f32 v42, v84, v85
    v_cvt_pk_bf16_f32 v43, v86, v87
    buffer_store_dwordx4 v[40:43], v246, s[28:31], s60 offen offset:0
    ds_read_b128 v[160:163], v245 offset:768
    ds_read_b128 v[164:167], v245 offset:784
    ds_read_b128 v[168:171], v245 offset:3328
    ds_read_b128 v[172:175], v245 offset:3344
    s_waitcnt lgkmcnt(8)
    v_pk_fma_f32 v[88:89], v[88:89], v[184:185], v[176:177]
    v_pk_fma_f32 v[90:91], v[90:91], v[186:187], v[178:179]
    v_pk_fma_f32 v[92:93], v[92:93], v[188:189], v[180:181]
    v_pk_fma_f32 v[94:95], v[94:95], v[190:191], v[182:183]
    v_cvt_pk_bf16_f32 v44, v88, v89
    v_cvt_pk_bf16_f32 v45, v90, v91
    v_cvt_pk_bf16_f32 v46, v92, v93
    v_cvt_pk_bf16_f32 v47, v94, v95
    buffer_store_dwordx4 v[44:47], v246, s[28:31], s60 offen offset:2048
    s_add_u32 s60, s60, 4096
    ds_read_b128 v[176:179], v245 offset:1024
    ds_read_b128 v[180:183], v245 offset:1040
    ds_read_b128 v[184:187], v245 offset:3584
    ds_read_b128 v[188:191], v245 offset:3600
    s_waitcnt lgkmcnt(8)
    v_pk_fma_f32 v[96:97], v[96:97], v[200:201], v[192:193]
    v_pk_fma_f32 v[98:99], v[98:99], v[202:203], v[194:195]
    v_pk_fma_f32 v[100:101], v[100:101], v[204:205], v[196:197]
    v_pk_fma_f32 v[102:103], v[102:103], v[206:207], v[198:199]
    v_cvt_pk_bf16_f32 v48, v96, v97
    v_cvt_pk_bf16_f32 v49, v98, v99
    v_cvt_pk_bf16_f32 v50, v100, v101
    v_cvt_pk_bf16_f32 v51, v102, v103
    buffer_store_dwordx4 v[48:51], v246, s[28:31], s60 offen offset:0
    ds_read_b128 v[192:195], v245 offset:1280
    ds_read_b128 v[196:199], v245 offset:1296
    ds_read_b128 v[200:203], v245 offset:3840
    ds_read_b128 v[204:207], v245 offset:3856
    s_waitcnt lgkmcnt(8)
    v_pk_fma_f32 v[104:105], v[104:105], v[168:169], v[160:161]
    v_pk_fma_f32 v[106:107], v[106:107], v[170:171], v[162:163]
    v_pk_fma_f32 v[108:109], v[108:109], v[172:173], v[164:165]
    v_pk_fma_f32 v[110:111], v[110:111], v[174:175], v[166:167]
    v_cvt_pk_bf16_f32 v52, v104, v105
    v_cvt_pk_bf16_f32 v53, v106, v107
    v_cvt_pk_bf16_f32 v54, v108, v109
    v_cvt_pk_bf16_f32 v55, v110, v111
    buffer_store_dwordx4 v[52:55], v246, s[28:31], s60 offen offset:2048
    s_add_u32 s60, s60, 4096
    ds_read_b128 v[160:163], v245 offset:1536
    ds_read_b128 v[164:167], v245 offset:1552
    ds_read_b128 v[168:171], v245 offset:4096
    ds_read_b128 v[172:175], v245 offset:4112
    s_waitcnt lgkmcnt(8)
    v_pk_fma_f32 v[112:113], v[112:113], v[184:185], v[176:177]
    v_pk_fma_f32 v[114:115], v[114:115], v[186:187], v[178:179]
    v_pk_fma_f32 v[116:117], v[116:117], v[188:189], v[180:181]
    v_pk_fma_f32 v[118:119], v[118:119], v[190:191], v[182:183]
    v_cvt_pk_bf16_f32 v56, v112, v113
    v_cvt_pk_bf16_f32 v57, v114, v115
    v_cvt_pk_bf16_f32 v58, v116, v117
    v_cvt_pk_bf16_f32 v59, v118, v119
    buffer_store_dwordx4 v[56:59], v246, s[28:31], s60 offen offset:0
    ds_read_b128 v[176:179], v245 offset:1792
    ds_read_b128 v[180:183], v245 offset:1808
    ds_read_b128 v[184:187], v245 offset:4352
    ds_read_b128 v[188:191], v245 offset:4368
    s_waitcnt lgkmcnt(8)
    v_pk_fma_f32 v[120:121], v[120:121], v[200:201], v[192:193]
    v_pk_fma_f32 v[122:123], v[122:123], v[202:203], v[194:195]
    v_pk_fma_f32 v[124:125], v[124:125], v[204:205], v[196:197]
    v_pk_fma_f32 v[126:127], v[126:127], v[206:207], v[198:199]
    v_cvt_pk_bf16_f32 v60, v120, v121
    v_cvt_pk_bf16_f32 v61, v122, v123
    v_cvt_pk_bf16_f32 v62, v124, v125
    v_cvt_pk_bf16_f32 v63, v126, v127
    buffer_store_dwordx4 v[60:63], v246, s[28:31], s60 offen offset:2048
    s_add_u32 s60, s60, 4096
    ds_read_b128 v[192:195], v245 offset:2048
    ds_read_b128 v[196:199], v245 offset:2064
    ds_read_b128 v[200:203], v245 offset:4608
    ds_read_b128 v[204:207], v245 offset:4624
    s_waitcnt lgkmcnt(8)
    v_pk_fma_f32 v[128:129], v[128:129], v[168:169], v[160:161]
    v_pk_fma_f32 v[130:131], v[130:131], v[170:171], v[162:163]
    v_pk_fma_f32 v[132:133], v[132:133], v[172:173], v[164:165]
    v_pk_fma_f32 v[134:135], v[134:135], v[174:175], v[166:167]
    v_cvt_pk_bf16_f32 v64, v128, v129
    v_cvt_pk_bf16_f32 v65, v130, v131
    v_cvt_pk_bf16_f32 v66, v132, v133
    v_cvt_pk_bf16_f32 v67, v134, v135
    buffer_store_dwordx4 v[64:67], v246, s[28:31], s60 offen offset:0
    ds_read_b128 v[160:163], v245 offset:2304
    ds_read_b128 v[164:167], v245 offset:2320
    ds_read_b128 v[168:171], v245 offset:4864
    ds_read_b128 v[172:175], v245 offset:4880
    s_waitcnt lgkmcnt(8)
    v_pk_fma_f32 v[136:137], v[136:137], v[184:185], v[176:177]
    v_pk_fma_f32 v[138:139], v[138:139], v[186:187], v[178:179]
    v_pk_fma_f32 v[140:141], v[140:141], v[188:189], v[180:181]
    v_pk_fma_f32 v[142:143], v[142:143], v[190:191], v[182:183]
    v_cvt_pk_bf16_f32 v68, v136, v137
    v_cvt_pk_bf16_f32 v69, v138, v139
    v_cvt_pk_bf16_f32 v70, v140, v141
    v_cvt_pk_bf16_f32 v71, v142, v143
    buffer_store_dwordx4 v[68:71], v246, s[28:31], s60 offen offset:2048
    s_add_u32 s60, s60, 4096
    s_waitcnt lgkmcnt(4)
    v_pk_fma_f32 v[144:145], v[144:145], v[200:201], v[192:193]
    v_pk_fma_f32 v[146:147], v[146:147], v[202:203], v[194:195]
    v_pk_fma_f32 v[148:149], v[148:149], v[204:205], v[196:197]
    v_pk_fma_f32 v[150:151], v[150:151], v[206:207], v[198:199]
    v_cvt_pk_bf16_f32 v72, v144, v145
    v_cvt_pk_bf16_f32 v73, v146, v147
    v_cvt_pk_bf16_f32 v74, v148, v149
    v_cvt_pk_bf16_f32 v75, v150, v151
    buffer_store_dwordx4 v[72:75], v246, s[28:31], s60 offen offset:0
    s_waitcnt lgkmcnt(0)
    v_pk_fma_f32 v[152:153], v[152:153], v[168:169], v[160:161]
    v_pk_fma_f32 v[154:155], v[154:155], v[170:171], v[162:163]
    v_pk_fma_f32 v[156:157], v[156:157], v[172:173], v[164:165]
    v_pk_fma_f32 v[158:159], v[158:159], v[174:175], v[166:167]
    v_cvt_pk_bf16_f32 v76, v152, v153
    v_cvt_pk_bf16_f32 v77, v154, v155
    v_cvt_pk_bf16_f32 v78, v156, v157
    v_cvt_pk_bf16_f32 v79, v158, v159
    buffer_store_dwordx4 v[76:79], v246, s[28:31], s60 offen offset:2048
    s_waitcnt vmcnt(0)
    s_lshl_b32 s60, s44, 8
    s_add_u32 s60, s60, 4096
    s_lshl_b32 s61, s45, 4
    s_lshl_b32 s62, s46, 2
    s_add_u32 s61, s61, s62
    v_mov_b32 v8, s61
    v_mov_b32 v9, s47
    s_mov_b64 exec, 1
    s_cmp_eq_u32 s55, 0
    s_cbranch_scc1 Lslow5
    buffer_store_dword v9, v8, s[28:31], s60 offen
Ljoin6:
    s_mov_b64 exec, -1
    s_lshl_b32 s60, s44, 8
    s_add_u32 s60, s60, 4096
    s_mov_b32 s54, 32768
Lp7:
    buffer_load_dword v4, v242, s[28:31], s60 offen offset:0 sc1
    s_waitcnt vmcnt(0)
    v_cmp_ne_u32 vcc, s47, v4
    s_cbranch_vccz Lpd8
    s_sub_u32 s54, s54, 1
    s_cbranch_scc0 Lp7
Lpd8:
    s_setprio 0
    s_branch L_p0_join
L_p0_dma:
    s_mov_b32 s32, s6
    s_mov_b32 s33, s7
    s_mov_b32 s34, 0x258000
    s_mov_b32 s35, 0x20000
    v_min_u32 v32, 39, v1
    s_sub_u32 s61, s46, 1
    s_mul_i32 s62, s61, 40
    v_add_u32 v32, s62, v32
    v_mul_u32_u24 v33, 2185, v32
    v_lshrrev_b32 v33, 16, v33
    v_mul_u32_u24 v34, 30, v33
    v_sub_u32 v34, v32, v34
    v_mul_u32_u24 v33, 3840, v33
    v_lshl_add_u32 v46, v34, 7, v33
    s_lshr_b32 s64, s2, 3
    s_mul_i32 s64, s64, 15360
    s_cmp_eq_u32 s46, 3
    s_cbranch_scc1 L_p0_q
    v_add_u32 v32, 0, v1
    v_mul_u32_u24 v33, 6554, v32
    v_lshrrev_b32 v33, 16, v33
    v_mul_u32_u24 v34, 10, v33
    v_sub_u32 v34, v32, v34
    v_and_b32 v35, 3, v33
    v_lshrrev_b32 v36, 4, v33
    v_lshl_add_u32 v35, v36, 2, v35
    v_bfe_u32 v36, v33, 2, 2
    v_lshl_add_u32 v35, v36, 3, v35
    v_mul_u32_u24 v35, 3840, v35
    v_lshl_add_u32 v35, v34, 4, v35
    v_add_u32 v40, 1280, v35
    v_add_u32 v32, 64, v1
    v_mul_u32_u24 v33, 6554, v32
    v_lshrrev_b32 v33, 16, v33
    v_mul_u32_u24 v34, 10, v33
    v_sub_u32 v34, v32, v34
    v_and_b32 v35, 3, v33
    v_lshrrev_b32 v36, 4, v33
    v_lshl_add_u32 v35, v36, 2, v35
    v_bfe_u32 v36, v33, 2, 2
    v_lshl_add_u32 v35, v36, 3, v35
    v_mul_u32_u24 v35, 3840, v35
    v_lshl_add_u32 v35, v34, 4, v35
    v_add_u32 v41, 256, v35
    v_add_u32 v32, 128, v1
    v_mul_u32_u24 v33, 6554, v32
    v_lshrrev_b32 v33, 16, v33
    v_mul_u32_u24 v34, 10, v33
    v_sub_u32 v34, v32, v34
    v_and_b32 v35, 3, v33
    v_lshrrev_b32 v36, 4, v33
    v_lshl_add_u32 v35, v36, 2, v35
    v_bfe_u32 v36, v33, 2, 2
    v_lshl_add_u32 v35, v36, 3, v35
    v_mul_u32_u24 v35, 3840, v35
    v_lshl_add_u32 v35, v34, 4, v35
    v_subrev_u32 v42, 768, v35
    v_add_u32 v32, 192, v1
    v_mul_u32_u24 v33, 6554, v32
    v_lshrrev_b32 v33, 16, v33
    v_mul_u32_u24 v34, 10, v33
    v_sub_u32 v34, v32, v34
    v_and_b32 v35, 3, v33
    v_lshrrev_b32 v36, 4, v33
    v_lshl_add_u32 v35, v36, 2, v35
    v_bfe_u32 v36, v33, 2, 2
    v_lshl_add_u32 v35, v36, 3, v35
    v_mul_u32_u24 v35, 3840, v35
    v_lshl_add_u32 v35, v34, 4, v35
    v_subrev_u32 v43, 1792, v35
    v_add_u32 v32, 256, v1
    v_mul_u32_u24 v33, 6554, v32
    v_lshrrev_b32 v33, 16, v33
    v_mul_u32_u24 v34, 10, v33
    v_sub_u32 v34, v32, v34
    v_and_b32 v35, 3, v33
    v_lshrrev_b32 v36, 4, v33
    v_lshl_add_u32 v35, v36, 2, v35
    v_bfe_u32 v36, v33, 2, 2
    v_lshl_add_u32 v35, v36, 3, v35
    v_mul_u32_u24 v35, 3840, v35
    v_lshl_add_u32 v35, v34, 4, v35
    v_add_u32 v44, 1280, v35
    s_mul_i32 s62, s45, 160
    s_mul_i32 s60, s61, 245760
    s_add_u32 s62, s62, s60
    s_mul_i32 s63, s61, 10240
    s_mov_b32 s65, 122880
    s_mov_b32 s66, 368640
    s_mov_b32 s67, 20480
    s_branch L_p0_go
L_p0_q:
    v_add_u32 v32, 0, v1
    v_mul_u32_u24 v33, 13108, v32
    v_lshrrev_b32 v33, 16, v33
    v_mul_u32_u24 v34, 5, v33
    v_sub_u32 v34, v32, v34
    v_and_b32 v35, 40, v33
    v_bfe_u32 v36, v33, 4, 1
    v_lshl_add_u32 v35, v36, 2, v35
    v_bfe_u32 v36, v33, 1, 2
    v_add_u32 v35, v35, v36
    v_and_b32 v36, 1, v33
    v_lshl_add_u32 v35, v36, 4, v35
    v_mul_u32_u24 v35, 3840, v35
    v_lshl_add_u32 v35, v34, 4, v35
    v_add_u32 v40, 0, v35
    v_add_u32 v32, 64, v1
    v_mul_u32_u24 v33, 13108, v32
    v_lshrrev_b32 v33, 16, v33
    v_mul_u32_u24 v34, 5, v33
    v_sub_u32 v34, v32, v34
    v_and_b32 v35, 40, v33
    v_bfe_u32 v36, v33, 4, 1
    v_lshl_add_u32 v35, v36, 2, v35
    v_bfe_u32 v36, v33, 1, 2
    v_add_u32 v35, v35, v36
    v_and_b32 v36, 1, v33
    v_lshl_add_u32 v35, v36, 4, v35
    v_mul_u32_u24 v35, 3840, v35
    v_lshl_add_u32 v35, v34, 4, v35
    v_subrev_u32 v41, 1024, v35
    v_add_u32 v32, 128, v1
    v_mul_u32_u24 v33, 13108, v32
    v_lshrrev_b32 v33, 16, v33
    v_mul_u32_u24 v34, 5, v33
    v_sub_u32 v34, v32, v34
    v_and_b32 v35, 40, v33
    v_bfe_u32 v36, v33, 4, 1
    v_lshl_add_u32 v35, v36, 2, v35
    v_bfe_u32 v36, v33, 1, 2
    v_add_u32 v35, v35, v36
    v_and_b32 v36, 1, v33
    v_lshl_add_u32 v35, v36, 4, v35
    v_mul_u32_u24 v35, 3840, v35
    v_lshl_add_u32 v35, v34, 4, v35
    v_subrev_u32 v42, 2048, v35
    v_add_u32 v32, 192, v1
    v_mul_u32_u24 v33, 13108, v32
    v_lshrrev_b32 v33, 16, v33
    v_mul_u32_u24 v34, 5, v33
    v_sub_u32 v34, v32, v34
    v_and_b32 v35, 40, v33
    v_bfe_u32 v36, v33, 4, 1
    v_lshl_add_u32 v35, v36, 2, v35
    v_bfe_u32 v36, v33, 1, 2
    v_add_u32 v35, v35, v36
    v_and_b32 v36, 1, v33
    v_lshl_add_u32 v35, v36, 4, v35
    v_mul_u32_u24 v35, 3840, v35
    v_lshl_add_u32 v35, v34, 4, v35
    v_subrev_u32 v43, 3072, v35
    v_add_u32 v32, 256, v1
    v_mul_u32_u24 v33, 13108, v32
    v_lshrrev_b32 v33, 16, v33
    v_mul_u32_u24 v34, 5, v33
    v_sub_u32 v34, v32, v34
    v_and_b32 v35, 40, v33
    v_bfe_u32 v36, v33, 4, 1
    v_lshl_add_u32 v35, v36, 2, v35
    v_bfe_u32 v36, v33, 1, 2
    v_add_u32 v35, v35, v36
    v_and_b32 v36, 1, v33
    v_lshl_add_u32 v35, v36, 4, v35
    v_mul_u32_u24 v35, 3840, v35
    v_lshl_add_u32 v35, v34, 4, v35
    v_add_u32 v44, 0, v35
    s_mul_i32 s62, s45, 80
    s_mov_b32 s63, 102400
    s_mov_b32 s65, 245760
    s_mov_b32 s66, 245760
    s_mov_b32 s67, 10240
L_p0_go:
    s_mul_i32 s69, s44, 3
    s_mul_i32 s60, s69, 52
    s_lshr_b32 s60, s60, 8
    s_mul_i32 s60, s60, 5
    s_sub_u32 s69, s69, s60
    s_mul_i32 s60, s69, 491520
    s_add_u32 s62, s62, s60
    s_mul_i32 s60, s69, s67
    s_add_u32 s63, s63, s60
    s_mul_i32 s70, s67, 5
    s_add_u32 m0, s63, 0
    s_nop 0
    buffer_load_dwordx4 v40, s[32:35], s62 offen offset:0  lds
    buffer_load_dwordx4 v41, s[32:35], s62 offen offset:1024  lds
    buffer_load_dwordx4 v42, s[32:35], s62 offen offset:2048  lds
    buffer_load_dwordx4 v43, s[32:35], s62 offen offset:3072  lds
    s_add_u32 m0, s63, 4096
    s_nop 0
    buffer_load_dwordx4 v44, s[32:35], s62 offen offset:0  lds
    s_add_u32 s62, s62, s65
    s_add_u32 m0, s63, 5120
    s_nop 0
    buffer_load_dwordx4 v40, s[32:35], s62 offen offset:0  lds
    buffer_load_dwordx4 v41, s[32:35], s62 offen offset:1024  lds
    buffer_load_dwordx4 v42, s[32:35], s62 offen offset:2048  lds
    buffer_load_dwordx4 v43, s[32:35], s62 offen offset:3072  lds
    s_add_u32 m0, s63, 9216
    s_nop 0
    buffer_load_dwordx4 v44, s[32:35], s62 offen offset:0  lds
    s_add_u32 s62, s62, s66
    s_add_u32 s63, s63, s67
    s_add_u32 s69, s69, 1
    s_cmp_eq_u32 s69, 5
    s_cselect_b32 s60, 2457600, 0
    s_cselect_b32 s61, s70, 0
    s_sub_u32 s62, s62, s60
    s_sub_u32 s63, s63, s61
    s_add_u32 m0, s63, 0
    s_nop 0
    buffer_load_dwordx4 v40, s[32:35], s62 offen offset:0  lds
    buffer_load_dwordx4 v41, s[32:35], s62 offen offset:1024  lds
    buffer_load_dwordx4 v42, s[32:35], s62 offen offset:2048  lds
    buffer_load_dwordx4 v43, s[32:35], s62 offen offset:3072  lds
    s_add_u32 m0, s63, 4096
    s_nop 0
    buffer_load_dwordx4 v44, s[32:35], s62 offen offset:0  lds
    s_add_u32 s62, s62, s65
    s_add_u32 m0, s63, 5120
    s_nop 0
    buffer_load_dwordx4 v40, s[32:35], s62 offen offset:0  lds
    buffer_load_dwordx4 v41, s[32:35], s62 offen offset:1024  lds
    buffer_load_dwordx4 v42, s[32:35], s62 offen offset:2048  lds
    buffer_load_dwordx4 v43, s[32:35], s62 offen offset:3072  lds
    s_add_u32 m0, s63, 9216
    s_nop 0
    buffer_load_dwordx4 v44, s[32:35], s62 offen offset:0  lds
    s_add_u32 s62, s62, s66
    s_add_u32 s63, s63, s67
    s_add_u32 s69, s69, 1
    s_cmp_eq_u32 s69, 5
    s_cselect_b32 s60, 2457600, 0
    s_cselect_b32 s61, s70, 0
    s_sub_u32 s62, s62, s60
    s_sub_u32 s63, s63, s61
    s_add_u32 m0, s63, 0
    s_nop 0
    buffer_load_dwordx4 v40, s[32:35], s62 offen offset:0  lds
    buffer_load_dwordx4 v41, s[32:35], s62 offen offset:1024  lds
    buffer_load_dwordx4 v42, s[32:35], s62 offen offset:2048  lds
    buffer_load_dwordx4 v43, s[32:35], s62 offen offset:3072  lds
    s_add_u32 m0, s63, 4096
    s_nop 0
    buffer_load_dwordx4 v44, s[32:35], s62 offen offset:0  lds
    s_add_u32 s62, s62, s65
    s_add_u32 m0, s63, 5120
    s_nop 0
    buffer_load_dwordx4 v40, s[32:35], s62 offen offset:0  lds
    buffer_load_dwordx4 v41, s[32:35], s62 offen offset:1024  lds
    buffer_load_dwordx4 v42, s[32:35], s62 offen offset:2048  lds
    buffer_load_dwordx4 v43, s[32:35], s62 offen offset:3072  lds
    s_add_u32 m0, s63, 9216
    s_nop 0
    buffer_load_dwordx4 v44, s[32:35], s62 offen offset:0  lds
    s_add_u32 s62, s62, s66
    s_add_u32 s63, s63, s67
    s_add_u32 s69, s69, 1
    s_cmp_eq_u32 s69, 5
    s_cselect_b32 s60, 2457600, 0
    s_cselect_b32 s61, s70, 0
    s_sub_u32 s62, s62, s60
    s_sub_u32 s63, s63, s61
    s_add_u32 m0, s63, 0
    s_nop 0
    buffer_load_dwordx4 v40, s[32:35], s62 offen offset:0  lds
    buffer_load_dwordx4 v41, s[32:35], s62 offen offset:1024  lds
    buffer_load_dwordx4 v42, s[32:35], s62 offen offset:2048  lds
    buffer_load_dwordx4 v43, s[32:35], s62 offen offset:3072  lds
    s_add_u32 m0, s63, 4096
    s_nop 0
    buffer_load_dwordx4 v44, s[32:35], s62 offen offset:0  lds
    s_add_u32 s62, s62, s65
    s_add_u32 m0, s63, 5120
    s_nop 0
    buffer_load_dwordx4 v40, s[32:35], s62 offen offset:0  lds
    buffer_load_dwordx4 v41, s[32:35], s62 offen offset:1024  lds
    buffer_load_dwordx4 v42, s[32:35], s62 offen offset:2048  lds
    buffer_load_dwordx4 v43, s[32:35], s62 offen offset:3072  lds
    s_add_u32 m0, s63, 9216
    s_nop 0
    buffer_load_dwordx4 v44, s[32:35], s62 offen offset:0  lds
    s_add_u32 s62, s62, s66
    s_add_u32 s63, s63, s67
    s_add_u32 s69, s69, 1
    s_cmp_eq_u32 s69, 5
    s_cselect_b32 s60, 2457600, 0
    s_cselect_b32 s61, s70, 0
    s_sub_u32 s62, s62, s60
    s_sub_u32 s63, s63, s61
    s_add_u32 m0, s63, 0
    s_nop 0
    buffer_load_dwordx4 v40, s[32:35], s62 offen offset:0  lds
    buffer_load_dwordx4 v41, s[32:35], s62 offen offset:1024  lds
    buffer_load_dwordx4 v42, s[32:35], s62 offen offset:2048  lds
    buffer_load_dwordx4 v43, s[32:35], s62 offen offset:3072  lds
    s_add_u32 m0, s63, 4096
    s_nop 0
    buffer_load_dwordx4 v44, s[32:35], s62 offen offset:0  lds
    s_add_u32 s62, s62, s65
    s_add_u32 m0, s63, 5120
    s_nop 0
    buffer_load_dwordx4 v40, s[32:35], s62 offen offset:0  lds
    buffer_load_dwordx4 v41, s[32:35], s62 offen offset:1024  lds
    buffer_load_dwordx4 v42, s[32:35], s62 offen offset:2048  lds
    buffer_load_dwordx4 v43, s[32:35], s62 offen offset:3072  lds
    s_add_u32 m0, s63, 9216
    s_nop 0
    buffer_load_dwordx4 v44, s[32:35], s62 offen offset:0  lds
    s_add_u32 s62, s62, s66
    s_add_u32 s63, s63, s67
    s_waitcnt lgkmcnt(0)
    s_mul_i32 s47, s48, 1664525
    s_add_u32 s47, s47, 1013904223
    s_bfe_u32 s40, s47, 524288
    s_bfe_u32 s41, s47, 524296
    s_bfe_u32 s42, s47, 524304
    s_bfe_u32 s43, s47, 524312
    s_sub_u32 s84, s46, 1
    s_lshl_b32 s84, s84, 8
    s_add_u32 s84, s84, s2
    s_and_b32 s85, s84, 1
    s_lshr_b32 s86, s84, 1
    s_and_b32 s87, s86, 15
    s_lshr_b32 s86, s86, 4
    s_cmp_eq_u32 s85, 0
    s_cselect_b32 s96, s12, s14
    s_cselect_b32 s97, s13, s15
    s_mov_b32 s98, 1966080
    s_mov_b32 s99, 0x20000
    s_mul_i32 s88, s86, 98304
    s_mul_i32 s89, s87, 192
    s_add_u32 s88, s88, s89
    s_mul_i32 s89, s87, 245760
    s_mul_i32 s90, s86, 6144
    s_add_u32 s89, s89, s90
    s_mul_i32 s90, s85, 3072
    s_add_u32 s89, s89, s90
    s_add_u32 s89, s89, 28311552
    s_mul_i32 s90, s87, 20
    s_add_u32 s90, s90, s86
    s_lshl_b32 s90, s90, 1
    s_add_u32 s90, s90, s85
    s_lshl_b32 s90, s90, 2
    s_sub_u32 s91, s84, 128
    s_cmp_lt_u32 s84, 512
    s_cselect_b32 s91, s84, s91
    s_cmp_lt_u32 s84, 640
    s_cselect_b32 s92, 1, 0
    s_cmp_lt_u32 s84, 512
    s_cselect_b32 s93, 1, 0
    s_sub_u32 s94, s84, 640
    s_cmp_lt_u32 s94, 32
    s_cselect_b32 s93, 1, s93
    s_cmp_lt_u32 s91, 160
    s_cselect_b32 s36, s8, s16
    s_cselect_b32 s37, s9, s17
    s_mov_b32 s38, 819200
    s_cselect_b32 s38, s38, 1966080
    s_mov_b32 s39, 0x20000
    s_cselect_b32 s94, 0, 160
    s_cselect_b64 s[58:59], -1, 0
    s_mov_b64 s[66:67], s[58:59]
    s_cselect_b32 s95, 20, 48
    s_mov_b32 s68, 25165824
    s_cselect_b32 s68, s68, 26214400
    s_mov_b32 s69, 4096
    s_cselect_b32 s69, s69, 8192
    s_sub_u32 s91, s91, s94
    s_and_b32 s94, s91, 7
    s_lshr_b32 s91, s91, 3
    s_mul_i32 s95, s95, s94
    s_add_u32 s95, s95, s91
    s_mul_i32 s91, s91, 40960
    s_mul_i32 s94, s94, 160
    s_add_u32 s91, s91, s94
    s_mul_i32 s94, s95, 5120
    s_add_u32 s94, s94, s68
    s_lshl_b32 s95, s95, 2
    s_add_u32 s95, s95, s69
    s_cmp_eq_u32 s92, 0
    s_cselect_b32 s88, 1073741824, s88
    s_cselect_b32 s89, 1073741824, s89
    s_cselect_b32 s90, 1073741824, s90
    s_cmp_eq_u32 s93, 0
    s_cselect_b32 s91, 1073741824, s91
    s_cselect_b32 s94, 1073741824, s94
    s_cselect_b32 s95, 1073741824, s95
    s_add_u32 s92, s89, 122880
    s_add_u32 s93, s94, 4096
    v_add_u32 v32, 0, v1
    v_mul_u32_u24 v33, 6554, v32
    v_lshrrev_b32 v33, 16, v33
    v_mul_u32_u24 v34, 10, v33
    v_sub_u32 v34, v32, v34
    v_and_b32 v35, 3, v33
    v_lshrrev_b32 v36, 4, v33
    v_lshl_add_u32 v35, v36, 2, v35
    v_bfe_u32 v36, v33, 2, 2
    v_lshl_add_u32 v35, v36, 3, v35
    v_cndmask_b32 v35, v33, v35, s[66:67]
    v_mul_u32_u24 v35, 1280, v35
    v_lshl_add_u32 v250, v34, 4, v35
    v_add_u32 v32, 64, v1
    v_mul_u32_u24 v33, 6554, v32
    v_lshrrev_b32 v33, 16, v33
    v_mul_u32_u24 v34, 10, v33
    v_sub_u32 v34, v32, v34
    v_and_b32 v35, 3, v33
    v_lshrrev_b32 v36, 4, v33
    v_lshl_add_u32 v35, v36, 2, v35
    v_bfe_u32 v36, v33, 2, 2
    v_lshl_add_u32 v35, v36, 3, v35
    v_cndmask_b32 v35, v33, v35, s[66:67]
    v_mul_u32_u24 v35, 1280, v35
    v_lshl_add_u32 v251, v34, 4, v35
    v_add_u32 v32, 128, v1
    v_mul_u32_u24 v33, 6554, v32
    v_lshrrev_b32 v33, 16, v33
    v_mul_u32_u24 v34, 10, v33
    v_sub_u32 v34, v32, v34
    v_and_b32 v35, 3, v33
    v_lshrrev_b32 v36, 4, v33
    v_lshl_add_u32 v35, v36, 2, v35
    v_bfe_u32 v36, v33, 2, 2
    v_lshl_add_u32 v35, v36, 3, v35
    v_cndmask_b32 v35, v33, v35, s[66:67]
    v_mul_u32_u24 v35, 1280, v35
    v_lshl_add_u32 v252, v34, 4, v35
    v_add_u32 v32, 192, v1
    v_mul_u32_u24 v33, 6554, v32
    v_lshrrev_b32 v33, 16, v33
    v_mul_u32_u24 v34, 10, v33
    v_sub_u32 v34, v32, v34
    v_and_b32 v35, 3, v33
    v_lshrrev_b32 v36, 4, v33
    v_lshl_add_u32 v35, v36, 2, v35
    v_bfe_u32 v36, v33, 2, 2
    v_lshl_add_u32 v35, v36, 3, v35
    v_cndmask_b32 v35, v33, v35, s[66:67]
    v_mul_u32_u24 v35, 1280, v35
    v_lshl_add_u32 v253, v34, 4, v35
    v_add_u32 v32, 256, v1
    v_mul_u32_u24 v33, 6554, v32
    v_lshrrev_b32 v33, 16, v33
    v_mul_u32_u24 v34, 10, v33
    v_sub_u32 v34, v32, v34
    v_and_b32 v35, 3, v33
    v_lshrrev_b32 v36, 4, v33
    v_lshl_add_u32 v35, v36, 2, v35
    v_bfe_u32 v36, v33, 2, 2
    v_lshl_add_u32 v35, v36, 3, v35
    v_cndmask_b32 v35, v33, v35, s[66:67]
    v_mul_u32_u24 v35, 1280, v35
    v_lshl_add_u32 v254, v34, 4, v35
    v_add_u32 v32, 0, v1
    v_mul_u32_u24 v33, 10923, v32
    v_lshrrev_b32 v33, 16, v33
    v_mul_u32_u24 v34, 6, v33
    v_sub_u32 v34, v32, v34
    v_and_b32 v35, 3, v33
    v_lshrrev_b32 v36, 4, v33
    v_lshl_add_u32 v35, v36, 2, v35
    v_bfe_u32 v36, v33, 2, 2
    v_lshl_add_u32 v35, v36, 3, v35
    v_mul_u32_u24 v35, 3072, v35
    v_lshl_add_u32 v37, v34, 4, v35
    v_add_u32 v32, 64, v1
    v_mul_u32_u24 v33, 10923, v32
    v_lshrrev_b32 v33, 16, v33
    v_mul_u32_u24 v34, 6, v33
    v_sub_u32 v34, v32, v34
    v_and_b32 v35, 3, v33
    v_lshrrev_b32 v36, 4, v33
    v_lshl_add_u32 v35, v36, 2, v35
    v_bfe_u32 v36, v33, 2, 2
    v_lshl_add_u32 v35, v36, 3, v35
    v_mul_u32_u24 v35, 3072, v35
    v_lshl_add_u32 v38, v34, 4, v35
    v_add_u32 v32, 128, v1
    v_mul_u32_u24 v33, 10923, v32
    v_lshrrev_b32 v33, 16, v33
    v_mul_u32_u24 v34, 6, v33
    v_sub_u32 v34, v32, v34
    v_and_b32 v35, 3, v33
    v_lshrrev_b32 v36, 4, v33
    v_lshl_add_u32 v35, v36, 2, v35
    v_bfe_u32 v36, v33, 2, 2
    v_lshl_add_u32 v35, v36, 3, v35
    v_mul_u32_u24 v35, 3072, v35
    v_lshl_add_u32 v39, v34, 4, v35
    buffer_load_dwordx4 v[160:163], v37, s[96:99], s88 offen offset:0 nt
    buffer_load_dwordx4 v[164:167], v38, s[96:99], s88 offen offset:0 nt
    buffer_load_dwordx4 v[168:171], v39, s[96:99], s88 offen offset:0 nt
    buffer_load_dwordx4 v[172:175], v37, s[96:99], s88 offen offset:96 nt
    buffer_load_dwordx4 v[176:179], v38, s[96:99], s88 offen offset:96 nt
    buffer_load_dwordx4 v[180:183], v39, s[96:99], s88 offen offset:96 nt
    buffer_load_dwordx4 v[184:187], v250, s[36:39], s91 offen nt
    buffer_load_dwordx4 v[188:191], v251, s[36:39], s91 offen nt
    buffer_load_dwordx4 v[192:195], v252, s[36:39], s91 offen nt
    buffer_load_dwordx4 v[196:199], v253, s[36:39], s91 offen nt
    buffer_load_dwordx4 v[200:203], v254, s[36:39], s91 offen nt
    s_waitcnt vmcnt(11)
L_p0_join:
    s_lshl_b32 s74, s44, 2
    s_add_u32 s74, s74, s46
    s_mul_i32 s74, s74, 40960
    s_add_u32 s74, s74, 1048576
    s_add_u32 s75, s74, 20480
    s_barrier
    s_cmp_lg_u32 s46, 1
    s_cbranch_scc1 Lct9
    s_getpc_b64 s[58:59]
Lpc10:
    s_add_u32 s58, s58, L_c2-Lpc10
    s_addc_u32 s59, s59, 0
    s_lshr_b32 s100, s2, 3
    v_lshl_add_u32 v204, v1, 5, s100
    v_lshlrev_b32 v204, 7, v204
    v_min_u32 v204, L_last-L_c2, v204
    s_mov_b64 exec, 15
    global_load_dword v205, v204, s[58:59]
    s_mov_b64 exec, -1
Lct9:
    v_mov_b32 v3, 161792
    ds_read_b32 v4, v3
    s_waitcnt lgkmcnt(0)
    v_readfirstlane_b32 s55, v4
    s_nop 0
    s_cmp_eq_u32 s55, 0
    s_cbranch_scc1 Lacq11
Lacqj12:
    buffer_load_dwordx4 a[0:3], v2, s[28:31], s74 offen offset:0 sc1
    buffer_load_dwordx4 a[80:83], v2, s[28:31], s75 offen offset:0 sc1
    buffer_load_dwordx4 a[4:7], v2, s[28:31], s74 offen offset:1024 sc1
    buffer_load_dwordx4 a[84:87], v2, s[28:31], s75 offen offset:1024 sc1
    buffer_load_dwordx4 a[8:11], v2, s[28:31], s74 offen offset:2048 sc1
    buffer_load_dwordx4 a[88:91], v2, s[28:31], s75 offen offset:2048 sc1
    ds_read_b64_tr_b16 v[80:81], v5 offset:0
    ds_read_b64_tr_b16 v[82:83], v5 offset:2560
    ds_read_b64_tr_b16 v[84:85], v5 offset:32
    ds_read_b64_tr_b16 v[86:87], v5 offset:2592
    ds_read_b64_tr_b16 v[88:89], v5 offset:64
    ds_read_b64_tr_b16 v[90:91], v5 offset:2624
    ds_read_b64_tr_b16 v[92:93], v5 offset:96
    ds_read_b64_tr_b16 v[94:95], v5 offset:2656
    ds_read_b64_tr_b16 v[96:97], v5 offset:128
    ds_read_b64_tr_b16 v[98:99], v5 offset:2688
    s_waitcnt vmcnt(4) lgkmcnt(4)
    v_mfma_f32_16x16x32_bf16 v[40:43], v[80:83], a[0:3], 0
    ds_read_b64_tr_b16 v[100:101], v5 offset:5120
    v_mfma_f32_16x16x32_bf16 v[60:63], v[80:83], a[80:83], 0
    ds_read_b64_tr_b16 v[102:103], v5 offset:7680
    buffer_load_dwordx4 a[12:15], v2, s[28:31], s74 offen offset:3072 sc1
    s_add_u32 s74, s74, 4096
    v_mfma_f32_16x16x32_bf16 v[44:47], v[84:87], a[0:3], 0
    ds_read_b64_tr_b16 v[104:105], v5 offset:5152
    v_mfma_f32_16x16x32_bf16 v[64:67], v[84:87], a[80:83], 0
    ds_read_b64_tr_b16 v[106:107], v5 offset:7712
    v_mfma_f32_16x16x32_bf16 v[48:51], v[88:91], a[0:3], 0
    ds_read_b64_tr_b16 v[108:109], v5 offset:5184
    v_mfma_f32_16x16x32_bf16 v[68:71], v[88:91], a[80:83], 0
    ds_read_b64_tr_b16 v[110:111], v5 offset:7744
    s_waitcnt lgkmcnt(6)
    v_mfma_f32_16x16x32_bf16 v[52:55], v[92:95], a[0:3], 0
    ds_read_b64_tr_b16 v[112:113], v5 offset:5216
    buffer_load_dwordx4 a[92:95], v2, s[28:31], s75 offen offset:3072 sc1
    s_add_u32 s75, s75, 4096
    v_mfma_f32_16x16x32_bf16 v[72:75], v[92:95], a[80:83], 0
    ds_read_b64_tr_b16 v[114:115], v5 offset:7776
    v_mfma_f32_16x16x32_bf16 v[56:59], v[96:99], a[0:3], 0
    ds_read_b64_tr_b16 v[116:117], v5 offset:5248
    v_mfma_f32_16x16x32_bf16 v[76:79], v[96:99], a[80:83], 0
    ds_read_b64_tr_b16 v[118:119], v5 offset:7808
    s_waitcnt vmcnt(4) lgkmcnt(4)
    v_mfma_f32_16x16x32_bf16 v[40:43], v[100:103], a[4:7], v[40:43]
    ds_read_b64_tr_b16 v[80:81], v5 offset:10240
    v_mfma_f32_16x16x32_bf16 v[60:63], v[100:103], a[84:87], v[60:63]
    ds_read_b64_tr_b16 v[82:83], v5 offset:12800
    buffer_load_dwordx4 a[16:19], v2, s[28:31], s74 offen offset:0 sc1
    v_mfma_f32_16x16x32_bf16 v[44:47], v[104:107], a[4:7], v[44:47]
    ds_read_b64_tr_b16 v[84:85], v5 offset:10272
    v_mfma_f32_16x16x32_bf16 v[64:67], v[104:107], a[84:87], v[64:67]
    ds_read_b64_tr_b16 v[86:87], v5 offset:12832
    v_mfma_f32_16x16x32_bf16 v[48:51], v[108:111], a[4:7], v[48:51]
    ds_read_b64_tr_b16 v[88:89], v5 offset:10304
    v_mfma_f32_16x16x32_bf16 v[68:71], v[108:111], a[84:87], v[68:71]
    ds_read_b64_tr_b16 v[90:91], v5 offset:12864
    s_waitcnt lgkmcnt(6)
    v_mfma_f32_16x16x32_bf16 v[52:55], v[112:115], a[4:7], v[52:55]
    ds_read_b64_tr_b16 v[92:93], v5 offset:10336
    buffer_load_dwordx4 a[96:99], v2, s[28:31], s75 offen offset:0 sc1
    v_mfma_f32_16x16x32_bf16 v[72:75], v[112:115], a[84:87], v[72:75]
    ds_read_b64_tr_b16 v[94:95], v5 offset:12896
    v_mfma_f32_16x16x32_bf16 v[56:59], v[116:119], a[4:7], v[56:59]
    ds_read_b64_tr_b16 v[96:97], v5 offset:10368
    v_mfma_f32_16x16x32_bf16 v[76:79], v[116:119], a[84:87], v[76:79]
    ds_read_b64_tr_b16 v[98:99], v5 offset:12928
    s_waitcnt vmcnt(4) lgkmcnt(4)
    v_mfma_f32_16x16x32_bf16 v[40:43], v[80:83], a[8:11], v[40:43]
    ds_read_b64_tr_b16 v[100:101], v5 offset:15360
    v_mfma_f32_16x16x32_bf16 v[60:63], v[80:83], a[88:91], v[60:63]
    ds_read_b64_tr_b16 v[102:103], v5 offset:17920
    buffer_load_dwordx4 a[20:23], v2, s[28:31], s74 offen offset:1024 sc1
    v_mfma_f32_16x16x32_bf16 v[44:47], v[84:87], a[8:11], v[44:47]
    ds_read_b64_tr_b16 v[104:105], v5 offset:15392
    v_mfma_f32_16x16x32_bf16 v[64:67], v[84:87], a[88:91], v[64:67]
    ds_read_b64_tr_b16 v[106:107], v5 offset:17952
    v_mfma_f32_16x16x32_bf16 v[48:51], v[88:91], a[8:11], v[48:51]
    ds_read_b64_tr_b16 v[108:109], v5 offset:15424
    v_mfma_f32_16x16x32_bf16 v[68:71], v[88:91], a[88:91], v[68:71]
    ds_read_b64_tr_b16 v[110:111], v5 offset:17984
    s_waitcnt lgkmcnt(6)
    v_mfma_f32_16x16x32_bf16 v[52:55], v[92:95], a[8:11], v[52:55]
    ds_read_b64_tr_b16 v[112:113], v5 offset:15456
    buffer_load_dwordx4 a[100:103], v2, s[28:31], s75 offen offset:1024 sc1
    v_mfma_f32_16x16x32_bf16 v[72:75], v[92:95], a[88:91], v[72:75]
    ds_read_b64_tr_b16 v[114:115], v5 offset:18016
    v_mfma_f32_16x16x32_bf16 v[56:59], v[96:99], a[8:11], v[56:59]
    ds_read_b64_tr_b16 v[116:117], v5 offset:15488
    v_mfma_f32_16x16x32_bf16 v[76:79], v[96:99], a[88:91], v[76:79]
    ds_read_b64_tr_b16 v[118:119], v5 offset:18048
    s_waitcnt vmcnt(4) lgkmcnt(4)
    v_mfma_f32_16x16x32_bf16 v[40:43], v[100:103], a[12:15], v[40:43]
    ds_read_b64_tr_b16 v[80:81], v5 offset:20480
    v_mfma_f32_16x16x32_bf16 v[60:63], v[100:103], a[92:95], v[60:63]
    ds_read_b64_tr_b16 v[82:83], v5 offset:23040
    buffer_load_dwordx4 a[24:27], v2, s[28:31], s74 offen offset:2048 sc1
    v_mfma_f32_16x16x32_bf16 v[44:47], v[104:107], a[12:15], v[44:47]
    ds_read_b64_tr_b16 v[84:85], v5 offset:20512
    v_mfma_f32_16x16x32_bf16 v[64:67], v[104:107], a[92:95], v[64:67]
    ds_read_b64_tr_b16 v[86:87], v5 offset:23072
    v_mfma_f32_16x16x32_bf16 v[48:51], v[108:111], a[12:15], v[48:51]
    ds_read_b64_tr_b16 v[88:89], v5 offset:20544
    v_mfma_f32_16x16x32_bf16 v[68:71], v[108:111], a[92:95], v[68:71]
    ds_read_b64_tr_b16 v[90:91], v5 offset:23104
    s_waitcnt lgkmcnt(6)
    v_mfma_f32_16x16x32_bf16 v[52:55], v[112:115], a[12:15], v[52:55]
    ds_read_b64_tr_b16 v[92:93], v5 offset:20576
    buffer_load_dwordx4 a[104:107], v2, s[28:31], s75 offen offset:2048 sc1
    v_mfma_f32_16x16x32_bf16 v[72:75], v[112:115], a[92:95], v[72:75]
    ds_read_b64_tr_b16 v[94:95], v5 offset:23136
    v_mfma_f32_16x16x32_bf16 v[56:59], v[116:119], a[12:15], v[56:59]
    ds_read_b64_tr_b16 v[96:97], v5 offset:20608
    v_mfma_f32_16x16x32_bf16 v[76:79], v[116:119], a[92:95], v[76:79]
    ds_read_b64_tr_b16 v[98:99], v5 offset:23168
    s_waitcnt vmcnt(4) lgkmcnt(4)
    v_mfma_f32_16x16x32_bf16 v[40:43], v[80:83], a[16:19], v[40:43]
    ds_read_b64_tr_b16 v[100:101], v5 offset:25600
    v_mfma_f32_16x16x32_bf16 v[60:63], v[80:83], a[96:99], v[60:63]
    ds_read_b64_tr_b16 v[102:103], v5 offset:28160
    buffer_load_dwordx4 a[28:31], v2, s[28:31], s74 offen offset:3072 sc1
    s_add_u32 s74, s74, 4096
    v_mfma_f32_16x16x32_bf16 v[44:47], v[84:87], a[16:19], v[44:47]
    ds_read_b64_tr_b16 v[104:105], v5 offset:25632
    v_mfma_f32_16x16x32_bf16 v[64:67], v[84:87], a[96:99], v[64:67]
    ds_read_b64_tr_b16 v[106:107], v5 offset:28192
    v_mfma_f32_16x16x32_bf16 v[48:51], v[88:91], a[16:19], v[48:51]
    ds_read_b64_tr_b16 v[108:109], v5 offset:25664
    v_mfma_f32_16x16x32_bf16 v[68:71], v[88:91], a[96:99], v[68:71]
    ds_read_b64_tr_b16 v[110:111], v5 offset:28224
    s_waitcnt lgkmcnt(6)
    v_mfma_f32_16x16x32_bf16 v[52:55], v[92:95], a[16:19], v[52:55]
    ds_read_b64_tr_b16 v[112:113], v5 offset:25696
    buffer_load_dwordx4 a[108:111], v2, s[28:31], s75 offen offset:3072 sc1
    s_add_u32 s75, s75, 4096
    v_mfma_f32_16x16x32_bf16 v[72:75], v[92:95], a[96:99], v[72:75]
    ds_read_b64_tr_b16 v[114:115], v5 offset:28256
    v_mfma_f32_16x16x32_bf16 v[56:59], v[96:99], a[16:19], v[56:59]
    ds_read_b64_tr_b16 v[116:117], v5 offset:25728
    v_mfma_f32_16x16x32_bf16 v[76:79], v[96:99], a[96:99], v[76:79]
    ds_read_b64_tr_b16 v[118:119], v5 offset:28288
    s_waitcnt vmcnt(4) lgkmcnt(4)
    v_mfma_f32_16x16x32_bf16 v[40:43], v[100:103], a[20:23], v[40:43]
    ds_read_b64_tr_b16 v[80:81], v5 offset:30720
    v_mfma_f32_16x16x32_bf16 v[60:63], v[100:103], a[100:103], v[60:63]
    ds_read_b64_tr_b16 v[82:83], v5 offset:33280
    buffer_load_dwordx4 a[32:35], v2, s[28:31], s74 offen offset:0 sc1
    v_mfma_f32_16x16x32_bf16 v[44:47], v[104:107], a[20:23], v[44:47]
    ds_read_b64_tr_b16 v[84:85], v5 offset:30752
    v_mfma_f32_16x16x32_bf16 v[64:67], v[104:107], a[100:103], v[64:67]
    ds_read_b64_tr_b16 v[86:87], v5 offset:33312
    v_mfma_f32_16x16x32_bf16 v[48:51], v[108:111], a[20:23], v[48:51]
    ds_read_b64_tr_b16 v[88:89], v5 offset:30784
    v_mfma_f32_16x16x32_bf16 v[68:71], v[108:111], a[100:103], v[68:71]
    ds_read_b64_tr_b16 v[90:91], v5 offset:33344
    s_waitcnt lgkmcnt(6)
    v_mfma_f32_16x16x32_bf16 v[52:55], v[112:115], a[20:23], v[52:55]
    ds_read_b64_tr_b16 v[92:93], v5 offset:30816
    buffer_load_dwordx4 a[112:115], v2, s[28:31], s75 offen offset:0 sc1
    v_mfma_f32_16x16x32_bf16 v[72:75], v[112:115], a[100:103], v[72:75]
    ds_read_b64_tr_b16 v[94:95], v5 offset:33376
    v_mfma_f32_16x16x32_bf16 v[56:59], v[116:119], a[20:23], v[56:59]
    ds_read_b64_tr_b16 v[96:97], v5 offset:30848
    v_mfma_f32_16x16x32_bf16 v[76:79], v[116:119], a[100:103], v[76:79]
    ds_read_b64_tr_b16 v[98:99], v5 offset:33408
    s_waitcnt vmcnt(4) lgkmcnt(4)
    v_mfma_f32_16x16x32_bf16 v[40:43], v[80:83], a[24:27], v[40:43]
    ds_read_b64_tr_b16 v[100:101], v5 offset:35840
    v_mfma_f32_16x16x32_bf16 v[60:63], v[80:83], a[104:107], v[60:63]
    ds_read_b64_tr_b16 v[102:103], v5 offset:38400
    buffer_load_dwordx4 a[36:39], v2, s[28:31], s74 offen offset:1024 sc1
    v_mfma_f32_16x16x32_bf16 v[44:47], v[84:87], a[24:27], v[44:47]
    ds_read_b64_tr_b16 v[104:105], v5 offset:35872
    v_mfma_f32_16x16x32_bf16 v[64:67], v[84:87], a[104:107], v[64:67]
    ds_read_b64_tr_b16 v[106:107], v5 offset:38432
    v_mfma_f32_16x16x32_bf16 v[48:51], v[88:91], a[24:27], v[48:51]
    ds_read_b64_tr_b16 v[108:109], v5 offset:35904
    v_mfma_f32_16x16x32_bf16 v[68:71], v[88:91], a[104:107], v[68:71]
    ds_read_b64_tr_b16 v[110:111], v5 offset:38464
    s_waitcnt lgkmcnt(6)
    v_mfma_f32_16x16x32_bf16 v[52:55], v[92:95], a[24:27], v[52:55]
    ds_read_b64_tr_b16 v[112:113], v5 offset:35936
    buffer_load_dwordx4 a[116:119], v2, s[28:31], s75 offen offset:1024 sc1
    v_mfma_f32_16x16x32_bf16 v[72:75], v[92:95], a[104:107], v[72:75]
    ds_read_b64_tr_b16 v[114:115], v5 offset:38496
    v_mfma_f32_16x16x32_bf16 v[56:59], v[96:99], a[24:27], v[56:59]
    ds_read_b64_tr_b16 v[116:117], v5 offset:35968
    v_mfma_f32_16x16x32_bf16 v[76:79], v[96:99], a[104:107], v[76:79]
    ds_read_b64_tr_b16 v[118:119], v5 offset:38528
    s_waitcnt vmcnt(4) lgkmcnt(4)
    v_mfma_f32_16x16x32_bf16 v[40:43], v[100:103], a[28:31], v[40:43]
    ds_read_b64_tr_b16 v[80:81], v5 offset:40960
    v_mfma_f32_16x16x32_bf16 v[60:63], v[100:103], a[108:111], v[60:63]
    ds_read_b64_tr_b16 v[82:83], v5 offset:43520
    buffer_load_dwordx4 a[40:43], v2, s[28:31], s74 offen offset:2048 sc1
    v_mfma_f32_16x16x32_bf16 v[44:47], v[104:107], a[28:31], v[44:47]
    ds_read_b64_tr_b16 v[84:85], v5 offset:40992
    v_mfma_f32_16x16x32_bf16 v[64:67], v[104:107], a[108:111], v[64:67]
    ds_read_b64_tr_b16 v[86:87], v5 offset:43552
    v_mfma_f32_16x16x32_bf16 v[48:51], v[108:111], a[28:31], v[48:51]
    ds_read_b64_tr_b16 v[88:89], v5 offset:41024
    v_mfma_f32_16x16x32_bf16 v[68:71], v[108:111], a[108:111], v[68:71]
    ds_read_b64_tr_b16 v[90:91], v5 offset:43584
    s_waitcnt lgkmcnt(6)
    v_mfma_f32_16x16x32_bf16 v[52:55], v[112:115], a[28:31], v[52:55]
    ds_read_b64_tr_b16 v[92:93], v5 offset:41056
    buffer_load_dwordx4 a[120:123], v2, s[28:31], s75 offen offset:2048 sc1
    v_mfma_f32_16x16x32_bf16 v[72:75], v[112:115], a[108:111], v[72:75]
    ds_read_b64_tr_b16 v[94:95], v5 offset:43616
    v_mfma_f32_16x16x32_bf16 v[56:59], v[116:119], a[28:31], v[56:59]
    ds_read_b64_tr_b16 v[96:97], v5 offset:41088
    v_mfma_f32_16x16x32_bf16 v[76:79], v[116:119], a[108:111], v[76:79]
    ds_read_b64_tr_b16 v[98:99], v5 offset:43648
    s_waitcnt vmcnt(4) lgkmcnt(4)
    v_mfma_f32_16x16x32_bf16 v[40:43], v[80:83], a[32:35], v[40:43]
    ds_read_b64_tr_b16 v[100:101], v5 offset:46080
    v_mfma_f32_16x16x32_bf16 v[60:63], v[80:83], a[112:115], v[60:63]
    ds_read_b64_tr_b16 v[102:103], v5 offset:48640
    buffer_load_dwordx4 a[44:47], v2, s[28:31], s74 offen offset:3072 sc1
    s_add_u32 s74, s74, 4096
    v_mfma_f32_16x16x32_bf16 v[44:47], v[84:87], a[32:35], v[44:47]
    ds_read_b64_tr_b16 v[104:105], v5 offset:46112
    v_mfma_f32_16x16x32_bf16 v[64:67], v[84:87], a[112:115], v[64:67]
    ds_read_b64_tr_b16 v[106:107], v5 offset:48672
    v_mfma_f32_16x16x32_bf16 v[48:51], v[88:91], a[32:35], v[48:51]
    ds_read_b64_tr_b16 v[108:109], v5 offset:46144
    v_mfma_f32_16x16x32_bf16 v[68:71], v[88:91], a[112:115], v[68:71]
    ds_read_b64_tr_b16 v[110:111], v5 offset:48704
    s_waitcnt lgkmcnt(6)
    v_mfma_f32_16x16x32_bf16 v[52:55], v[92:95], a[32:35], v[52:55]
    ds_read_b64_tr_b16 v[112:113], v5 offset:46176
    buffer_load_dwordx4 a[124:127], v2, s[28:31], s75 offen offset:3072 sc1
    s_add_u32 s75, s75, 4096
    v_mfma_f32_16x16x32_bf16 v[72:75], v[92:95], a[112:115], v[72:75]
    ds_read_b64_tr_b16 v[114:115], v5 offset:48736
    v_mfma_f32_16x16x32_bf16 v[56:59], v[96:99], a[32:35], v[56:59]
    ds_read_b64_tr_b16 v[116:117], v5 offset:46208
    v_mfma_f32_16x16x32_bf16 v[76:79], v[96:99], a[112:115], v[76:79]
    ds_read_b64_tr_b16 v[118:119], v5 offset:48768
    s_waitcnt vmcnt(4) lgkmcnt(4)
    v_mfma_f32_16x16x32_bf16 v[40:43], v[100:103], a[36:39], v[40:43]
    ds_read_b64_tr_b16 v[80:81], v6 offset:0
    v_mfma_f32_16x16x32_bf16 v[60:63], v[100:103], a[116:119], v[60:63]
    ds_read_b64_tr_b16 v[82:83], v6 offset:2560
    buffer_load_dwordx4 a[48:51], v2, s[28:31], s74 offen offset:0 sc1
    v_mfma_f32_16x16x32_bf16 v[44:47], v[104:107], a[36:39], v[44:47]
    ds_read_b64_tr_b16 v[84:85], v6 offset:32
    v_mfma_f32_16x16x32_bf16 v[64:67], v[104:107], a[116:119], v[64:67]
    ds_read_b64_tr_b16 v[86:87], v6 offset:2592
    v_mfma_f32_16x16x32_bf16 v[48:51], v[108:111], a[36:39], v[48:51]
    ds_read_b64_tr_b16 v[88:89], v6 offset:64
    v_mfma_f32_16x16x32_bf16 v[68:71], v[108:111], a[116:119], v[68:71]
    ds_read_b64_tr_b16 v[90:91], v6 offset:2624
    s_waitcnt lgkmcnt(6)
    v_mfma_f32_16x16x32_bf16 v[52:55], v[112:115], a[36:39], v[52:55]
    ds_read_b64_tr_b16 v[92:93], v6 offset:96
    buffer_load_dwordx4 a[128:131], v2, s[28:31], s75 offen offset:0 sc1
    v_mfma_f32_16x16x32_bf16 v[72:75], v[112:115], a[116:119], v[72:75]
    ds_read_b64_tr_b16 v[94:95], v6 offset:2656
    v_mfma_f32_16x16x32_bf16 v[56:59], v[116:119], a[36:39], v[56:59]
    ds_read_b64_tr_b16 v[96:97], v6 offset:128
    v_mfma_f32_16x16x32_bf16 v[76:79], v[116:119], a[116:119], v[76:79]
    ds_read_b64_tr_b16 v[98:99], v6 offset:2688
    s_waitcnt vmcnt(4) lgkmcnt(4)
    v_mfma_f32_16x16x32_bf16 v[40:43], v[80:83], a[40:43], v[40:43]
    ds_read_b64_tr_b16 v[100:101], v6 offset:5120
    v_mfma_f32_16x16x32_bf16 v[60:63], v[80:83], a[120:123], v[60:63]
    ds_read_b64_tr_b16 v[102:103], v6 offset:7680
    buffer_load_dwordx4 a[52:55], v2, s[28:31], s74 offen offset:1024 sc1
    v_mfma_f32_16x16x32_bf16 v[44:47], v[84:87], a[40:43], v[44:47]
    ds_read_b64_tr_b16 v[104:105], v6 offset:5152
    v_mfma_f32_16x16x32_bf16 v[64:67], v[84:87], a[120:123], v[64:67]
    ds_read_b64_tr_b16 v[106:107], v6 offset:7712
    v_mfma_f32_16x16x32_bf16 v[48:51], v[88:91], a[40:43], v[48:51]
    ds_read_b64_tr_b16 v[108:109], v6 offset:5184
    v_mfma_f32_16x16x32_bf16 v[68:71], v[88:91], a[120:123], v[68:71]
    ds_read_b64_tr_b16 v[110:111], v6 offset:7744
    s_waitcnt lgkmcnt(6)
    v_mfma_f32_16x16x32_bf16 v[52:55], v[92:95], a[40:43], v[52:55]
    ds_read_b64_tr_b16 v[112:113], v6 offset:5216
    buffer_load_dwordx4 a[132:135], v2, s[28:31], s75 offen offset:1024 sc1
    v_mfma_f32_16x16x32_bf16 v[72:75], v[92:95], a[120:123], v[72:75]
    ds_read_b64_tr_b16 v[114:115], v6 offset:7776
    v_mfma_f32_16x16x32_bf16 v[56:59], v[96:99], a[40:43], v[56:59]
    ds_read_b64_tr_b16 v[116:117], v6 offset:5248
    v_mfma_f32_16x16x32_bf16 v[76:79], v[96:99], a[120:123], v[76:79]
    ds_read_b64_tr_b16 v[118:119], v6 offset:7808
    s_waitcnt vmcnt(4) lgkmcnt(4)
    v_mfma_f32_16x16x32_bf16 v[40:43], v[100:103], a[44:47], v[40:43]
    ds_read_b64_tr_b16 v[80:81], v6 offset:10240
    v_mfma_f32_16x16x32_bf16 v[60:63], v[100:103], a[124:127], v[60:63]
    ds_read_b64_tr_b16 v[82:83], v6 offset:12800
    buffer_load_dwordx4 a[56:59], v2, s[28:31], s74 offen offset:2048 sc1
    v_mfma_f32_16x16x32_bf16 v[44:47], v[104:107], a[44:47], v[44:47]
    ds_read_b64_tr_b16 v[84:85], v6 offset:10272
    v_mfma_f32_16x16x32_bf16 v[64:67], v[104:107], a[124:127], v[64:67]
    ds_read_b64_tr_b16 v[86:87], v6 offset:12832
    v_mfma_f32_16x16x32_bf16 v[48:51], v[108:111], a[44:47], v[48:51]
    ds_read_b64_tr_b16 v[88:89], v6 offset:10304
    v_mfma_f32_16x16x32_bf16 v[68:71], v[108:111], a[124:127], v[68:71]
    ds_read_b64_tr_b16 v[90:91], v6 offset:12864
    s_waitcnt lgkmcnt(6)
    v_mfma_f32_16x16x32_bf16 v[52:55], v[112:115], a[44:47], v[52:55]
    ds_read_b64_tr_b16 v[92:93], v6 offset:10336
    buffer_load_dwordx4 a[136:139], v2, s[28:31], s75 offen offset:2048 sc1
    v_mfma_f32_16x16x32_bf16 v[72:75], v[112:115], a[124:127], v[72:75]
    ds_read_b64_tr_b16 v[94:95], v6 offset:12896
    v_mfma_f32_16x16x32_bf16 v[56:59], v[116:119], a[44:47], v[56:59]
    ds_read_b64_tr_b16 v[96:97], v6 offset:10368
    v_mfma_f32_16x16x32_bf16 v[76:79], v[116:119], a[124:127], v[76:79]
    ds_read_b64_tr_b16 v[98:99], v6 offset:12928
    s_barrier
    s_waitcnt vmcnt(4) lgkmcnt(4)
    v_mfma_f32_16x16x32_bf16 v[40:43], v[80:83], a[48:51], v[40:43]
    ds_read_b64_tr_b16 v[100:101], v6 offset:15360
    v_mfma_f32_16x16x32_bf16 v[60:63], v[80:83], a[128:131], v[60:63]
    ds_read_b64_tr_b16 v[102:103], v6 offset:17920
    buffer_load_dwordx4 a[60:63], v2, s[28:31], s74 offen offset:3072 sc1
    s_add_u32 s74, s74, 4096
    v_mfma_f32_16x16x32_bf16 v[44:47], v[84:87], a[48:51], v[44:47]
    ds_read_b64_tr_b16 v[104:105], v6 offset:15392
    v_mfma_f32_16x16x32_bf16 v[64:67], v[84:87], a[128:131], v[64:67]
    ds_read_b64_tr_b16 v[106:107], v6 offset:17952
    v_mfma_f32_16x16x32_bf16 v[48:51], v[88:91], a[48:51], v[48:51]
    ds_read_b64_tr_b16 v[108:109], v6 offset:15424
    v_mfma_f32_16x16x32_bf16 v[68:71], v[88:91], a[128:131], v[68:71]
    ds_read_b64_tr_b16 v[110:111], v6 offset:17984
    s_waitcnt lgkmcnt(6)
    v_mfma_f32_16x16x32_bf16 v[52:55], v[92:95], a[48:51], v[52:55]
    ds_read_b64_tr_b16 v[112:113], v6 offset:15456
    buffer_load_dwordx4 a[140:143], v2, s[28:31], s75 offen offset:3072 sc1
    s_add_u32 s75, s75, 4096
    v_mfma_f32_16x16x32_bf16 v[72:75], v[92:95], a[128:131], v[72:75]
    ds_read_b64_tr_b16 v[114:115], v6 offset:18016
    v_mfma_f32_16x16x32_bf16 v[56:59], v[96:99], a[48:51], v[56:59]
    ds_read_b64_tr_b16 v[116:117], v6 offset:15488
    v_mfma_f32_16x16x32_bf16 v[76:79], v[96:99], a[128:131], v[76:79]
    ds_read_b64_tr_b16 v[118:119], v6 offset:18048
    s_waitcnt vmcnt(4) lgkmcnt(4)
    v_mfma_f32_16x16x32_bf16 v[40:43], v[100:103], a[52:55], v[40:43]
    ds_read_b64_tr_b16 v[80:81], v6 offset:20480
    v_mfma_f32_16x16x32_bf16 v[60:63], v[100:103], a[132:135], v[60:63]
    ds_read_b64_tr_b16 v[82:83], v6 offset:23040
    buffer_load_dwordx4 a[64:67], v2, s[28:31], s74 offen offset:0 sc1
    v_mfma_f32_16x16x32_bf16 v[44:47], v[104:107], a[52:55], v[44:47]
    ds_read_b64_tr_b16 v[84:85], v6 offset:20512
    v_mfma_f32_16x16x32_bf16 v[64:67], v[104:107], a[132:135], v[64:67]
    ds_read_b64_tr_b16 v[86:87], v6 offset:23072
    v_mfma_f32_16x16x32_bf16 v[48:51], v[108:111], a[52:55], v[48:51]
    ds_read_b64_tr_b16 v[88:89], v6 offset:20544
    v_mfma_f32_16x16x32_bf16 v[68:71], v[108:111], a[132:135], v[68:71]
    ds_read_b64_tr_b16 v[90:91], v6 offset:23104
    s_waitcnt lgkmcnt(6)
    v_mfma_f32_16x16x32_bf16 v[52:55], v[112:115], a[52:55], v[52:55]
    ds_read_b64_tr_b16 v[92:93], v6 offset:20576
    buffer_load_dwordx4 a[144:147], v2, s[28:31], s75 offen offset:0 sc1
    v_mfma_f32_16x16x32_bf16 v[72:75], v[112:115], a[132:135], v[72:75]
    ds_read_b64_tr_b16 v[94:95], v6 offset:23136
    v_mfma_f32_16x16x32_bf16 v[56:59], v[116:119], a[52:55], v[56:59]
    ds_read_b64_tr_b16 v[96:97], v6 offset:20608
    v_mfma_f32_16x16x32_bf16 v[76:79], v[116:119], a[132:135], v[76:79]
    ds_read_b64_tr_b16 v[98:99], v6 offset:23168
    s_waitcnt vmcnt(4) lgkmcnt(4)
    v_mfma_f32_16x16x32_bf16 v[40:43], v[80:83], a[56:59], v[40:43]
    ds_read_b64_tr_b16 v[100:101], v6 offset:25600
    v_mfma_f32_16x16x32_bf16 v[60:63], v[80:83], a[136:139], v[60:63]
    ds_read_b64_tr_b16 v[102:103], v6 offset:28160
    buffer_load_dwordx4 a[68:71], v2, s[28:31], s74 offen offset:1024 sc1
    v_mfma_f32_16x16x32_bf16 v[44:47], v[84:87], a[56:59], v[44:47]
    ds_read_b64_tr_b16 v[104:105], v6 offset:25632
    v_mfma_f32_16x16x32_bf16 v[64:67], v[84:87], a[136:139], v[64:67]
    ds_read_b64_tr_b16 v[106:107], v6 offset:28192
    v_mfma_f32_16x16x32_bf16 v[48:51], v[88:91], a[56:59], v[48:51]
    ds_read_b64_tr_b16 v[108:109], v6 offset:25664
    v_mfma_f32_16x16x32_bf16 v[68:71], v[88:91], a[136:139], v[68:71]
    ds_read_b64_tr_b16 v[110:111], v6 offset:28224
    s_waitcnt lgkmcnt(6)
    v_mfma_f32_16x16x32_bf16 v[52:55], v[92:95], a[56:59], v[52:55]
    ds_read_b64_tr_b16 v[112:113], v6 offset:25696
    buffer_load_dwordx4 a[148:151], v2, s[28:31], s75 offen offset:1024 sc1
    v_mfma_f32_16x16x32_bf16 v[72:75], v[92:95], a[136:139], v[72:75]
    ds_read_b64_tr_b16 v[114:115], v6 offset:28256
    v_mfma_f32_16x16x32_bf16 v[56:59], v[96:99], a[56:59], v[56:59]
    ds_read_b64_tr_b16 v[116:117], v6 offset:25728
    v_mfma_f32_16x16x32_bf16 v[76:79], v[96:99], a[136:139], v[76:79]
    ds_read_b64_tr_b16 v[118:119], v6 offset:28288
    s_waitcnt vmcnt(4) lgkmcnt(4)
    v_mfma_f32_16x16x32_bf16 v[40:43], v[100:103], a[60:63], v[40:43]
    ds_read_b64_tr_b16 v[80:81], v6 offset:30720
    v_mfma_f32_16x16x32_bf16 v[60:63], v[100:103], a[140:143], v[60:63]
    ds_read_b64_tr_b16 v[82:83], v6 offset:33280
    buffer_load_dwordx4 a[72:75], v2, s[28:31], s74 offen offset:2048 sc1
    v_mfma_f32_16x16x32_bf16 v[44:47], v[104:107], a[60:63], v[44:47]
    ds_read_b64_tr_b16 v[84:85], v6 offset:30752
    v_mfma_f32_16x16x32_bf16 v[64:67], v[104:107], a[140:143], v[64:67]
    ds_read_b64_tr_b16 v[86:87], v6 offset:33312
    v_mfma_f32_16x16x32_bf16 v[48:51], v[108:111], a[60:63], v[48:51]
    ds_read_b64_tr_b16 v[88:89], v6 offset:30784
    v_mfma_f32_16x16x32_bf16 v[68:71], v[108:111], a[140:143], v[68:71]
    ds_read_b64_tr_b16 v[90:91], v6 offset:33344
    s_waitcnt lgkmcnt(6)
    v_mfma_f32_16x16x32_bf16 v[52:55], v[112:115], a[60:63], v[52:55]
    ds_read_b64_tr_b16 v[92:93], v6 offset:30816
    buffer_load_dwordx4 a[152:155], v2, s[28:31], s75 offen offset:2048 sc1
    v_mfma_f32_16x16x32_bf16 v[72:75], v[112:115], a[140:143], v[72:75]
    ds_read_b64_tr_b16 v[94:95], v6 offset:33376
    v_mfma_f32_16x16x32_bf16 v[56:59], v[116:119], a[60:63], v[56:59]
    ds_read_b64_tr_b16 v[96:97], v6 offset:30848
    v_mfma_f32_16x16x32_bf16 v[76:79], v[116:119], a[140:143], v[76:79]
    ds_read_b64_tr_b16 v[98:99], v6 offset:33408
    s_waitcnt vmcnt(4) lgkmcnt(4)
    v_mfma_f32_16x16x32_bf16 v[40:43], v[80:83], a[64:67], v[40:43]
    ds_read_b64_tr_b16 v[100:101], v6 offset:35840
    v_mfma_f32_16x16x32_bf16 v[60:63], v[80:83], a[144:147], v[60:63]
    ds_read_b64_tr_b16 v[102:103], v6 offset:38400
    buffer_load_dwordx4 a[76:79], v2, s[28:31], s74 offen offset:3072 sc1
    v_mfma_f32_16x16x32_bf16 v[44:47], v[84:87], a[64:67], v[44:47]
    ds_read_b64_tr_b16 v[104:105], v6 offset:35872
    v_mfma_f32_16x16x32_bf16 v[64:67], v[84:87], a[144:147], v[64:67]
    ds_read_b64_tr_b16 v[106:107], v6 offset:38432
    v_mfma_f32_16x16x32_bf16 v[48:51], v[88:91], a[64:67], v[48:51]
    ds_read_b64_tr_b16 v[108:109], v6 offset:35904
    v_mfma_f32_16x16x32_bf16 v[68:71], v[88:91], a[144:147], v[68:71]
    ds_read_b64_tr_b16 v[110:111], v6 offset:38464
    s_waitcnt lgkmcnt(6)
    v_mfma_f32_16x16x32_bf16 v[52:55], v[92:95], a[64:67], v[52:55]
    ds_read_b64_tr_b16 v[112:113], v6 offset:35936
    buffer_load_dwordx4 a[156:159], v2, s[28:31], s75 offen offset:3072 sc1
    v_mfma_f32_16x16x32_bf16 v[72:75], v[92:95], a[144:147], v[72:75]
    ds_read_b64_tr_b16 v[114:115], v6 offset:38496
    v_mfma_f32_16x16x32_bf16 v[56:59], v[96:99], a[64:67], v[56:59]
    ds_read_b64_tr_b16 v[116:117], v6 offset:35968
    v_mfma_f32_16x16x32_bf16 v[76:79], v[96:99], a[144:147], v[76:79]
    ds_read_b64_tr_b16 v[118:119], v6 offset:38528
    s_waitcnt vmcnt(4) lgkmcnt(4)
    v_mfma_f32_16x16x32_bf16 v[40:43], v[100:103], a[68:71], v[40:43]
    ds_read_b64_tr_b16 v[80:81], v6 offset:40960
    v_mfma_f32_16x16x32_bf16 v[60:63], v[100:103], a[148:151], v[60:63]
    ds_read_b64_tr_b16 v[82:83], v6 offset:43520
    buffer_store_dwordx4 v[160:163], v2, s[28:31], s89 offen offset:0 sc1
    v_mfma_f32_16x16x32_bf16 v[44:47], v[104:107], a[68:71], v[44:47]
    ds_read_b64_tr_b16 v[84:85], v6 offset:40992
    v_mfma_f32_16x16x32_bf16 v[64:67], v[104:107], a[148:151], v[64:67]
    ds_read_b64_tr_b16 v[86:87], v6 offset:43552
    v_mfma_f32_16x16x32_bf16 v[48:51], v[108:111], a[68:71], v[48:51]
    ds_read_b64_tr_b16 v[88:89], v6 offset:41024
    v_mfma_f32_16x16x32_bf16 v[68:71], v[108:111], a[148:151], v[68:71]
    ds_read_b64_tr_b16 v[90:91], v6 offset:43584
    s_waitcnt lgkmcnt(6)
    v_mfma_f32_16x16x32_bf16 v[52:55], v[112:115], a[68:71], v[52:55]
    ds_read_b64_tr_b16 v[92:93], v6 offset:41056
    buffer_store_dwordx4 v[164:167], v2, s[28:31], s89 offen offset:1024 sc1
    v_mfma_f32_16x16x32_bf16 v[72:75], v[112:115], a[148:151], v[72:75]
    ds_read_b64_tr_b16 v[94:95], v6 offset:43616
    v_mfma_f32_16x16x32_bf16 v[56:59], v[116:119], a[68:71], v[56:59]
    ds_read_b64_tr_b16 v[96:97], v6 offset:41088
    v_mfma_f32_16x16x32_bf16 v[76:79], v[116:119], a[148:151], v[76:79]
    ds_read_b64_tr_b16 v[98:99], v6 offset:43648
    s_waitcnt vmcnt(4) lgkmcnt(4)
    v_mfma_f32_16x16x32_bf16 v[40:43], v[80:83], a[72:75], v[40:43]
    ds_read_b64_tr_b16 v[100:101], v6 offset:46080
    v_mfma_f32_16x16x32_bf16 v[60:63], v[80:83], a[152:155], v[60:63]
    ds_read_b64_tr_b16 v[102:103], v6 offset:48640
    buffer_store_dwordx4 v[168:171], v2, s[28:31], s89 offen offset:2048 sc1
    v_mfma_f32_16x16x32_bf16 v[44:47], v[84:87], a[72:75], v[44:47]
    ds_read_b64_tr_b16 v[104:105], v6 offset:46112
    v_mfma_f32_16x16x32_bf16 v[64:67], v[84:87], a[152:155], v[64:67]
    ds_read_b64_tr_b16 v[106:107], v6 offset:48672
    v_mfma_f32_16x16x32_bf16 v[48:51], v[88:91], a[72:75], v[48:51]
    ds_read_b64_tr_b16 v[108:109], v6 offset:46144
    buffer_store_dwordx4 v[172:175], v2, s[28:31], s92 offen offset:0 sc1
    v_mfma_f32_16x16x32_bf16 v[68:71], v[88:91], a[152:155], v[68:71]
    ds_read_b64_tr_b16 v[110:111], v6 offset:48704
    s_waitcnt lgkmcnt(6)
    v_mfma_f32_16x16x32_bf16 v[52:55], v[92:95], a[72:75], v[52:55]
    ds_read_b64_tr_b16 v[112:113], v6 offset:46176
    v_mfma_f32_16x16x32_bf16 v[72:75], v[92:95], a[152:155], v[72:75]
    ds_read_b64_tr_b16 v[114:115], v6 offset:48736
    buffer_store_dwordx4 v[176:179], v2, s[28:31], s92 offen offset:1024 sc1
    v_mfma_f32_16x16x32_bf16 v[56:59], v[96:99], a[72:75], v[56:59]
    ds_read_b64_tr_b16 v[116:117], v6 offset:46208
    v_mfma_f32_16x16x32_bf16 v[76:79], v[96:99], a[152:155], v[76:79]
    ds_read_b64_tr_b16 v[118:119], v6 offset:48768
    s_waitcnt vmcnt(5) lgkmcnt(4)
    v_mfma_f32_16x16x32_bf16 v[40:43], v[100:103], a[76:79], v[40:43]
    v_mfma_f32_16x16x32_bf16 v[60:63], v[100:103], a[156:159], v[60:63]
    buffer_store_dwordx4 v[180:183], v2, s[28:31], s92 offen offset:2048 sc1
    v_mfma_f32_16x16x32_bf16 v[44:47], v[104:107], a[76:79], v[44:47]
    v_mfma_f32_16x16x32_bf16 v[64:67], v[104:107], a[156:159], v[64:67]
    v_mfma_f32_16x16x32_bf16 v[48:51], v[108:111], a[76:79], v[48:51]
    v_mfma_f32_16x16x32_bf16 v[68:71], v[108:111], a[156:159], v[68:71]
    s_waitcnt lgkmcnt(0)
    v_mfma_f32_16x16x32_bf16 v[52:55], v[112:115], a[76:79], v[52:55]
    buffer_store_dwordx4 v[184:187], v2, s[28:31], s94 offen offset:0 sc1
    v_mfma_f32_16x16x32_bf16 v[72:75], v[112:115], a[156:159], v[72:75]
    v_mfma_f32_16x16x32_bf16 v[56:59], v[116:119], a[76:79], v[56:59]
    v_mfma_f32_16x16x32_bf16 v[76:79], v[116:119], a[156:159], v[76:79]
    buffer_store_dwordx4 v[188:191], v2, s[28:31], s94 offen offset:1024 sc1
    buffer_store_dwordx4 v[192:195], v2, s[28:31], s94 offen offset:2048 sc1
    buffer_store_dwordx4 v[196:199], v2, s[28:31], s94 offen offset:3072 sc1
    buffer_store_dwordx4 v[200:203], v2, s[28:31], s93 offen offset:0 sc1
    v_and_b32 v32, 127, v0
    v_mul_u32_u24 v32, 48, v32
    v_lshrrev_b32 v33, 7, v0
    v_mul_u32_u24 v33, 6144, v33
    v_add_u32 v32, v32, v33
    v_add_u32 v32, 40, v32
    s_cmp_lt_u32 s45, 8
    s_mov_b32 s60, 0x3f803f80
    s_cselect_b32 s61, 0x3f800000, s60
    v_mov_b32 v34, s61
    v_mov_b32 v35, s60
    v_cvt_pk_bf16_f32 v40, v40, v41
    v_cvt_pk_bf16_f32 v41, v42, v43
    v_cvt_pk_bf16_f32 v44, v44, v45
    v_cvt_pk_bf16_f32 v45, v46, v47
    v_cvt_pk_bf16_f32 v48, v48, v49
    v_cvt_pk_bf16_f32 v49, v50, v51
    v_cvt_pk_bf16_f32 v52, v52, v53
    v_cvt_pk_bf16_f32 v53, v54, v55
    v_cvt_pk_bf16_f32 v56, v56, v57
    v_cvt_pk_bf16_f32 v57, v58, v59
    v_cvt_pk_bf16_f32 v60, v60, v61
    v_cvt_pk_bf16_f32 v61, v62, v63
    v_cvt_pk_bf16_f32 v64, v64, v65
    v_cvt_pk_bf16_f32 v65, v66, v67
    v_cvt_pk_bf16_f32 v68, v68, v69
    v_cvt_pk_bf16_f32 v69, v70, v71
    v_cvt_pk_bf16_f32 v72, v72, v73
    v_cvt_pk_bf16_f32 v73, v74, v75
    v_cvt_pk_bf16_f32 v76, v76, v77
    v_cvt_pk_bf16_f32 v77, v78, v79
    ds_write_b64 v10, v[40:41] offset:0
    ds_write_b64 v11, v[44:45] offset:0
    ds_write_b64 v12, v[48:49] offset:0
    ds_write_b64 v13, v[52:53] offset:0
    ds_write_b64 v14, v[56:57] offset:0
    ds_write_b64 v10, v[60:61] offset:768
    ds_write_b64 v11, v[64:65] offset:768
    ds_write_b64 v12, v[68:69] offset:768
    ds_write_b64 v13, v[72:73] offset:768
    ds_write_b64 v14, v[76:77] offset:768
    ds_write_b64 v32, v[34:35]
    ds_write_b64 v32, v[34:35] offset:12288
    s_mul_i32 s60, s46, 6144
    s_add_u32 s60, s60, 0
    v_add_u32 v33, s60, v2
    s_lshl_b32 s60, s44, 4
    s_add_u32 s60, s60, s45
    s_lshl_b32 s60, s60, 2
    s_add_u32 s60, s60, s46
    s_mul_i32 s60, s60, 6144
    s_add_u32 s60, s60, 4194304
    s_add_u32 s61, s60, 4096
    s_waitcnt lgkmcnt(0)
    s_barrier
    ds_read_b128 v[40:43], v33 offset:0
    ds_read_b128 v[44:47], v33 offset:1024
    ds_read_b128 v[48:51], v33 offset:2048
    ds_read_b128 v[52:55], v33 offset:3072
    ds_read_b128 v[56:59], v33 offset:4096
    ds_read_b128 v[60:63], v33 offset:5120
    s_waitcnt lgkmcnt(5)
    buffer_store_dwordx4 v[40:43], v2, s[28:31], s60 offen offset:0 sc1
    s_waitcnt lgkmcnt(4)
    buffer_store_dwordx4 v[44:47], v2, s[28:31], s60 offen offset:1024 sc1
    s_waitcnt lgkmcnt(3)
    buffer_store_dwordx4 v[48:51], v2, s[28:31], s60 offen offset:2048 sc1
    s_waitcnt lgkmcnt(2)
    buffer_store_dwordx4 v[52:55], v2, s[28:31], s60 offen offset:3072 sc1
    s_waitcnt lgkmcnt(1)
    buffer_store_dwordx4 v[56:59], v2, s[28:31], s61 offen offset:0 sc1
    s_waitcnt lgkmcnt(0)
    buffer_store_dwordx4 v[60:63], v2, s[28:31], s61 offen offset:1024 sc1
    ds_read_b64_tr_b16 v[80:81], v7 offset:0
    ds_read_b64_tr_b16 v[82:83], v7 offset:1280
    ds_read_b64_tr_b16 v[84:85], v7 offset:32
    ds_read_b64_tr_b16 v[86:87], v7 offset:1312
    ds_read_b64_tr_b16 v[88:89], v7 offset:64
    ds_read_b64_tr_b16 v[90:91], v7 offset:1344
    s_waitcnt lgkmcnt(0)
    v_mfma_f32_16x16x32_bf16 v[120:123], v[80:83], a[0:3], 0
    ds_read_b64_tr_b16 v[92:93], v7 offset:2560
    v_mfma_f32_16x16x32_bf16 v[132:135], v[80:83], a[80:83], 0
    ds_read_b64_tr_b16 v[94:95], v7 offset:3840
    v_mfma_f32_16x16x32_bf16 v[124:127], v[84:87], a[0:3], 0
    ds_read_b64_tr_b16 v[96:97], v7 offset:2592
    v_mfma_f32_16x16x32_bf16 v[136:139], v[84:87], a[80:83], 0
    ds_read_b64_tr_b16 v[98:99], v7 offset:3872
    v_mfma_f32_16x16x32_bf16 v[128:131], v[88:91], a[0:3], 0
    ds_read_b64_tr_b16 v[100:101], v7 offset:2624
    v_mfma_f32_16x16x32_bf16 v[140:143], v[88:91], a[80:83], 0
    ds_read_b64_tr_b16 v[102:103], v7 offset:3904
    s_waitcnt lgkmcnt(0)
    v_mfma_f32_16x16x32_bf16 v[120:123], v[92:95], a[4:7], v[120:123]
    ds_read_b64_tr_b16 v[80:81], v7 offset:5120
    v_mfma_f32_16x16x32_bf16 v[132:135], v[92:95], a[84:87], v[132:135]
    ds_read_b64_tr_b16 v[82:83], v7 offset:6400
    v_mfma_f32_16x16x32_bf16 v[124:127], v[96:99], a[4:7], v[124:127]
    ds_read_b64_tr_b16 v[84:85], v7 offset:5152
    v_mfma_f32_16x16x32_bf16 v[136:139], v[96:99], a[84:87], v[136:139]
    ds_read_b64_tr_b16 v[86:87], v7 offset:6432
    v_mfma_f32_16x16x32_bf16 v[128:131], v[100:103], a[4:7], v[128:131]
    ds_read_b64_tr_b16 v[88:89], v7 offset:5184
    v_mfma_f32_16x16x32_bf16 v[140:143], v[100:103], a[84:87], v[140:143]
    ds_read_b64_tr_b16 v[90:91], v7 offset:6464
    s_waitcnt lgkmcnt(0)
    v_mfma_f32_16x16x32_bf16 v[120:123], v[80:83], a[8:11], v[120:123]
    ds_read_b64_tr_b16 v[92:93], v7 offset:7680
    v_mfma_f32_16x16x32_bf16 v[132:135], v[80:83], a[88:91], v[132:135]
    ds_read_b64_tr_b16 v[94:95], v7 offset:8960
    v_mfma_f32_16x16x32_bf16 v[124:127], v[84:87], a[8:11], v[124:127]
    ds_read_b64_tr_b16 v[96:97], v7 offset:7712
    v_mfma_f32_16x16x32_bf16 v[136:139], v[84:87], a[88:91], v[136:139]
    ds_read_b64_tr_b16 v[98:99], v7 offset:8992
    v_mfma_f32_16x16x32_bf16 v[128:131], v[88:91], a[8:11], v[128:131]
    ds_read_b64_tr_b16 v[100:101], v7 offset:7744
    v_mfma_f32_16x16x32_bf16 v[140:143], v[88:91], a[88:91], v[140:143]
    ds_read_b64_tr_b16 v[102:103], v7 offset:9024
    s_waitcnt lgkmcnt(0)
    v_mfma_f32_16x16x32_bf16 v[120:123], v[92:95], a[12:15], v[120:123]
    ds_read_b64_tr_b16 v[80:81], v7 offset:10240
    v_mfma_f32_16x16x32_bf16 v[132:135], v[92:95], a[92:95], v[132:135]
    ds_read_b64_tr_b16 v[82:83], v7 offset:11520
    v_mfma_f32_16x16x32_bf16 v[124:127], v[96:99], a[12:15], v[124:127]
    ds_read_b64_tr_b16 v[84:85], v7 offset:10272
    v_mfma_f32_16x16x32_bf16 v[136:139], v[96:99], a[92:95], v[136:139]
    ds_read_b64_tr_b16 v[86:87], v7 offset:11552
    v_mfma_f32_16x16x32_bf16 v[128:131], v[100:103], a[12:15], v[128:131]
    ds_read_b64_tr_b16 v[88:89], v7 offset:10304
    v_mfma_f32_16x16x32_bf16 v[140:143], v[100:103], a[92:95], v[140:143]
    ds_read_b64_tr_b16 v[90:91], v7 offset:11584
    s_waitcnt lgkmcnt(0)
    v_mfma_f32_16x16x32_bf16 v[120:123], v[80:83], a[16:19], v[120:123]
    ds_read_b64_tr_b16 v[92:93], v7 offset:12800
    v_mfma_f32_16x16x32_bf16 v[132:135], v[80:83], a[96:99], v[132:135]
    ds_read_b64_tr_b16 v[94:95], v7 offset:14080
    v_mfma_f32_16x16x32_bf16 v[124:127], v[84:87], a[16:19], v[124:127]
    ds_read_b64_tr_b16 v[96:97], v7 offset:12832
    v_mfma_f32_16x16x32_bf16 v[136:139], v[84:87], a[96:99], v[136:139]
    ds_read_b64_tr_b16 v[98:99], v7 offset:14112
    v_mfma_f32_16x16x32_bf16 v[128:131], v[88:91], a[16:19], v[128:131]
    ds_read_b64_tr_b16 v[100:101], v7 offset:12864
    v_mfma_f32_16x16x32_bf16 v[140:143], v[88:91], a[96:99], v[140:143]
    ds_read_b64_tr_b16 v[102:103], v7 offset:14144
    s_waitcnt lgkmcnt(0)
    v_mfma_f32_16x16x32_bf16 v[120:123], v[92:95], a[20:23], v[120:123]
    ds_read_b64_tr_b16 v[80:81], v7 offset:15360
    v_mfma_f32_16x16x32_bf16 v[132:135], v[92:95], a[100:103], v[132:135]
    ds_read_b64_tr_b16 v[82:83], v7 offset:16640
    v_mfma_f32_16x16x32_bf16 v[124:127], v[96:99], a[20:23], v[124:127]
    ds_read_b64_tr_b16 v[84:85], v7 offset:15392
    v_mfma_f32_16x16x32_bf16 v[136:139], v[96:99], a[100:103], v[136:139]
    ds_read_b64_tr_b16 v[86:87], v7 offset:16672
    v_mfma_f32_16x16x32_bf16 v[128:131], v[100:103], a[20:23], v[128:131]
    ds_read_b64_tr_b16 v[88:89], v7 offset:15424
    v_mfma_f32_16x16x32_bf16 v[140:143], v[100:103], a[100:103], v[140:143]
    ds_read_b64_tr_b16 v[90:91], v7 offset:16704
    s_waitcnt lgkmcnt(0)
    v_mfma_f32_16x16x32_bf16 v[120:123], v[80:83], a[24:27], v[120:123]
    ds_read_b64_tr_b16 v[92:93], v7 offset:17920
    v_mfma_f32_16x16x32_bf16 v[132:135], v[80:83], a[104:107], v[132:135]
    ds_read_b64_tr_b16 v[94:95], v7 offset:19200
    v_mfma_f32_16x16x32_bf16 v[124:127], v[84:87], a[24:27], v[124:127]
    ds_read_b64_tr_b16 v[96:97], v7 offset:17952
    v_mfma_f32_16x16x32_bf16 v[136:139], v[84:87], a[104:107], v[136:139]
    ds_read_b64_tr_b16 v[98:99], v7 offset:19232
    v_mfma_f32_16x16x32_bf16 v[128:131], v[88:91], a[24:27], v[128:131]
    ds_read_b64_tr_b16 v[100:101], v7 offset:17984
    v_mfma_f32_16x16x32_bf16 v[140:143], v[88:91], a[104:107], v[140:143]
    ds_read_b64_tr_b16 v[102:103], v7 offset:19264
    s_waitcnt lgkmcnt(0)
    v_mfma_f32_16x16x32_bf16 v[120:123], v[92:95], a[28:31], v[120:123]
    ds_read_b64_tr_b16 v[80:81], v7 offset:20480
    v_mfma_f32_16x16x32_bf16 v[132:135], v[92:95], a[108:111], v[132:135]
    ds_read_b64_tr_b16 v[82:83], v7 offset:21760
    v_mfma_f32_16x16x32_bf16 v[124:127], v[96:99], a[28:31], v[124:127]
    ds_read_b64_tr_b16 v[84:85], v7 offset:20512
    v_mfma_f32_16x16x32_bf16 v[136:139], v[96:99], a[108:111], v[136:139]
    ds_read_b64_tr_b16 v[86:87], v7 offset:21792
    v_mfma_f32_16x16x32_bf16 v[128:131], v[100:103], a[28:31], v[128:131]
    ds_read_b64_tr_b16 v[88:89], v7 offset:20544
    v_mfma_f32_16x16x32_bf16 v[140:143], v[100:103], a[108:111], v[140:143]
    ds_read_b64_tr_b16 v[90:91], v7 offset:21824
    s_waitcnt vmcnt(0)
    s_lshl_b32 s60, s44, 8
    s_add_u32 s60, s60, 8192
    s_lshl_b32 s61, s45, 4
    s_lshl_b32 s62, s46, 2
    s_add_u32 s61, s61, s62
    v_mov_b32 v3, s61
    v_mov_b32 v4, s47
    s_mov_b64 exec, 1
    buffer_store_dword v4, v3, s[28:31], s60 offen sc1
    s_mov_b64 exec, -1
    v_mov_b32 v4, s47
    s_mov_b32 s100, 32768
    v_mov_b32 v3, s90
    v_writelane_b32 v3, s95, 1
    s_mov_b64 exec, 3
    buffer_store_dword v4, v3, s[28:31], s100 offen sc1
    s_mov_b64 exec, -1
    s_waitcnt lgkmcnt(0)
    v_mfma_f32_16x16x32_bf16 v[120:123], v[80:83], a[32:35], v[120:123]
    ds_read_b64_tr_b16 v[92:93], v7 offset:23040
    v_mfma_f32_16x16x32_bf16 v[132:135], v[80:83], a[112:115], v[132:135]
    ds_read_b64_tr_b16 v[94:95], v7 offset:24320
    v_mfma_f32_16x16x32_bf16 v[124:127], v[84:87], a[32:35], v[124:127]
    ds_read_b64_tr_b16 v[96:97], v7 offset:23072
    v_mfma_f32_16x16x32_bf16 v[136:139], v[84:87], a[112:115], v[136:139]
    ds_read_b64_tr_b16 v[98:99], v7 offset:24352
    v_mfma_f32_16x16x32_bf16 v[128:131], v[88:91], a[32:35], v[128:131]
    ds_read_b64_tr_b16 v[100:101], v7 offset:23104
    v_mfma_f32_16x16x32_bf16 v[140:143], v[88:91], a[112:115], v[140:143]
    ds_read_b64_tr_b16 v[102:103], v7 offset:24384
    s_waitcnt lgkmcnt(0)
    v_mfma_f32_16x16x32_bf16 v[120:123], v[92:95], a[36:39], v[120:123]
    ds_read_b64_tr_b16 v[80:81], v7 offset:25600
    v_mfma_f32_16x16x32_bf16 v[132:135], v[92:95], a[116:119], v[132:135]
    ds_read_b64_tr_b16 v[82:83], v7 offset:26880
    v_mfma_f32_16x16x32_bf16 v[124:127], v[96:99], a[36:39], v[124:127]
    ds_read_b64_tr_b16 v[84:85], v7 offset:25632
    v_mfma_f32_16x16x32_bf16 v[136:139], v[96:99], a[116:119], v[136:139]
    ds_read_b64_tr_b16 v[86:87], v7 offset:26912
    v_mfma_f32_16x16x32_bf16 v[128:131], v[100:103], a[36:39], v[128:131]
    ds_read_b64_tr_b16 v[88:89], v7 offset:25664
    v_mfma_f32_16x16x32_bf16 v[140:143], v[100:103], a[116:119], v[140:143]
    ds_read_b64_tr_b16 v[90:91], v7 offset:26944
    s_waitcnt lgkmcnt(0)
    v_mfma_f32_16x16x32_bf16 v[120:123], v[80:83], a[40:43], v[120:123]
    ds_read_b64_tr_b16 v[92:93], v7 offset:28160
    v_mfma_f32_16x16x32_bf16 v[132:135], v[80:83], a[120:123], v[132:135]
    ds_read_b64_tr_b16 v[94:95], v7 offset:29440
    v_mfma_f32_16x16x32_bf16 v[124:127], v[84:87], a[40:43], v[124:127]
    ds_read_b64_tr_b16 v[96:97], v7 offset:28192
    v_mfma_f32_16x16x32_bf16 v[136:139], v[84:87], a[120:123], v[136:139]
    ds_read_b64_tr_b16 v[98:99], v7 offset:29472
    v_mfma_f32_16x16x32_bf16 v[128:131], v[88:91], a[40:43], v[128:131]
    ds_read_b64_tr_b16 v[100:101], v7 offset:28224
    v_mfma_f32_16x16x32_bf16 v[140:143], v[88:91], a[120:123], v[140:143]
    ds_read_b64_tr_b16 v[102:103], v7 offset:29504
    s_waitcnt lgkmcnt(0)
    v_mfma_f32_16x16x32_bf16 v[120:123], v[92:95], a[44:47], v[120:123]
    ds_read_b64_tr_b16 v[80:81], v7 offset:30720
    v_mfma_f32_16x16x32_bf16 v[132:135], v[92:95], a[124:127], v[132:135]
    ds_read_b64_tr_b16 v[82:83], v7 offset:32000
    v_mfma_f32_16x16x32_bf16 v[124:127], v[96:99], a[44:47], v[124:127]
    ds_read_b64_tr_b16 v[84:85], v7 offset:30752
    v_mfma_f32_16x16x32_bf16 v[136:139], v[96:99], a[124:127], v[136:139]
    ds_read_b64_tr_b16 v[86:87], v7 offset:32032
    v_mfma_f32_16x16x32_bf16 v[128:131], v[100:103], a[44:47], v[128:131]
    ds_read_b64_tr_b16 v[88:89], v7 offset:30784
    v_mfma_f32_16x16x32_bf16 v[140:143], v[100:103], a[124:127], v[140:143]
    ds_read_b64_tr_b16 v[90:91], v7 offset:32064
    s_waitcnt lgkmcnt(0)
    v_mfma_f32_16x16x32_bf16 v[120:123], v[80:83], a[48:51], v[120:123]
    ds_read_b64_tr_b16 v[92:93], v7 offset:33280
    v_mfma_f32_16x16x32_bf16 v[132:135], v[80:83], a[128:131], v[132:135]
    ds_read_b64_tr_b16 v[94:95], v7 offset:34560
    v_mfma_f32_16x16x32_bf16 v[124:127], v[84:87], a[48:51], v[124:127]
    ds_read_b64_tr_b16 v[96:97], v7 offset:33312
    v_mfma_f32_16x16x32_bf16 v[136:139], v[84:87], a[128:131], v[136:139]
    ds_read_b64_tr_b16 v[98:99], v7 offset:34592
    v_mfma_f32_16x16x32_bf16 v[128:131], v[88:91], a[48:51], v[128:131]
    ds_read_b64_tr_b16 v[100:101], v7 offset:33344
    v_mfma_f32_16x16x32_bf16 v[140:143], v[88:91], a[128:131], v[140:143]
    ds_read_b64_tr_b16 v[102:103], v7 offset:34624
    s_waitcnt lgkmcnt(0)
    v_mfma_f32_16x16x32_bf16 v[120:123], v[92:95], a[52:55], v[120:123]
    ds_read_b64_tr_b16 v[80:81], v7 offset:35840
    v_mfma_f32_16x16x32_bf16 v[132:135], v[92:95], a[132:135], v[132:135]
    ds_read_b64_tr_b16 v[82:83], v7 offset:37120
    v_mfma_f32_16x16x32_bf16 v[124:127], v[96:99], a[52:55], v[124:127]
    ds_read_b64_tr_b16 v[84:85], v7 offset:35872
    v_mfma_f32_16x16x32_bf16 v[136:139], v[96:99], a[132:135], v[136:139]
    ds_read_b64_tr_b16 v[86:87], v7 offset:37152
    v_mfma_f32_16x16x32_bf16 v[128:131], v[100:103], a[52:55], v[128:131]
    ds_read_b64_tr_b16 v[88:89], v7 offset:35904
    v_mfma_f32_16x16x32_bf16 v[140:143], v[100:103], a[132:135], v[140:143]
    ds_read_b64_tr_b16 v[90:91], v7 offset:37184
    s_waitcnt lgkmcnt(0)
    v_mfma_f32_16x16x32_bf16 v[120:123], v[80:83], a[56:59], v[120:123]
    ds_read_b64_tr_b16 v[92:93], v7 offset:38400
    v_mfma_f32_16x16x32_bf16 v[132:135], v[80:83], a[136:139], v[132:135]
    ds_read_b64_tr_b16 v[94:95], v7 offset:39680
    v_mfma_f32_16x16x32_bf16 v[124:127], v[84:87], a[56:59], v[124:127]
    ds_read_b64_tr_b16 v[96:97], v7 offset:38432
    v_mfma_f32_16x16x32_bf16 v[136:139], v[84:87], a[136:139], v[136:139]
    ds_read_b64_tr_b16 v[98:99], v7 offset:39712
    v_mfma_f32_16x16x32_bf16 v[128:131], v[88:91], a[56:59], v[128:131]
    ds_read_b64_tr_b16 v[100:101], v7 offset:38464
    v_mfma_f32_16x16x32_bf16 v[140:143], v[88:91], a[136:139], v[140:143]
    ds_read_b64_tr_b16 v[102:103], v7 offset:39744
    s_waitcnt lgkmcnt(0)
    v_mfma_f32_16x16x32_bf16 v[120:123], v[92:95], a[60:63], v[120:123]
    ds_read_b64_tr_b16 v[80:81], v7 offset:40960
    v_mfma_f32_16x16x32_bf16 v[132:135], v[92:95], a[140:143], v[132:135]
    ds_read_b64_tr_b16 v[82:83], v7 offset:42240
    v_mfma_f32_16x16x32_bf16 v[124:127], v[96:99], a[60:63], v[124:127]
    ds_read_b64_tr_b16 v[84:85], v7 offset:40992
    v_mfma_f32_16x16x32_bf16 v[136:139], v[96:99], a[140:143], v[136:139]
    ds_read_b64_tr_b16 v[86:87], v7 offset:42272
    v_mfma_f32_16x16x32_bf16 v[128:131], v[100:103], a[60:63], v[128:131]
    ds_read_b64_tr_b16 v[88:89], v7 offset:41024
    v_mfma_f32_16x16x32_bf16 v[140:143], v[100:103], a[140:143], v[140:143]
    ds_read_b64_tr_b16 v[90:91], v7 offset:42304
    s_waitcnt lgkmcnt(0)
    v_mfma_f32_16x16x32_bf16 v[120:123], v[80:83], a[64:67], v[120:123]
    ds_read_b64_tr_b16 v[92:93], v7 offset:43520
    v_mfma_f32_16x16x32_bf16 v[132:135], v[80:83], a[144:147], v[132:135]
    ds_read_b64_tr_b16 v[94:95], v7 offset:44800
    v_mfma_f32_16x16x32_bf16 v[124:127], v[84:87], a[64:67], v[124:127]
    ds_read_b64_tr_b16 v[96:97], v7 offset:43552
    v_mfma_f32_16x16x32_bf16 v[136:139], v[84:87], a[144:147], v[136:139]
    ds_read_b64_tr_b16 v[98:99], v7 offset:44832
    v_mfma_f32_16x16x32_bf16 v[128:131], v[88:91], a[64:67], v[128:131]
    ds_read_b64_tr_b16 v[100:101], v7 offset:43584
    v_mfma_f32_16x16x32_bf16 v[140:143], v[88:91], a[144:147], v[140:143]
    ds_read_b64_tr_b16 v[102:103], v7 offset:44864
    s_waitcnt lgkmcnt(0)
    v_mfma_f32_16x16x32_bf16 v[120:123], v[92:95], a[68:71], v[120:123]
    ds_read_b64_tr_b16 v[80:81], v7 offset:46080
    v_mfma_f32_16x16x32_bf16 v[132:135], v[92:95], a[148:151], v[132:135]
    ds_read_b64_tr_b16 v[82:83], v7 offset:47360
    v_mfma_f32_16x16x32_bf16 v[124:127], v[96:99], a[68:71], v[124:127]
    ds_read_b64_tr_b16 v[84:85], v7 offset:46112
    v_mfma_f32_16x16x32_bf16 v[136:139], v[96:99], a[148:151], v[136:139]
    ds_read_b64_tr_b16 v[86:87], v7 offset:47392
    v_mfma_f32_16x16x32_bf16 v[128:131], v[100:103], a[68:71], v[128:131]
    ds_read_b64_tr_b16 v[88:89], v7 offset:46144
    v_mfma_f32_16x16x32_bf16 v[140:143], v[100:103], a[148:151], v[140:143]
    ds_read_b64_tr_b16 v[90:91], v7 offset:47424
    s_waitcnt lgkmcnt(0)
    v_mfma_f32_16x16x32_bf16 v[120:123], v[80:83], a[72:75], v[120:123]
    ds_read_b64_tr_b16 v[92:93], v7 offset:48640
    v_mfma_f32_16x16x32_bf16 v[132:135], v[80:83], a[152:155], v[132:135]
    ds_read_b64_tr_b16 v[94:95], v7 offset:49920
    v_mfma_f32_16x16x32_bf16 v[124:127], v[84:87], a[72:75], v[124:127]
    ds_read_b64_tr_b16 v[96:97], v7 offset:48672
    v_mfma_f32_16x16x32_bf16 v[136:139], v[84:87], a[152:155], v[136:139]
    ds_read_b64_tr_b16 v[98:99], v7 offset:49952
    v_mfma_f32_16x16x32_bf16 v[128:131], v[88:91], a[72:75], v[128:131]
    ds_read_b64_tr_b16 v[100:101], v7 offset:48704
    v_mfma_f32_16x16x32_bf16 v[140:143], v[88:91], a[152:155], v[140:143]
    ds_read_b64_tr_b16 v[102:103], v7 offset:49984
    s_waitcnt lgkmcnt(0)
    v_mfma_f32_16x16x32_bf16 v[120:123], v[92:95], a[76:79], v[120:123]
    v_mfma_f32_16x16x32_bf16 v[132:135], v[92:95], a[156:159], v[132:135]
    v_mfma_f32_16x16x32_bf16 v[124:127], v[96:99], a[76:79], v[124:127]
    v_mfma_f32_16x16x32_bf16 v[136:139], v[96:99], a[156:159], v[136:139]
    v_mfma_f32_16x16x32_bf16 v[128:131], v[100:103], a[76:79], v[128:131]
    v_mfma_f32_16x16x32_bf16 v[140:143], v[100:103], a[156:159], v[140:143]
    s_cmp_ge_u32 s2, 200
    s_cbranch_scc1 L_late0
    s_mul_i32 s101, s2, 1639
    s_lshr_b32 s101, s101, 16
    s_mul_i32 s49, s101, 40
    s_sub_u32 s49, s2, s49
    s_add_u32 s49, s49, 20
    s_mov_b32 s32, s18
    s_mov_b32 s33, s19
    s_mov_b32 s34, 0x500
    s_mov_b32 s35, 0x20000
    s_mov_b32 s36, s20
    s_mov_b32 s37, s21
    s_mov_b32 s38, 0x4b0000
    s_mov_b32 s39, 0x20000
    v_lshlrev_b32 v83, 3, v0
    buffer_load_dwordx2 v[84:85], v83, s[32:35], 0 offen
    v_lshrrev_b32 v87, 3, v0
    v_mul_u32_u24 v88, 30720, v87
    v_and_b32 v89, 7, v0
    v_lshl_add_u32 v88, v89, 4, v88
    s_lshl_b32 s64, s49, 7
    s_mul_i32 s66, s101, 983040
    s_add_u32 s64, s64, s66
    buffer_load_dwordx4 v[160:163], v88, s[36:39], s64 offen nt
    s_add_u32 s64, s64, 7680
    buffer_load_dwordx4 v[164:167], v88, s[36:39], s64 offen nt
    s_add_u32 s64, s64, 7680
    buffer_load_dwordx4 v[168:171], v88, s[36:39], s64 offen nt
    s_add_u32 s64, s64, 7680
    buffer_load_dwordx4 v[172:175], v88, s[36:39], s64 offen nt
L_late0:
    s_mov_b32 s60, 0x3ea52b5c
    v_mul_f32 v120, s60, v120
    v_mul_f32 v121, s60, v121
    v_mul_f32 v122, s60, v122
    v_mul_f32 v123, s60, v123
    v_cvt_pk_bf16_f32 v120, v120, v121
    v_cvt_pk_bf16_f32 v121, v122, v123
    ds_write_b64 v15, v[120:121] offset:0
    v_mul_f32 v124, s60, v124
    v_mul_f32 v125, s60, v125
    v_mul_f32 v126, s60, v126
    v_mul_f32 v127, s60, v127
    v_cvt_pk_bf16_f32 v124, v124, v125
    v_cvt_pk_bf16_f32 v125, v126, v127
    ds_write_b64 v16, v[124:125] offset:0
    v_mul_f32 v128, s60, v128
    v_mul_f32 v129, s60, v129
    v_mul_f32 v130, s60, v130
    v_mul_f32 v131, s60, v131
    v_cvt_pk_bf16_f32 v128, v128, v129
    v_cvt_pk_bf16_f32 v129, v130, v131
    ds_write_b64 v17, v[128:129] offset:0
    v_mul_f32 v132, s60, v132
    v_mul_f32 v133, s60, v133
    v_mul_f32 v134, s60, v134
    v_mul_f32 v135, s60, v135
    v_cvt_pk_bf16_f32 v132, v132, v133
    v_cvt_pk_bf16_f32 v133, v134, v135
    ds_write_b64 v15, v[132:133] offset:768
    v_mul_f32 v136, s60, v136
    v_mul_f32 v137, s60, v137
    v_mul_f32 v138, s60, v138
    v_mul_f32 v139, s60, v139
    v_cvt_pk_bf16_f32 v136, v136, v137
    v_cvt_pk_bf16_f32 v137, v138, v139
    ds_write_b64 v16, v[136:137] offset:768
    v_mul_f32 v140, s60, v140
    v_mul_f32 v141, s60, v141
    v_mul_f32 v142, s60, v142
    v_mul_f32 v143, s60, v143
    v_cvt_pk_bf16_f32 v140, v140, v141
    v_cvt_pk_bf16_f32 v141, v142, v143
    ds_write_b64 v17, v[140:141] offset:768
    s_cmp_ge_u32 s2, 200
    s_cbranch_scc1 L_late1
    s_waitcnt vmcnt(4)
    v_lshlrev_b32 v90, 16, v84
    v_and_b32 v91, 0xffff0000, v84
    v_lshlrev_b32 v92, 16, v85
    v_and_b32 v93, 0xffff0000, v85
    v_mul_f32 v94, 0xbfb8aa3b, v90
    v_mul_f32 v95, 0xbfb8aa3b, v91
    v_mul_f32 v96, 0xbfb8aa3b, v92
    v_mul_f32 v97, 0xbfb8aa3b, v93
    v_exp_f32 v94, v94
    v_exp_f32 v95, v95
    v_exp_f32 v96, v96
    v_exp_f32 v97, v97
    v_add_f32 v94, 1.0, v94
    v_add_f32 v95, 1.0, v95
    v_add_f32 v96, 1.0, v96
    v_add_f32 v97, 1.0, v97
    v_rcp_f32 v94, v94
    v_rcp_f32 v95, v95
    v_rcp_f32 v96, v96
    v_rcp_f32 v97, v97
    v_mul_f32 v90, v90, v94
    v_mul_f32 v91, v91, v95
    v_mul_f32 v92, v92, v96
    v_mul_f32 v93, v93, v97
    v_cvt_pk_bf16_f32 v94, v90, v91
    v_cvt_pk_bf16_f32 v95, v92, v93
    v_lshlrev_b32 v96, 16, v94
    v_and_b32 v97, 0xffff0000, v94
    v_lshlrev_b32 v98, 16, v95
    v_and_b32 v99, 0xffff0000, v95
    v_lshlrev_b32 v83, 4, v0
    v_add_u32 v83, 158720, v83
    ds_write_b128 v83, v[96:99]
    v_mul_u32_u24 v83, 16, v87
    s_mul_i32 s66, s101, 512
    s_add_u32 s66, s66, 158720
    v_add_u32 v83, s66, v83
    s_waitcnt lgkmcnt(0)
    s_barrier
    ds_read_b64 v[100:101], v83 offset:0
    ds_read_b64 v[102:103], v83 offset:8
    v_mov_b32 v90, 0
    v_mov_b32 v91, 0
    v_mov_b32 v92, 0
    v_mov_b32 v93, 0
    v_mov_b32 v94, 0
    v_mov_b32 v95, 0
    v_mov_b32 v96, 0
    v_mov_b32 v97, 0
    s_waitcnt vmcnt(3)
    v_lshlrev_b32 v200, 16, v160
    v_and_b32 v201, 0xffff0000, v160
    s_waitcnt lgkmcnt(1)
    v_pk_fma_f32 v[90:91], v[200:201], v[100:101], v[90:91] op_sel:[0,0,0] op_sel_hi:[1,0,1]
    v_lshlrev_b32 v202, 16, v161
    v_and_b32 v203, 0xffff0000, v161
    v_pk_fma_f32 v[92:93], v[202:203], v[100:101], v[92:93] op_sel:[0,0,0] op_sel_hi:[1,0,1]
    v_lshlrev_b32 v200, 16, v162
    v_and_b32 v201, 0xffff0000, v162
    v_pk_fma_f32 v[94:95], v[200:201], v[100:101], v[94:95] op_sel:[0,0,0] op_sel_hi:[1,0,1]
    v_lshlrev_b32 v202, 16, v163
    v_and_b32 v203, 0xffff0000, v163
    v_pk_fma_f32 v[96:97], v[202:203], v[100:101], v[96:97] op_sel:[0,0,0] op_sel_hi:[1,0,1]
    s_waitcnt vmcnt(2)
    v_lshlrev_b32 v200, 16, v164
    v_and_b32 v201, 0xffff0000, v164
    v_pk_fma_f32 v[90:91], v[200:201], v[100:101], v[90:91] op_sel:[0,1,0] op_sel_hi:[1,1,1]
    v_lshlrev_b32 v202, 16, v165
    v_and_b32 v203, 0xffff0000, v165
    v_pk_fma_f32 v[92:93], v[202:203], v[100:101], v[92:93] op_sel:[0,1,0] op_sel_hi:[1,1,1]
    v_lshlrev_b32 v200, 16, v166
    v_and_b32 v201, 0xffff0000, v166
    v_pk_fma_f32 v[94:95], v[200:201], v[100:101], v[94:95] op_sel:[0,1,0] op_sel_hi:[1,1,1]
    v_lshlrev_b32 v202, 16, v167
    v_and_b32 v203, 0xffff0000, v167
    v_pk_fma_f32 v[96:97], v[202:203], v[100:101], v[96:97] op_sel:[0,1,0] op_sel_hi:[1,1,1]
    s_waitcnt vmcnt(1)
    v_lshlrev_b32 v200, 16, v168
    v_and_b32 v201, 0xffff0000, v168
    s_waitcnt lgkmcnt(0)
    v_pk_fma_f32 v[90:91], v[200:201], v[102:103], v[90:91] op_sel:[0,0,0] op_sel_hi:[1,0,1]
    v_lshlrev_b32 v202, 16, v169
    v_and_b32 v203, 0xffff0000, v169
    v_pk_fma_f32 v[92:93], v[202:203], v[102:103], v[92:93] op_sel:[0,0,0] op_sel_hi:[1,0,1]
    v_lshlrev_b32 v200, 16, v170
    v_and_b32 v201, 0xffff0000, v170
    v_pk_fma_f32 v[94:95], v[200:201], v[102:103], v[94:95] op_sel:[0,0,0] op_sel_hi:[1,0,1]
    v_lshlrev_b32 v202, 16, v171
    v_and_b32 v203, 0xffff0000, v171
    v_pk_fma_f32 v[96:97], v[202:203], v[102:103], v[96:97] op_sel:[0,0,0] op_sel_hi:[1,0,1]
    s_waitcnt vmcnt(0)
    v_lshlrev_b32 v200, 16, v172
    v_and_b32 v201, 0xffff0000, v172
    v_pk_fma_f32 v[90:91], v[200:201], v[102:103], v[90:91] op_sel:[0,1,0] op_sel_hi:[1,1,1]
    v_lshlrev_b32 v202, 16, v173
    v_and_b32 v203, 0xffff0000, v173
    v_pk_fma_f32 v[92:93], v[202:203], v[102:103], v[92:93] op_sel:[0,1,0] op_sel_hi:[1,1,1]
    v_lshlrev_b32 v200, 16, v174
    v_and_b32 v201, 0xffff0000, v174
    v_pk_fma_f32 v[94:95], v[200:201], v[102:103], v[94:95] op_sel:[0,1,0] op_sel_hi:[1,1,1]
    v_lshlrev_b32 v202, 16, v175
    v_and_b32 v203, 0xffff0000, v175
    v_pk_fma_f32 v[96:97], v[202:203], v[102:103], v[96:97] op_sel:[0,1,0] op_sel_hi:[1,1,1]
    v_add_f32_dpp v100, v90, v90 row_ror:8 row_mask:0xf bank_mask:0xf
    v_add_f32_dpp v101, v91, v91 row_ror:8 row_mask:0xf bank_mask:0xf
    v_add_f32_dpp v102, v92, v92 row_ror:8 row_mask:0xf bank_mask:0xf
    v_add_f32_dpp v103, v93, v93 row_ror:8 row_mask:0xf bank_mask:0xf
    v_add_f32_dpp v104, v94, v94 row_ror:8 row_mask:0xf bank_mask:0xf
    v_add_f32_dpp v105, v95, v95 row_ror:8 row_mask:0xf bank_mask:0xf
    v_add_f32_dpp v106, v96, v96 row_ror:8 row_mask:0xf bank_mask:0xf
    v_add_f32_dpp v107, v97, v97 row_ror:8 row_mask:0xf bank_mask:0xf
    v_permlane16_swap_b32 v100, v104
    v_permlane16_swap_b32 v101, v105
    v_permlane16_swap_b32 v102, v106
    v_permlane16_swap_b32 v103, v107
    v_add_f32 v100, v100, v104
    v_add_f32 v101, v101, v105
    v_add_f32 v102, v102, v106
    v_add_f32 v103, v103, v107
    s_nop 0
    v_permlane32_swap_b32 v100, v102
    v_permlane32_swap_b32 v101, v103
    v_bfe_u32 v83, v1, 4, 1
    v_lshlrev_b32 v83, 4, v83
    v_bfe_u32 v84, v1, 5, 1
    v_lshl_add_u32 v83, v84, 3, v83
    v_lshl_add_u32 v83, v89, 5, v83
    s_lshl_b32 s64, s46, 8
    s_add_u32 s64, s64, 162816
    v_add_u32 v83, s64, v83
    v_add_f32 v100, v100, v102
    v_add_f32 v101, v101, v103
    ds_write_b64 v83, v[100:101]
    v_and_b32 v83, 15, v1
    v_lshlrev_b32 v83, 4, v83
    v_add_u32 v84, 162816, v83
    s_waitcnt lgkmcnt(0)
    s_barrier
    s_cmp_lg_u32 s46, 3
    s_cbranch_scc1 L_late1
    ds_read_b128 v[100:103], v84 offset:0
    ds_read_b128 v[104:107], v84 offset:256
    ds_read_b128 v[108:111], v84 offset:512
    ds_read_b128 v[112:115], v84 offset:768
    s_lshl_b32 s64, s49, 8
    s_mul_i32 s65, s101, 10240
    s_add_u32 s64, s64, s65
    s_add_u32 s64, s64, 125952
    v_mov_b32 v85, 0xff
    s_waitcnt lgkmcnt(2)
    v_add_f32 v100, v100, v104
    s_waitcnt lgkmcnt(0)
    v_add_f32 v108, v108, v112
    v_add_f32 v101, v101, v105
    v_add_f32 v109, v109, v113
    v_add_f32 v102, v102, v106
    v_add_f32 v110, v110, v114
    v_add_f32 v103, v103, v107
    v_add_f32 v111, v111, v115
    v_add_f32 v100, v100, v108
    v_add_f32 v101, v101, v109
    v_add_f32 v102, v102, v110
    v_add_f32 v103, v103, v111
    v_bfi_b32 v100, v85, s40, v100
    v_bfi_b32 v101, v85, s41, v101
    v_bfi_b32 v102, v85, s42, v102
    v_bfi_b32 v103, v85, s43, v103
    s_mov_b64 exec, 0xffff
    buffer_store_dwordx4 v[100:103], v83, s[28:31], s64 offen sc1
    s_mov_b64 exec, -1
    s_nop 1
L_late1:
L_c2:
    s_cmp_lg_u32 s46, 0
    s_cbranch_scc1 L_kvseen
    s_lshl_b32 s60, s44, 8
    s_add_u32 s60, s60, 8192
    v_lshrrev_b32 v3, 2, v1
    s_min_u32 s61, s44, 2
    v_min_u32 v3, s61, v3
    s_lshl_b32 s61, s61, 8
    s_sub_u32 s60, s60, s61
    v_lshlrev_b32 v3, 8, v3
    v_bfe_u32 v4, v1, 1, 1
    v_lshl_add_u32 v3, v4, 7, v3
    v_and_b32 v4, 1, v1
    v_lshl_add_u32 v3, v4, 2, v3
    s_lshl_b32 s61, s51, 4
    s_lshl_b32 s62, s50, 3
    s_add_u32 s61, s61, s62
    v_add_u32 v3, s61, v3
    s_min_u32 s61, s44, 2
    s_lshl_b32 s61, s61, 8
    v_and_b32 v4, 15, v1
    v_lshlrev_b32 v4, 4, v4
    v_add_u32 v4, s61, v4
    v_cndmask_b32 v3, v3, v4, s[56:57]
    s_mov_b32 s54, 32768
Lp13:
    buffer_load_dword v4, v3, s[28:31], s60 offen offset:0 sc1
    s_waitcnt vmcnt(0)
    v_cmp_ne_u32 vcc, s47, v4
    s_cbranch_vccz Lpd14
    s_sub_u32 s54, s54, 1
    s_cbranch_scc0 Lp13
Lpd14:
L_kvseen:
    s_lshl_b32 s62, s44, 4
    s_add_u32 s62, s62, s51
    s_lshl_b32 s62, s62, 2
    s_lshl_b32 s60, s50, 1
    s_add_u32 s62, s62, s60
    s_add_u32 s62, s62, s52
    s_mul_i32 s62, s62, 6144
    s_mul_i32 s60, s53, 3072
    s_add_u32 s62, s62, s60
    s_add_u32 s62, s62, 4194304
    s_sub_u32 s63, s62, 393216
    s_cmp_ge_u32 s44, 1
    s_cselect_b32 s63, s63, 1073741824
    s_sub_u32 s64, s62, 786432
    s_cmp_ge_u32 s44, 2
    s_cselect_b32 s64, s64, 1073741824
    s_mul_i32 s61, s52, 18432
    s_add_u32 s61, s61, s60
    v_add_u32 v32, 73728, v21
    v_add_u32 v33, 73728, v22
    s_waitcnt lgkmcnt(0)
    ds_read_b128 v[144:147], v32 offset:0
    ds_read_b64 v[148:149], v33 offset:0
    ds_read_b128 v[152:155], v32 offset:6144
    ds_read_b64 v[156:157], v33 offset:6144
    s_mul_i32 s65, s46, 2560
    s_mul_i32 s66, s51, 320
    s_add_u32 s65, s65, s66
    s_add_u32 s65, s65, 131072
    s_barrier
    s_add_u32 m0, s61, 0
    s_nop 0
    buffer_load_dwordx4 v2, s[28:31], s64 offen offset:0 sc1 lds
    buffer_load_dwordx4 v2, s[28:31], s64 offen offset:1024 sc1 lds
    buffer_load_dwordx4 v2, s[28:31], s64 offen offset:2048 sc1 lds
    s_add_u32 m0, s61, 6144
    s_nop 0
    buffer_load_dwordx4 v2, s[28:31], s63 offen offset:0 sc1 lds
    buffer_load_dwordx4 v2, s[28:31], s63 offen offset:1024 sc1 lds
    buffer_load_dwordx4 v2, s[28:31], s63 offen offset:2048 sc1 lds
    s_add_u32 m0, s61, 12288
    s_nop 0
    buffer_load_dwordx4 v2, s[28:31], s62 offen offset:0 sc1 lds
    buffer_load_dwordx4 v2, s[28:31], s62 offen offset:1024 sc1 lds
    buffer_load_dwordx4 v2, s[28:31], s62 offen offset:2048 sc1 lds
    s_add_u32 m0, s61, 36864
    s_add_u32 s64, s64, 196608
    buffer_load_dwordx4 v2, s[28:31], s64 offen offset:0 sc1 lds
    buffer_load_dwordx4 v2, s[28:31], s64 offen offset:1024 sc1 lds
    buffer_load_dwordx4 v2, s[28:31], s64 offen offset:2048 sc1 lds
    s_add_u32 m0, s61, 43008
    s_add_u32 s63, s63, 196608
    buffer_load_dwordx4 v2, s[28:31], s63 offen offset:0 sc1 lds
    buffer_load_dwordx4 v2, s[28:31], s63 offen offset:1024 sc1 lds
    buffer_load_dwordx4 v2, s[28:31], s63 offen offset:2048 sc1 lds
    s_add_u32 m0, s61, 49152
    s_add_u32 s62, s62, 196608
    buffer_load_dwordx4 v2, s[28:31], s62 offen offset:0 sc1 lds
    buffer_load_dwordx4 v2, s[28:31], s62 offen offset:1024 sc1 lds
    buffer_load_dwordx4 v2, s[28:31], s62 offen offset:2048 sc1 lds
    v_mov_b32 v34, 0x3f80
    s_waitcnt lgkmcnt(2)
    v_cndmask_b32 v148, v148, v34, s[56:57]
    v_cndmask_b32 v149, v149, 0, s[56:57]
    s_waitcnt lgkmcnt(0)
    v_cndmask_b32 v156, v156, v34, s[56:57]
    v_cndmask_b32 v157, v157, 0, s[56:57]
    s_cmp_eq_u32 s46, 2
    s_cselect_b32 s67, 1.0, 0
    s_mov_b32 s68, 0xbfb8aa3b
    s_cmp_eq_u32 s46, 0
    s_cselect_b32 s68, 1.0, s68
    s_cmp_eq_u32 s46, 3
    s_cselect_b32 s68, 0xbf317218, s68
    s_mov_b32 s32, s4
    s_mov_b32 s33, s5
    s_mov_b32 s34, 0x280000
    s_mov_b32 s35, 0x20000
    s_mul_i32 s72, s51, 20
    s_add_u32 s72, s72, s46
    s_lshl_b32 s69, s72, 2
    s_mul_i32 s72, s72, 5120
    s_add_u32 s72, s72, 25165824
    s_mul_i32 s73, s46, 5120
    s_mul_i32 s76, s45, 245760
    s_mul_i32 s70, s46, 3072
    s_add_u32 s76, s76, s70
    s_add_u32 s76, s76, 28311552
    v_min_u32 v35, 9, v1
    v_lshlrev_b32 v35, 4, v35
    s_mul_i32 s70, s45, 160
    s_lshl_b32 s60, s46, 2
    s_add_u32 s70, s70, s60
    v_add_u32 v35, s70, v35
    v_subrev_u32 v36, 10, v1
    v_lshlrev_b32 v36, 4, v36
    s_add_u32 s69, s69, 4096
    v_add_u32 v36, s69, v36
    v_cmp_lt_u32 s[58:59], 9, v1
    s_nop 1
    v_cndmask_b32 v35, v35, v36, s[58:59]
    v_min_u32 v36, 26, v1
    v_subrev_u32 v36, 15, v36
    v_lshlrev_b32 v36, 3, v36
    s_mul_i32 s69, s51, 48
    s_mul_i32 s70, s52, 24
    s_add_u32 s69, s69, s70
    s_add_u32 s69, s69, s53
    s_lshl_b32 s69, s69, 2
    s_add_u32 s69, s69, 8192
    v_add_u32 v36, s69, v36
    v_cmp_lt_u32 s[58:59], 14, v1
    s_nop 1
    v_cndmask_b32 v35, v35, v36, s[58:59]
    s_mov_b32 s70, 32768
    s_waitcnt vmcnt(9)
    s_cmp_ge_u32 s44, 2
    s_cbranch_scc1 L_noinv
    v_mul_u32_u24 v3, 48, v1
    v_add_u32 v3, s61, v3
    v_mov_b32 v8, 0x3f80f149
    v_mov_b32 v9, 0x3f803f80
    ds_write_b64 v3, v[8:9] offset:40
    s_cmp_ge_u32 s44, 1
    s_cbranch_scc1 L_noinv
    ds_write_b64 v3, v[8:9] offset:6184
L_noinv:
    s_waitcnt lgkmcnt(0)
    s_barrier
    s_cmp_lg_u32 s46, 1
    s_cbranch_scc1 Lct15
    s_getpc_b64 s[58:59]
Lpc16:
    s_add_u32 s58, s58, L_c3-Lpc16
    s_addc_u32 s59, s59, 0
    s_lshr_b32 s100, s2, 3
    v_lshl_add_u32 v204, v1, 5, s100
    v_lshlrev_b32 v204, 7, v204
    v_min_u32 v204, L_last-L_c3, v204
    s_mov_b64 exec, 31
    global_load_dword v205, v204, s[58:59]
    s_mov_b64 exec, -1
Lct15:
    s_lshl_b32 s69, s44, 3
    s_add_u32 s69, s69, s51
    s_lshl_b32 s69, s69, 3
    s_lshl_b32 s60, s50, 2
    s_add_u32 s69, s69, s60
    s_add_u32 s69, s69, s46
    s_lshl_b32 s69, s69, 8
    s_add_u32 s69, s69, 327680
    v_lshlrev_b32 v32, 2, v1
    buffer_load_dword v36, v35, s[28:31], s70 offen sc1
    ds_read_b128 a[0:3], v21 offset:0
    ds_read_b64 a[4:5], v22 offset:0
    ds_read_b128 a[8:11], v21 offset:1536
    ds_read_b64 a[12:13], v22 offset:1536
    ds_read_b128 a[16:19], v21 offset:3072
    ds_read_b64 a[20:21], v22 offset:3072
    ds_read_b128 a[24:27], v21 offset:4608
    ds_read_b64 a[28:29], v22 offset:4608
    s_waitcnt lgkmcnt(4)
    v_mfma_f32_32x32x16_bf16 v[40:55], a[0:3], v[144:147], v[224:239]
    ds_read_b128 a[32:35], v21 offset:6144
    ds_read_b64 a[36:37], v22 offset:6144
    v_mfma_f32_32x32x8_bf16 v[40:55], a[4:5], v[148:149], v[40:55]
    v_mfma_f32_32x32x16_bf16 v[56:71], a[8:11], v[144:147], 0
    ds_read_b128 a[40:43], v21 offset:7680
    ds_read_b64 a[44:45], v22 offset:7680
    v_mfma_f32_32x32x8_bf16 v[56:71], a[12:13], v[148:149], v[56:71]
    s_waitcnt lgkmcnt(4)
    v_mfma_f32_32x32x16_bf16 v[72:87], a[16:19], v[144:147], 0
    ds_read_b128 a[48:51], v21 offset:9216
    ds_read_b64 a[52:53], v22 offset:9216
    s_nop 3
    v_max_f32 v8, v40, v41
    v_max_f32 v9, v42, v43
    v_max3_f32 v8, v44, v45, v8
    v_max3_f32 v9, v46, v47, v9
    v_mfma_f32_32x32x8_bf16 v[72:87], a[20:21], v[148:149], v[72:87]
    v_max3_f32 v8, v48, v49, v8
    v_max3_f32 v9, v50, v51, v9
    v_max3_f32 v8, v52, v53, v8
    v_max3_f32 v9, v54, v55, v9
    v_mfma_f32_32x32x16_bf16 v[40:55], a[24:27], v[144:147], 0
    ds_read_b128 a[56:59], v21 offset:10752
    ds_read_b64 a[60:61], v22 offset:10752
    v_max3_f32 v8, v56, v57, v8
    v_max3_f32 v9, v58, v59, v9
    v_max3_f32 v8, v60, v61, v8
    v_max3_f32 v9, v62, v63, v9
    v_mfma_f32_32x32x8_bf16 v[40:55], a[28:29], v[148:149], v[40:55]
    v_max3_f32 v8, v64, v65, v8
    v_max3_f32 v9, v66, v67, v9
    v_max3_f32 v8, v68, v69, v8
    v_max3_f32 v9, v70, v71, v9
    s_waitcnt lgkmcnt(4)
    v_mfma_f32_32x32x16_bf16 v[56:71], a[32:35], v[144:147], 0
    ds_read_b128 a[64:67], v21 offset:12288
    ds_read_b64 a[68:69], v22 offset:12288
    v_max3_f32 v8, v72, v73, v8
    v_max3_f32 v9, v74, v75, v9
    v_max3_f32 v8, v76, v77, v8
    v_max3_f32 v9, v78, v79, v9
    v_mfma_f32_32x32x8_bf16 v[56:71], a[36:37], v[148:149], v[56:71]
    v_max3_f32 v8, v80, v81, v8
    v_max3_f32 v9, v82, v83, v9
    v_max3_f32 v8, v84, v85, v8
    v_max3_f32 v9, v86, v87, v9
    v_mfma_f32_32x32x16_bf16 v[72:87], a[40:43], v[144:147], 0
    buffer_load_dwordx2 v[240:241], v25, s[32:35], s71 offen offset:0
    v_max3_f32 v8, v40, v41, v8
    v_max3_f32 v9, v42, v43, v9
    v_max3_f32 v8, v44, v45, v8
    v_max3_f32 v9, v46, v47, v9
    v_mfma_f32_32x32x8_bf16 v[72:87], a[44:45], v[148:149], v[72:87]
    v_max3_f32 v8, v48, v49, v8
    v_max3_f32 v9, v50, v51, v9
    v_max3_f32 v8, v52, v53, v8
    v_max3_f32 v9, v54, v55, v9
    s_waitcnt lgkmcnt(2)
    v_mfma_f32_32x32x16_bf16 v[40:55], a[48:51], v[144:147], 0
    buffer_load_dwordx2 v[242:243], v25, s[32:35], s71 offen offset:32
    v_max3_f32 v8, v56, v57, v8
    v_max3_f32 v9, v58, v59, v9
    v_max3_f32 v8, v60, v61, v8
    v_max3_f32 v9, v62, v63, v9
    v_mfma_f32_32x32x8_bf16 v[40:55], a[52:53], v[148:149], v[40:55]
    v_max3_f32 v8, v64, v65, v8
    v_max3_f32 v9, v66, v67, v9
    v_max3_f32 v8, v68, v69, v8
    v_max3_f32 v9, v70, v71, v9
    v_mfma_f32_32x32x16_bf16 v[56:71], a[56:59], v[144:147], 0
    v_max3_f32 v8, v72, v73, v8
    v_max3_f32 v9, v74, v75, v9
    v_max3_f32 v8, v76, v77, v8
    v_max3_f32 v9, v78, v79, v9
    v_mfma_f32_32x32x8_bf16 v[56:71], a[60:61], v[148:149], v[56:71]
    v_max3_f32 v8, v80, v81, v8
    v_max3_f32 v9, v82, v83, v9
    v_max3_f32 v8, v84, v85, v8
    v_max3_f32 v9, v86, v87, v9
    s_waitcnt lgkmcnt(0)
    v_mfma_f32_32x32x16_bf16 v[72:87], a[64:67], v[144:147], v[208:223]
    buffer_load_dwordx2 v[244:245], v25, s[32:35], s71 offen offset:64
    v_max3_f32 v8, v40, v41, v8
    v_max3_f32 v9, v42, v43, v9
    v_max3_f32 v8, v44, v45, v8
    v_max3_f32 v9, v46, v47, v9
    v_mfma_f32_32x32x8_bf16 v[72:87], a[68:69], v[148:149], v[72:87]
    v_max3_f32 v8, v48, v49, v8
    v_max3_f32 v9, v50, v51, v9
    v_max3_f32 v8, v52, v53, v8
    v_max3_f32 v9, v54, v55, v9
    s_waitcnt vmcnt(4)
    s_barrier
    s_waitcnt vmcnt(3)
    v_cmp_ne_u32 vcc, s47, v36
    s_cbranch_vccnz Lrs17
Lrj18:
    v_mfma_f32_32x32x16_bf16 v[40:55], a[0:3], v[144:147], v[224:239]
    ds_read_b64_tr_b16 v[128:129], v23 offset:0
    ds_read_b64_tr_b16 v[130:131], v23 offset:384
    ds_read_b64_tr_b16 v[132:133], v23 offset:768
    ds_read_b64_tr_b16 v[134:135], v23 offset:1152
    v_max3_f32 v8, v56, v57, v8
    v_max3_f32 v9, v58, v59, v9
    v_max3_f32 v8, v60, v61, v8
    v_max3_f32 v9, v62, v63, v9
    v_max3_f32 v8, v64, v65, v8
    v_max3_f32 v9, v66, v67, v9
    v_max3_f32 v8, v68, v69, v8
    v_max3_f32 v9, v70, v71, v9
    v_mfma_f32_32x32x16_bf16 v[56:71], a[8:11], v[144:147], 0
    v_max3_f32 v8, v72, v73, v8
    v_max3_f32 v9, v74, v75, v9
    v_max3_f32 v8, v76, v77, v8
    v_max3_f32 v9, v78, v79, v9
    v_max3_f32 v8, v80, v81, v8
    v_max3_f32 v9, v82, v83, v9
    v_max3_f32 v8, v84, v85, v8
    v_max3_f32 v9, v86, v87, v9
    v_max_f32 v8, v8, v9
    v_mov_b32 v9, v8
    s_nop 1
    v_permlane32_swap_b32 v8, v9
    v_max_f32 v8, v8, v9
    v_sub_f32 v8, 0, v8
    v_and_b32 v9, 0xffff0000, v8
    v_sub_f32 v8, v8, v9
    v_or_b32 v9, 0x3f80, v9
    v_and_b32 v3, 0xffff0000, v8
    v_sub_f32 v8, v8, v3
    v_lshrrev_b32 v3, 16, v3
    v_and_b32 v8, 0xffff0000, v8
    v_or_b32 v8, v8, v3
    v_cndmask_b32 v148, v148, v9, s[56:57]
    v_cndmask_b32 v149, v149, v8, s[56:57]
    s_nop 1
    v_mfma_f32_32x32x8_bf16 v[40:55], a[4:5], v[148:149], v[40:55]
    v_mfma_f32_32x32x8_bf16 v[56:71], a[12:13], v[148:149], v[56:71]
    s_nop 10
    v_exp_f32 v40, v40
    v_exp_f32 v41, v41
    v_exp_f32 v42, v42
    v_exp_f32 v43, v43
    ds_read_b64_tr_b16 v[136:137], v23 offset:1536
    ds_read_b64_tr_b16 v[138:139], v23 offset:1920
    buffer_load_dwordx2 v[246:247], v25, s[32:35], s71 offen offset:96
    v_mfma_f32_32x32x16_bf16 v[72:87], a[16:19], v[144:147], 0
    v_exp_f32 v44, v44
    v_exp_f32 v45, v45
    v_exp_f32 v46, v46
    v_exp_f32 v47, v47
    v_cvt_pk_bf16_f32 v120, v40, v41
    v_cvt_pk_bf16_f32 v121, v42, v43
    v_cvt_pk_bf16_f32 v122, v44, v45
    v_cvt_pk_bf16_f32 v123, v46, v47
    ds_read_b64_tr_b16 v[140:141], v23 offset:2304
    ds_read_b64_tr_b16 v[142:143], v23 offset:2688
    s_waitcnt lgkmcnt(6)
    v_mfma_f32_32x32x16_bf16 v[88:103], v[128:131], v[120:123], 0
    buffer_load_dwordx2 v[248:249], v25, s[32:35], s71 offen offset:128
    v_exp_f32 v48, v48
    v_exp_f32 v49, v49
    v_exp_f32 v50, v50
    v_exp_f32 v51, v51
    v_mfma_f32_32x32x8_bf16 v[72:87], a[20:21], v[148:149], v[72:87]
    v_exp_f32 v52, v52
    v_exp_f32 v53, v53
    v_exp_f32 v54, v54
    v_exp_f32 v55, v55
    v_cvt_pk_bf16_f32 v124, v48, v49
    v_cvt_pk_bf16_f32 v125, v50, v51
    v_cvt_pk_bf16_f32 v126, v52, v53
    v_cvt_pk_bf16_f32 v127, v54, v55
    buffer_load_dword v33, v32, s[28:31], s69 offen
    s_waitcnt lgkmcnt(4)
    v_mfma_f32_32x32x16_bf16 v[88:103], v[132:135], v[124:127], v[88:103]
    v_exp_f32 v56, v56
    v_exp_f32 v57, v57
    v_exp_f32 v58, v58
    v_exp_f32 v59, v59
    ds_read_b64_tr_b16 v[128:129], v23 offset:3072
    ds_read_b64_tr_b16 v[130:131], v23 offset:3456
    v_mfma_f32_32x32x16_bf16 v[40:55], a[24:27], v[144:147], 0
    v_exp_f32 v60, v60
    v_exp_f32 v61, v61
    v_exp_f32 v62, v62
    v_exp_f32 v63, v63
    v_cvt_pk_bf16_f32 v120, v56, v57
    v_cvt_pk_bf16_f32 v121, v58, v59
    v_cvt_pk_bf16_f32 v122, v60, v61
    v_cvt_pk_bf16_f32 v123, v62, v63
    ds_read_b64_tr_b16 v[132:133], v23 offset:3840
    ds_read_b64_tr_b16 v[134:135], v23 offset:4224
    s_waitcnt lgkmcnt(6)
    v_mfma_f32_32x32x16_bf16 v[88:103], v[136:139], v[120:123], v[88:103]
    s_add_u32 m0, s73, 73728
    s_nop 0
    buffer_load_dwordx4 v2, s[28:31], s72 offen offset:0 sc1 lds
    v_exp_f32 v64, v64
    v_exp_f32 v65, v65
    v_exp_f32 v66, v66
    v_exp_f32 v67, v67
    v_mfma_f32_32x32x8_bf16 v[40:55], a[28:29], v[148:149], v[40:55]
    v_exp_f32 v68, v68
    v_exp_f32 v69, v69
    v_exp_f32 v70, v70
    v_exp_f32 v71, v71
    v_cvt_pk_bf16_f32 v124, v64, v65
    v_cvt_pk_bf16_f32 v125, v66, v67
    v_cvt_pk_bf16_f32 v126, v68, v69
    v_cvt_pk_bf16_f32 v127, v70, v71
    buffer_load_dwordx4 v2, s[28:31], s72 offen offset:1024 sc1 lds
    s_waitcnt lgkmcnt(4)
    v_mfma_f32_32x32x16_bf16 v[88:103], v[140:143], v[124:127], v[88:103]
    v_exp_f32 v72, v72
    v_exp_f32 v73, v73
    v_exp_f32 v74, v74
    v_exp_f32 v75, v75
    ds_read_b64_tr_b16 v[136:137], v23 offset:4608
    ds_read_b64_tr_b16 v[138:139], v23 offset:4992
    buffer_load_dwordx4 v2, s[28:31], s72 offen offset:2048 sc1 lds
    v_mfma_f32_32x32x16_bf16 v[56:71], a[32:35], v[144:147], 0
    v_exp_f32 v76, v76
    v_exp_f32 v77, v77
    v_exp_f32 v78, v78
    v_exp_f32 v79, v79
    v_cvt_pk_bf16_f32 v120, v72, v73
    v_cvt_pk_bf16_f32 v121, v74, v75
    v_cvt_pk_bf16_f32 v122, v76, v77
    v_cvt_pk_bf16_f32 v123, v78, v79
    ds_read_b64_tr_b16 v[140:141], v23 offset:5376
    ds_read_b64_tr_b16 v[142:143], v23 offset:5760
    s_waitcnt lgkmcnt(6)
    v_mfma_f32_32x32x16_bf16 v[88:103], v[128:131], v[120:123], v[88:103]
    v_exp_f32 v80, v80
    v_exp_f32 v81, v81
    v_exp_f32 v82, v82
    v_exp_f32 v83, v83
    v_mfma_f32_32x32x8_bf16 v[56:71], a[36:37], v[148:149], v[56:71]
    buffer_load_dwordx4 v2, s[28:31], s72 offen offset:3072 sc1 lds
    v_exp_f32 v84, v84
    v_exp_f32 v85, v85
    v_exp_f32 v86, v86
    v_exp_f32 v87, v87
    v_cvt_pk_bf16_f32 v124, v80, v81
    v_cvt_pk_bf16_f32 v125, v82, v83
    v_cvt_pk_bf16_f32 v126, v84, v85
    v_cvt_pk_bf16_f32 v127, v86, v87
    s_waitcnt lgkmcnt(4)
    s_nop 0
    v_mfma_f32_32x32x16_bf16 v[88:103], v[132:135], v[124:127], v[88:103]
    v_exp_f32 v40, v40
    v_exp_f32 v41, v41
    v_exp_f32 v42, v42
    v_exp_f32 v43, v43
    ds_read_b64_tr_b16 v[128:129], v23 offset:6144
    ds_read_b64_tr_b16 v[130:131], v23 offset:6528
    s_add_u32 m0, s73, 77824
    s_add_u32 s72, s72, 4096
    buffer_load_dwordx4 v2, s[28:31], s72 offen offset:0 sc1 lds
    s_add_u32 s72, s72, 16384
    v_mfma_f32_32x32x16_bf16 v[72:87], a[40:43], v[144:147], 0
    v_exp_f32 v44, v44
    v_exp_f32 v45, v45
    v_exp_f32 v46, v46
    v_exp_f32 v47, v47
    v_cvt_pk_bf16_f32 v120, v40, v41
    v_cvt_pk_bf16_f32 v121, v42, v43
    v_cvt_pk_bf16_f32 v122, v44, v45
    v_cvt_pk_bf16_f32 v123, v46, v47
    ds_read_b64_tr_b16 v[132:133], v23 offset:6912
    ds_read_b64_tr_b16 v[134:135], v23 offset:7296
    s_waitcnt lgkmcnt(6)
    v_mfma_f32_32x32x16_bf16 v[88:103], v[136:139], v[120:123], v[88:103]
    s_add_u32 m0, s73, 94208
    s_nop 0
    buffer_load_dwordx4 v2, s[28:31], s72 offen offset:0 sc1 lds
    v_exp_f32 v48, v48
    v_exp_f32 v49, v49
    v_exp_f32 v50, v50
    v_exp_f32 v51, v51
    v_mfma_f32_32x32x8_bf16 v[72:87], a[44:45], v[148:149], v[72:87]
    v_exp_f32 v52, v52
    v_exp_f32 v53, v53
    v_exp_f32 v54, v54
    v_exp_f32 v55, v55
    v_cvt_pk_bf16_f32 v124, v48, v49
    v_cvt_pk_bf16_f32 v125, v50, v51
    v_cvt_pk_bf16_f32 v126, v52, v53
    v_cvt_pk_bf16_f32 v127, v54, v55
    buffer_load_dwordx4 v2, s[28:31], s72 offen offset:1024 sc1 lds
    s_waitcnt lgkmcnt(4)
    v_mfma_f32_32x32x16_bf16 v[88:103], v[140:143], v[124:127], v[88:103]
    v_exp_f32 v56, v56
    v_exp_f32 v57, v57
    v_exp_f32 v58, v58
    v_exp_f32 v59, v59
    ds_read_b64_tr_b16 v[136:137], v23 offset:7680
    ds_read_b64_tr_b16 v[138:139], v23 offset:8064
    v_mfma_f32_32x32x16_bf16 v[40:55], a[48:51], v[144:147], 0
    v_exp_f32 v60, v60
    v_exp_f32 v61, v61
    v_exp_f32 v62, v62
    v_exp_f32 v63, v63
    v_cvt_pk_bf16_f32 v120, v56, v57
    v_cvt_pk_bf16_f32 v121, v58, v59
    v_cvt_pk_bf16_f32 v122, v60, v61
    v_cvt_pk_bf16_f32 v123, v62, v63
    ds_read_b64_tr_b16 v[140:141], v23 offset:8448
    ds_read_b64_tr_b16 v[142:143], v23 offset:8832
    s_waitcnt lgkmcnt(6)
    v_mfma_f32_32x32x16_bf16 v[88:103], v[128:131], v[120:123], v[88:103]
    buffer_load_dwordx4 v2, s[28:31], s72 offen offset:2048 sc1 lds
    v_exp_f32 v64, v64
    v_exp_f32 v65, v65
    v_exp_f32 v66, v66
    v_exp_f32 v67, v67
    v_mfma_f32_32x32x8_bf16 v[40:55], a[52:53], v[148:149], v[40:55]
    buffer_load_dwordx4 v2, s[28:31], s72 offen offset:3072 sc1 lds
    v_exp_f32 v68, v68
    v_exp_f32 v69, v69
    v_exp_f32 v70, v70
    v_exp_f32 v71, v71
    v_cvt_pk_bf16_f32 v124, v64, v65
    v_cvt_pk_bf16_f32 v125, v66, v67
    v_cvt_pk_bf16_f32 v126, v68, v69
    v_cvt_pk_bf16_f32 v127, v70, v71
    s_waitcnt lgkmcnt(4)
    s_nop 0
    v_mfma_f32_32x32x16_bf16 v[88:103], v[132:135], v[124:127], v[88:103]
    v_exp_f32 v72, v72
    v_exp_f32 v73, v73
    v_exp_f32 v74, v74
    v_exp_f32 v75, v75
    ds_read_b64_tr_b16 v[128:129], v23 offset:9216
    ds_read_b64_tr_b16 v[130:131], v23 offset:9600
    s_add_u32 m0, s73, 98304
    s_add_u32 s72, s72, 4096
    buffer_load_dwordx4 v2, s[28:31], s72 offen offset:0 sc1 lds
    s_add_u32 s72, s72, 16384
    v_mfma_f32_32x32x16_bf16 v[56:71], a[56:59], v[144:147], 0
    v_exp_f32 v76, v76
    v_exp_f32 v77, v77
    v_exp_f32 v78, v78
    v_exp_f32 v79, v79
    v_cvt_pk_bf16_f32 v120, v72, v73
    v_cvt_pk_bf16_f32 v121, v74, v75
    v_cvt_pk_bf16_f32 v122, v76, v77
    v_cvt_pk_bf16_f32 v123, v78, v79
    ds_read_b64_tr_b16 v[132:133], v23 offset:9984
    ds_read_b64_tr_b16 v[134:135], v23 offset:10368
    s_waitcnt lgkmcnt(6)
    v_mfma_f32_32x32x16_bf16 v[88:103], v[136:139], v[120:123], v[88:103]
    v_exp_f32 v80, v80
    v_exp_f32 v81, v81
    v_exp_f32 v82, v82
    v_exp_f32 v83, v83
    v_mfma_f32_32x32x8_bf16 v[56:71], a[60:61], v[148:149], v[56:71]
    s_add_u32 m0, s73, 114688
    s_nop 0
    buffer_load_dwordx4 v2, s[28:31], s72 offen offset:0 sc1 lds
    v_exp_f32 v84, v84
    v_exp_f32 v85, v85
    v_exp_f32 v86, v86
    v_exp_f32 v87, v87
    v_cvt_pk_bf16_f32 v124, v80, v81
    v_cvt_pk_bf16_f32 v125, v82, v83
    v_cvt_pk_bf16_f32 v126, v84, v85
    v_cvt_pk_bf16_f32 v127, v86, v87
    buffer_load_dwordx4 v2, s[28:31], s72 offen offset:1024 sc1 lds
    s_waitcnt lgkmcnt(4)
    v_mfma_f32_32x32x16_bf16 v[88:103], v[140:143], v[124:127], v[88:103]
    v_exp_f32 v40, v40
    v_exp_f32 v41, v41
    v_exp_f32 v42, v42
    v_exp_f32 v43, v43
    ds_read_b64_tr_b16 v[136:137], v23 offset:10752
    ds_read_b64_tr_b16 v[138:139], v23 offset:11136
    v_mfma_f32_32x32x16_bf16 v[72:87], a[64:67], v[144:147], v[208:223]
    v_exp_f32 v44, v44
    v_exp_f32 v45, v45
    v_exp_f32 v46, v46
    v_exp_f32 v47, v47
    v_cvt_pk_bf16_f32 v120, v40, v41
    v_cvt_pk_bf16_f32 v121, v42, v43
    v_cvt_pk_bf16_f32 v122, v44, v45
    v_cvt_pk_bf16_f32 v123, v46, v47
    ds_read_b64_tr_b16 v[140:141], v23 offset:11520
    ds_read_b64_tr_b16 v[142:143], v23 offset:11904
    s_waitcnt lgkmcnt(6)
    v_mfma_f32_32x32x16_bf16 v[88:103], v[128:131], v[120:123], v[88:103]
    buffer_load_dwordx4 v2, s[28:31], s72 offen offset:2048 sc1 lds
    v_exp_f32 v48, v48
    v_exp_f32 v49, v49
    v_exp_f32 v50, v50
    v_exp_f32 v51, v51
    v_mfma_f32_32x32x8_bf16 v[72:87], a[68:69], v[148:149], v[72:87]
    v_exp_f32 v52, v52
    v_exp_f32 v53, v53
    v_exp_f32 v54, v54
    v_exp_f32 v55, v55
    v_cvt_pk_bf16_f32 v124, v48, v49
    v_cvt_pk_bf16_f32 v125, v50, v51
    v_cvt_pk_bf16_f32 v126, v52, v53
    v_cvt_pk_bf16_f32 v127, v54, v55
    buffer_load_dwordx4 v2, s[28:31], s72 offen offset:3072 sc1 lds
    s_waitcnt lgkmcnt(4)
    v_mfma_f32_32x32x16_bf16 v[88:103], v[132:135], v[124:127], v[88:103]
    v_exp_f32 v56, v56
    v_exp_f32 v57, v57
    v_exp_f32 v58, v58
    v_exp_f32 v59, v59
    ds_read_b64_tr_b16 v[128:129], v23 offset:12288
    ds_read_b64_tr_b16 v[130:131], v23 offset:12672
    s_add_u32 m0, s73, 118784
    s_add_u32 s72, s72, 4096
    buffer_load_dwordx4 v2, s[28:31], s72 offen offset:0 sc1 lds
    s_add_u32 s72, s72, 16384
    v_exp_f32 v60, v60
    v_exp_f32 v61, v61
    v_exp_f32 v62, v62
    v_exp_f32 v63, v63
    v_cvt_pk_bf16_f32 v120, v56, v57
    v_cvt_pk_bf16_f32 v121, v58, v59
    v_cvt_pk_bf16_f32 v122, v60, v61
    v_cvt_pk_bf16_f32 v123, v62, v63
    ds_read_b64_tr_b16 v[132:133], v23 offset:13056
    ds_read_b64_tr_b16 v[134:135], v23 offset:13440
    s_waitcnt lgkmcnt(6)
    v_mfma_f32_32x32x16_bf16 v[88:103], v[136:139], v[120:123], v[88:103]
    v_exp_f32 v64, v64
    v_exp_f32 v65, v65
    v_exp_f32 v66, v66
    v_exp_f32 v67, v67
    s_add_u32 m0, s73, 135168
    s_nop 0
    buffer_load_dwordx4 v2, s[28:31], s72 offen offset:0 sc1 lds
    v_exp_f32 v68, v68
    v_exp_f32 v69, v69
    v_exp_f32 v70, v70
    v_exp_f32 v71, v71
    v_cvt_pk_bf16_f32 v124, v64, v65
    v_cvt_pk_bf16_f32 v125, v66, v67
    v_cvt_pk_bf16_f32 v126, v68, v69
    v_cvt_pk_bf16_f32 v127, v70, v71
    s_waitcnt lgkmcnt(4)
    s_nop 0
    v_mfma_f32_32x32x16_bf16 v[88:103], v[140:143], v[124:127], v[88:103]
    v_exp_f32 v72, v72
    v_exp_f32 v73, v73
    v_exp_f32 v74, v74
    v_exp_f32 v75, v75
    buffer_load_dwordx4 v2, s[28:31], s72 offen offset:1024 sc1 lds
    v_exp_f32 v76, v76
    v_exp_f32 v77, v77
    v_exp_f32 v78, v78
    v_exp_f32 v79, v79
    v_cvt_pk_bf16_f32 v120, v72, v73
    v_cvt_pk_bf16_f32 v121, v74, v75
    v_cvt_pk_bf16_f32 v122, v76, v77
    v_cvt_pk_bf16_f32 v123, v78, v79
    s_waitcnt lgkmcnt(2)
    s_nop 0
    v_mfma_f32_32x32x16_bf16 v[88:103], v[128:131], v[120:123], v[88:103]
    buffer_load_dwordx4 v2, s[28:31], s72 offen offset:2048 sc1 lds
    v_exp_f32 v80, v80
    v_exp_f32 v81, v81
    v_exp_f32 v82, v82
    v_exp_f32 v83, v83
    v_exp_f32 v84, v84
    v_exp_f32 v85, v85
    v_exp_f32 v86, v86
    v_exp_f32 v87, v87
    v_cvt_pk_bf16_f32 v124, v80, v81
    v_cvt_pk_bf16_f32 v125, v82, v83
    v_cvt_pk_bf16_f32 v126, v84, v85
    v_cvt_pk_bf16_f32 v127, v86, v87
    buffer_load_dwordx4 v2, s[28:31], s72 offen offset:3072 sc1 lds
    s_waitcnt lgkmcnt(0)
    v_mfma_f32_32x32x16_bf16 v[88:103], v[132:135], v[124:127], v[88:103]
    ds_read_b128 a[0:3], v21 offset:18432
    ds_read_b64 a[4:5], v22 offset:18432
    ds_read_b128 a[8:11], v21 offset:19968
    ds_read_b64 a[12:13], v22 offset:19968
    ds_read_b128 a[16:19], v21 offset:21504
    ds_read_b64 a[20:21], v22 offset:21504
    ds_read_b128 a[24:27], v21 offset:23040
    ds_read_b64 a[28:29], v22 offset:23040
    s_waitcnt lgkmcnt(4)
    v_mfma_f32_32x32x16_bf16 v[40:55], a[0:3], v[152:155], v[224:239]
    ds_read_b128 a[32:35], v21 offset:24576
    ds_read_b64 a[36:37], v22 offset:24576
    v_mfma_f32_32x32x8_bf16 v[40:55], a[4:5], v[156:157], v[40:55]
    v_mfma_f32_32x32x16_bf16 v[56:71], a[8:11], v[152:155], 0
    ds_read_b128 a[40:43], v21 offset:26112
    ds_read_b64 a[44:45], v22 offset:26112
    v_mfma_f32_32x32x8_bf16 v[56:71], a[12:13], v[156:157], v[56:71]
    s_waitcnt lgkmcnt(4)
    v_mfma_f32_32x32x16_bf16 v[72:87], a[16:19], v[152:155], 0
    ds_read_b128 a[48:51], v21 offset:27648
    ds_read_b64 a[52:53], v22 offset:27648
    s_nop 3
    v_max_f32 v8, v40, v41
    v_max_f32 v9, v42, v43
    v_max3_f32 v8, v44, v45, v8
    v_max3_f32 v9, v46, v47, v9
    v_mfma_f32_32x32x8_bf16 v[72:87], a[20:21], v[156:157], v[72:87]
    v_max3_f32 v8, v48, v49, v8
    v_max3_f32 v9, v50, v51, v9
    v_max3_f32 v8, v52, v53, v8
    v_max3_f32 v9, v54, v55, v9
    v_mfma_f32_32x32x16_bf16 v[40:55], a[24:27], v[152:155], 0
    ds_read_b128 a[56:59], v21 offset:29184
    ds_read_b64 a[60:61], v22 offset:29184
    v_max3_f32 v8, v56, v57, v8
    v_max3_f32 v9, v58, v59, v9
    v_max3_f32 v8, v60, v61, v8
    v_max3_f32 v9, v62, v63, v9
    v_mfma_f32_32x32x8_bf16 v[40:55], a[28:29], v[156:157], v[40:55]
    v_max3_f32 v8, v64, v65, v8
    v_max3_f32 v9, v66, v67, v9
    v_max3_f32 v8, v68, v69, v8
    v_max3_f32 v9, v70, v71, v9
    s_waitcnt lgkmcnt(4)
    v_mfma_f32_32x32x16_bf16 v[56:71], a[32:35], v[152:155], 0
    ds_read_b128 a[64:67], v21 offset:30720
    ds_read_b64 a[68:69], v22 offset:30720
    v_max3_f32 v8, v72, v73, v8
    v_max3_f32 v9, v74, v75, v9
    v_max3_f32 v8, v76, v77, v8
    v_max3_f32 v9, v78, v79, v9
    v_mfma_f32_32x32x8_bf16 v[56:71], a[36:37], v[156:157], v[56:71]
    v_max3_f32 v8, v80, v81, v8
    v_max3_f32 v9, v82, v83, v9
    v_max3_f32 v8, v84, v85, v8
    v_max3_f32 v9, v86, v87, v9
    v_mfma_f32_32x32x16_bf16 v[72:87], a[40:43], v[152:155], 0
    v_max3_f32 v8, v40, v41, v8
    v_max3_f32 v9, v42, v43, v9
    v_max3_f32 v8, v44, v45, v8
    v_max3_f32 v9, v46, v47, v9
    v_mfma_f32_32x32x8_bf16 v[72:87], a[44:45], v[156:157], v[72:87]
    v_max3_f32 v8, v48, v49, v8
    v_max3_f32 v9, v50, v51, v9
    v_max3_f32 v8, v52, v53, v8
    v_max3_f32 v9, v54, v55, v9
    s_waitcnt lgkmcnt(2)
    v_mfma_f32_32x32x16_bf16 v[40:55], a[48:51], v[152:155], 0
    s_add_u32 m0, s73, 139264
    s_add_u32 s72, s72, 4096
    buffer_load_dwordx4 v2, s[28:31], s72 offen offset:0 sc1 lds
    s_add_u32 s72, s72, 16384
    v_max3_f32 v8, v56, v57, v8
    v_max3_f32 v9, v58, v59, v9
    v_max3_f32 v8, v60, v61, v8
    v_max3_f32 v9, v62, v63, v9
    v_mfma_f32_32x32x8_bf16 v[40:55], a[52:53], v[156:157], v[40:55]
    v_max3_f32 v8, v64, v65, v8
    v_max3_f32 v9, v66, v67, v9
    v_max3_f32 v8, v68, v69, v8
    v_max3_f32 v9, v70, v71, v9
    v_mfma_f32_32x32x16_bf16 v[56:71], a[56:59], v[152:155], 0
    buffer_load_dwordx4 a[100:103], v2, s[28:31], s76 offen offset:0 sc1
    v_max3_f32 v8, v72, v73, v8
    v_max3_f32 v9, v74, v75, v9
    v_max3_f32 v8, v76, v77, v8
    v_max3_f32 v9, v78, v79, v9
    v_mfma_f32_32x32x8_bf16 v[56:71], a[60:61], v[156:157], v[56:71]
    v_max3_f32 v8, v80, v81, v8
    v_max3_f32 v9, v82, v83, v9
    v_max3_f32 v8, v84, v85, v8
    v_max3_f32 v9, v86, v87, v9
    s_waitcnt lgkmcnt(0)
    v_mfma_f32_32x32x16_bf16 v[72:87], a[64:67], v[152:155], v[208:223]
    v_max3_f32 v8, v40, v41, v8
    v_max3_f32 v9, v42, v43, v9
    v_max3_f32 v8, v44, v45, v8
    v_max3_f32 v9, v46, v47, v9
    v_mfma_f32_32x32x8_bf16 v[72:87], a[68:69], v[156:157], v[72:87]
    v_max3_f32 v8, v48, v49, v8
    v_max3_f32 v9, v50, v51, v9
    v_max3_f32 v8, v52, v53, v8
    v_max3_f32 v9, v54, v55, v9
    v_mfma_f32_32x32x16_bf16 v[40:55], a[0:3], v[152:155], v[224:239]
    ds_read_b64_tr_b16 v[128:129], v23 offset:18432
    ds_read_b64_tr_b16 v[130:131], v23 offset:18816
    ds_read_b64_tr_b16 v[132:133], v23 offset:19200
    ds_read_b64_tr_b16 v[134:135], v23 offset:19584
    v_max3_f32 v8, v56, v57, v8
    v_max3_f32 v9, v58, v59, v9
    v_max3_f32 v8, v60, v61, v8
    v_max3_f32 v9, v62, v63, v9
    v_max3_f32 v8, v64, v65, v8
    v_max3_f32 v9, v66, v67, v9
    v_max3_f32 v8, v68, v69, v8
    v_max3_f32 v9, v70, v71, v9
    v_mfma_f32_32x32x16_bf16 v[56:71], a[8:11], v[152:155], 0
    v_max3_f32 v8, v72, v73, v8
    v_max3_f32 v9, v74, v75, v9
    v_max3_f32 v8, v76, v77, v8
    v_max3_f32 v9, v78, v79, v9
    v_max3_f32 v8, v80, v81, v8
    v_max3_f32 v9, v82, v83, v9
    v_max3_f32 v8, v84, v85, v8
    v_max3_f32 v9, v86, v87, v9
    v_max_f32 v8, v8, v9
    v_mov_b32 v9, v8
    s_nop 1
    v_permlane32_swap_b32 v8, v9
    v_max_f32 v8, v8, v9
    v_sub_f32 v8, 0, v8
    v_and_b32 v9, 0xffff0000, v8
    v_sub_f32 v8, v8, v9
    v_or_b32 v9, 0x3f80, v9
    v_and_b32 v3, 0xffff0000, v8
    v_sub_f32 v8, v8, v3
    v_lshrrev_b32 v3, 16, v3
    v_and_b32 v8, 0xffff0000, v8
    v_or_b32 v8, v8, v3
    v_cndmask_b32 v156, v156, v9, s[56:57]
    v_cndmask_b32 v157, v157, v8, s[56:57]
    s_nop 1
    v_mfma_f32_32x32x8_bf16 v[40:55], a[4:5], v[156:157], v[40:55]
    v_mfma_f32_32x32x8_bf16 v[56:71], a[12:13], v[156:157], v[56:71]
    s_nop 10
    v_exp_f32 v40, v40
    v_exp_f32 v41, v41
    v_exp_f32 v42, v42
    v_exp_f32 v43, v43
    ds_read_b64_tr_b16 v[136:137], v23 offset:19968
    ds_read_b64_tr_b16 v[138:139], v23 offset:20352
    buffer_load_dwordx4 a[104:107], v2, s[28:31], s76 offen offset:1024 sc1
    v_mfma_f32_32x32x16_bf16 v[72:87], a[16:19], v[152:155], 0
    v_exp_f32 v44, v44
    v_exp_f32 v45, v45
    v_exp_f32 v46, v46
    v_exp_f32 v47, v47
    v_cvt_pk_bf16_f32 v120, v40, v41
    v_cvt_pk_bf16_f32 v121, v42, v43
    v_cvt_pk_bf16_f32 v122, v44, v45
    v_cvt_pk_bf16_f32 v123, v46, v47
    ds_read_b64_tr_b16 v[140:141], v23 offset:20736
    ds_read_b64_tr_b16 v[142:143], v23 offset:21120
    s_waitcnt lgkmcnt(6)
    v_mfma_f32_32x32x16_bf16 v[104:119], v[128:131], v[120:123], 0
    v_exp_f32 v48, v48
    v_exp_f32 v49, v49
    v_exp_f32 v50, v50
    v_exp_f32 v51, v51
    v_mfma_f32_32x32x8_bf16 v[72:87], a[20:21], v[156:157], v[72:87]
    v_exp_f32 v52, v52
    v_exp_f32 v53, v53
    v_exp_f32 v54, v54
    v_exp_f32 v55, v55
    v_cvt_pk_bf16_f32 v124, v48, v49
    v_cvt_pk_bf16_f32 v125, v50, v51
    v_cvt_pk_bf16_f32 v126, v52, v53
    v_cvt_pk_bf16_f32 v127, v54, v55
    buffer_load_dwordx4 a[108:111], v2, s[28:31], s76 offen offset:2048 sc1
    s_add_u32 s76, s76, 12288
    s_waitcnt lgkmcnt(4)
    v_mfma_f32_32x32x16_bf16 v[104:119], v[132:135], v[124:127], v[104:119]
    v_exp_f32 v56, v56
    v_exp_f32 v57, v57
    v_exp_f32 v58, v58
    v_exp_f32 v59, v59
    ds_read_b64_tr_b16 v[128:129], v23 offset:21504
    ds_read_b64_tr_b16 v[130:131], v23 offset:21888
    v_mfma_f32_32x32x16_bf16 v[40:55], a[24:27], v[152:155], 0
    v_exp_f32 v60, v60
    v_exp_f32 v61, v61
    v_exp_f32 v62, v62
    v_exp_f32 v63, v63
    v_cvt_pk_bf16_f32 v120, v56, v57
    v_cvt_pk_bf16_f32 v121, v58, v59
    v_cvt_pk_bf16_f32 v122, v60, v61
    v_cvt_pk_bf16_f32 v123, v62, v63
    ds_read_b64_tr_b16 v[132:133], v23 offset:22272
    ds_read_b64_tr_b16 v[134:135], v23 offset:22656
    s_waitcnt lgkmcnt(6)
    v_mfma_f32_32x32x16_bf16 v[104:119], v[136:139], v[120:123], v[104:119]
    buffer_load_dwordx4 a[112:115], v2, s[28:31], s76 offen offset:0 sc1
    v_exp_f32 v64, v64
    v_exp_f32 v65, v65
    v_exp_f32 v66, v66
    v_exp_f32 v67, v67
    v_mfma_f32_32x32x8_bf16 v[40:55], a[28:29], v[156:157], v[40:55]
    v_exp_f32 v68, v68
    v_exp_f32 v69, v69
    v_exp_f32 v70, v70
    v_exp_f32 v71, v71
    v_cvt_pk_bf16_f32 v124, v64, v65
    v_cvt_pk_bf16_f32 v125, v66, v67
    v_cvt_pk_bf16_f32 v126, v68, v69
    v_cvt_pk_bf16_f32 v127, v70, v71
    s_waitcnt lgkmcnt(4)
    s_nop 0
    v_mfma_f32_32x32x16_bf16 v[104:119], v[140:143], v[124:127], v[104:119]
    v_exp_f32 v72, v72
    v_exp_f32 v73, v73
    v_exp_f32 v74, v74
    v_exp_f32 v75, v75
    ds_read_b64_tr_b16 v[136:137], v23 offset:23040
    ds_read_b64_tr_b16 v[138:139], v23 offset:23424
    buffer_load_dwordx4 a[116:119], v2, s[28:31], s76 offen offset:1024 sc1
    v_mfma_f32_32x32x16_bf16 v[56:71], a[32:35], v[152:155], 0
    v_exp_f32 v76, v76
    v_exp_f32 v77, v77
    v_exp_f32 v78, v78
    v_exp_f32 v79, v79
    v_cvt_pk_bf16_f32 v120, v72, v73
    v_cvt_pk_bf16_f32 v121, v74, v75
    v_cvt_pk_bf16_f32 v122, v76, v77
    v_cvt_pk_bf16_f32 v123, v78, v79
    ds_read_b64_tr_b16 v[140:141], v23 offset:23808
    ds_read_b64_tr_b16 v[142:143], v23 offset:24192
    s_waitcnt lgkmcnt(6)
    v_mfma_f32_32x32x16_bf16 v[104:119], v[128:131], v[120:123], v[104:119]
    v_exp_f32 v80, v80
    v_exp_f32 v81, v81
    v_exp_f32 v82, v82
    v_exp_f32 v83, v83
    v_mfma_f32_32x32x8_bf16 v[56:71], a[36:37], v[156:157], v[56:71]
    v_exp_f32 v84, v84
    v_exp_f32 v85, v85
    v_exp_f32 v86, v86
    v_exp_f32 v87, v87
    v_cvt_pk_bf16_f32 v124, v80, v81
    v_cvt_pk_bf16_f32 v125, v82, v83
    v_cvt_pk_bf16_f32 v126, v84, v85
    v_cvt_pk_bf16_f32 v127, v86, v87
    buffer_load_dwordx4 a[120:123], v2, s[28:31], s76 offen offset:2048 sc1
    s_add_u32 s76, s76, 12288
    s_waitcnt lgkmcnt(4)
    v_mfma_f32_32x32x16_bf16 v[104:119], v[132:135], v[124:127], v[104:119]
    v_exp_f32 v40, v40
    v_exp_f32 v41, v41
    v_exp_f32 v42, v42
    v_exp_f32 v43, v43
    ds_read_b64_tr_b16 v[128:129], v23 offset:24576
    ds_read_b64_tr_b16 v[130:131], v23 offset:24960
    v_mfma_f32_32x32x16_bf16 v[72:87], a[40:43], v[152:155], 0
    v_exp_f32 v44, v44
    v_exp_f32 v45, v45
    v_exp_f32 v46, v46
    v_exp_f32 v47, v47
    v_cvt_pk_bf16_f32 v120, v40, v41
    v_cvt_pk_bf16_f32 v121, v42, v43
    v_cvt_pk_bf16_f32 v122, v44, v45
    v_cvt_pk_bf16_f32 v123, v46, v47
    ds_read_b64_tr_b16 v[132:133], v23 offset:25344
    ds_read_b64_tr_b16 v[134:135], v23 offset:25728
    s_waitcnt lgkmcnt(6)
    v_mfma_f32_32x32x16_bf16 v[104:119], v[136:139], v[120:123], v[104:119]
    buffer_load_dwordx4 a[124:127], v2, s[28:31], s76 offen offset:0 sc1
    v_exp_f32 v48, v48
    v_exp_f32 v49, v49
    v_exp_f32 v50, v50
    v_exp_f32 v51, v51
    v_mfma_f32_32x32x8_bf16 v[72:87], a[44:45], v[156:157], v[72:87]
    v_exp_f32 v52, v52
    v_exp_f32 v53, v53
    v_exp_f32 v54, v54
    v_exp_f32 v55, v55
    v_cvt_pk_bf16_f32 v124, v48, v49
    v_cvt_pk_bf16_f32 v125, v50, v51
    v_cvt_pk_bf16_f32 v126, v52, v53
    v_cvt_pk_bf16_f32 v127, v54, v55
    s_waitcnt lgkmcnt(4)
    s_nop 0
    v_mfma_f32_32x32x16_bf16 v[104:119], v[140:143], v[124:127], v[104:119]
    v_exp_f32 v56, v56
    v_exp_f32 v57, v57
    v_exp_f32 v58, v58
    v_exp_f32 v59, v59
    ds_read_b64_tr_b16 v[136:137], v23 offset:26112
    ds_read_b64_tr_b16 v[138:139], v23 offset:26496
    buffer_load_dwordx4 a[128:131], v2, s[28:31], s76 offen offset:1024 sc1
    v_mfma_f32_32x32x16_bf16 v[40:55], a[48:51], v[152:155], 0
    v_exp_f32 v60, v60
    v_exp_f32 v61, v61
    v_exp_f32 v62, v62
    v_exp_f32 v63, v63
    v_cvt_pk_bf16_f32 v120, v56, v57
    v_cvt_pk_bf16_f32 v121, v58, v59
    v_cvt_pk_bf16_f32 v122, v60, v61
    v_cvt_pk_bf16_f32 v123, v62, v63
    ds_read_b64_tr_b16 v[140:141], v23 offset:26880
    ds_read_b64_tr_b16 v[142:143], v23 offset:27264
    s_waitcnt lgkmcnt(6)
    v_mfma_f32_32x32x16_bf16 v[104:119], v[128:131], v[120:123], v[104:119]
    v_exp_f32 v64, v64
    v_exp_f32 v65, v65
    v_exp_f32 v66, v66
    v_exp_f32 v67, v67
    v_mfma_f32_32x32x8_bf16 v[40:55], a[52:53], v[156:157], v[40:55]
    buffer_load_dwordx4 a[132:135], v2, s[28:31], s76 offen offset:2048 sc1
    s_add_u32 s76, s76, 12288
    v_exp_f32 v68, v68
    v_exp_f32 v69, v69
    v_exp_f32 v70, v70
    v_exp_f32 v71, v71
    v_cvt_pk_bf16_f32 v124, v64, v65
    v_cvt_pk_bf16_f32 v125, v66, v67
    v_cvt_pk_bf16_f32 v126, v68, v69
    v_cvt_pk_bf16_f32 v127, v70, v71
    s_add_u32 s66, s65, 0
    buffer_load_dwordx4 v[160:163], v26, s[28:31], s66 offen sc1
    s_add_u32 s66, s65, 10240
    buffer_load_dwordx4 v[164:167], v26, s[28:31], s66 offen sc1
    s_add_u32 s66, s65, 20480
    buffer_load_dwordx4 v[168:171], v26, s[28:31], s66 offen sc1
    s_add_u32 s66, s65, 30720
    buffer_load_dwordx4 v[172:175], v26, s[28:31], s66 offen sc1
    s_add_u32 s66, s65, 40960
    buffer_load_dwordx4 v[176:179], v26, s[28:31], s66 offen sc1
    s_waitcnt lgkmcnt(4)
    v_mfma_f32_32x32x16_bf16 v[104:119], v[132:135], v[124:127], v[104:119]
    v_exp_f32 v72, v72
    v_exp_f32 v73, v73
    v_exp_f32 v74, v74
    v_exp_f32 v75, v75
    ds_read_b64_tr_b16 v[128:129], v23 offset:27648
    ds_read_b64_tr_b16 v[130:131], v23 offset:28032
    v_mfma_f32_32x32x16_bf16 v[56:71], a[56:59], v[152:155], 0
    v_exp_f32 v76, v76
    v_exp_f32 v77, v77
    v_exp_f32 v78, v78
    v_exp_f32 v79, v79
    v_cvt_pk_bf16_f32 v120, v72, v73
    v_cvt_pk_bf16_f32 v121, v74, v75
    v_cvt_pk_bf16_f32 v122, v76, v77
    v_cvt_pk_bf16_f32 v123, v78, v79
    ds_read_b64_tr_b16 v[132:133], v23 offset:28416
    ds_read_b64_tr_b16 v[134:135], v23 offset:28800
    s_waitcnt lgkmcnt(6)
    v_mfma_f32_32x32x16_bf16 v[104:119], v[136:139], v[120:123], v[104:119]
    buffer_load_dwordx4 a[136:139], v2, s[28:31], s76 offen offset:0 sc1
    v_exp_f32 v80, v80
    v_exp_f32 v81, v81
    v_exp_f32 v82, v82
    v_exp_f32 v83, v83
    v_mfma_f32_32x32x8_bf16 v[56:71], a[60:61], v[156:157], v[56:71]
    v_exp_f32 v84, v84
    v_exp_f32 v85, v85
    v_exp_f32 v86, v86
    v_exp_f32 v87, v87
    v_cvt_pk_bf16_f32 v124, v80, v81
    v_cvt_pk_bf16_f32 v125, v82, v83
    v_cvt_pk_bf16_f32 v126, v84, v85
    v_cvt_pk_bf16_f32 v127, v86, v87
    s_waitcnt lgkmcnt(4)
    s_nop 0
    v_mfma_f32_32x32x16_bf16 v[104:119], v[140:143], v[124:127], v[104:119]
    v_exp_f32 v40, v40
    v_exp_f32 v41, v41
    v_exp_f32 v42, v42
    v_exp_f32 v43, v43
    ds_read_b64_tr_b16 v[136:137], v23 offset:29184
    ds_read_b64_tr_b16 v[138:139], v23 offset:29568
    buffer_load_dwordx4 a[140:143], v2, s[28:31], s76 offen offset:1024 sc1
    v_mfma_f32_32x32x16_bf16 v[72:87], a[64:67], v[152:155], v[208:223]
    v_exp_f32 v44, v44
    v_exp_f32 v45, v45
    v_exp_f32 v46, v46
    v_exp_f32 v47, v47
    v_cvt_pk_bf16_f32 v120, v40, v41
    v_cvt_pk_bf16_f32 v121, v42, v43
    v_cvt_pk_bf16_f32 v122, v44, v45
    v_cvt_pk_bf16_f32 v123, v46, v47
    ds_read_b64_tr_b16 v[140:141], v23 offset:29952
    ds_read_b64_tr_b16 v[142:143], v23 offset:30336
    s_waitcnt lgkmcnt(6)
    v_mfma_f32_32x32x16_bf16 v[104:119], v[128:131], v[120:123], v[104:119]
    v_exp_f32 v48, v48
    v_exp_f32 v49, v49
    v_exp_f32 v50, v50
    v_exp_f32 v51, v51
    v_mfma_f32_32x32x8_bf16 v[72:87], a[68:69], v[156:157], v[72:87]
    buffer_load_dwordx4 a[144:147], v2, s[28:31], s76 offen offset:2048 sc1
    s_add_u32 s76, s76, 12288
    v_exp_f32 v52, v52
    v_exp_f32 v53, v53
    v_exp_f32 v54, v54
    v_exp_f32 v55, v55
    v_cvt_pk_bf16_f32 v124, v48, v49
    v_cvt_pk_bf16_f32 v125, v50, v51
    v_cvt_pk_bf16_f32 v126, v52, v53
    v_cvt_pk_bf16_f32 v127, v54, v55
    s_waitcnt lgkmcnt(4)
    s_nop 0
    v_mfma_f32_32x32x16_bf16 v[104:119], v[132:135], v[124:127], v[104:119]
    v_exp_f32 v56, v56
    v_exp_f32 v57, v57
    v_exp_f32 v58, v58
    v_exp_f32 v59, v59
    ds_read_b64_tr_b16 v[128:129], v23 offset:30720
    ds_read_b64_tr_b16 v[130:131], v23 offset:31104
    v_exp_f32 v60, v60
    v_exp_f32 v61, v61
    v_exp_f32 v62, v62
    v_exp_f32 v63, v63
    v_cvt_pk_bf16_f32 v120, v56, v57
    v_cvt_pk_bf16_f32 v121, v58, v59
    v_cvt_pk_bf16_f32 v122, v60, v61
    v_cvt_pk_bf16_f32 v123, v62, v63
    ds_read_b64_tr_b16 v[132:133], v23 offset:31488
    ds_read_b64_tr_b16 v[134:135], v23 offset:31872
    s_waitcnt lgkmcnt(6)
    v_mfma_f32_32x32x16_bf16 v[104:119], v[136:139], v[120:123], v[104:119]
    buffer_load_dwordx4 a[148:151], v2, s[28:31], s76 offen offset:0 sc1
    v_exp_f32 v64, v64
    v_exp_f32 v65, v65
    v_exp_f32 v66, v66
    v_exp_f32 v67, v67
    v_exp_f32 v68, v68
    v_exp_f32 v69, v69
    v_exp_f32 v70, v70
    v_exp_f32 v71, v71
    v_cvt_pk_bf16_f32 v124, v64, v65
    v_cvt_pk_bf16_f32 v125, v66, v67
    v_cvt_pk_bf16_f32 v126, v68, v69
    v_cvt_pk_bf16_f32 v127, v70, v71
    buffer_load_dwordx4 a[152:155], v2, s[28:31], s76 offen offset:1024 sc1
    s_waitcnt lgkmcnt(4)
    v_mfma_f32_32x32x16_bf16 v[104:119], v[140:143], v[124:127], v[104:119]
    v_exp_f32 v72, v72
    v_exp_f32 v73, v73
    v_exp_f32 v74, v74
    v_exp_f32 v75, v75
    v_exp_f32 v76, v76
    v_exp_f32 v77, v77
    v_exp_f32 v78, v78
    v_exp_f32 v79, v79
    v_cvt_pk_bf16_f32 v120, v72, v73
    v_cvt_pk_bf16_f32 v121, v74, v75
    v_cvt_pk_bf16_f32 v122, v76, v77
    v_cvt_pk_bf16_f32 v123, v78, v79
    s_waitcnt lgkmcnt(2)
    s_nop 0
    v_mfma_f32_32x32x16_bf16 v[104:119], v[128:131], v[120:123], v[104:119]
    v_exp_f32 v80, v80
    v_exp_f32 v81, v81
    v_exp_f32 v82, v82
    v_exp_f32 v83, v83
    buffer_load_dwordx4 a[156:159], v2, s[28:31], s76 offen offset:2048 sc1
    s_add_u32 s76, s76, 12288
    v_exp_f32 v84, v84
    v_exp_f32 v85, v85
    v_exp_f32 v86, v86
    v_exp_f32 v87, v87
    v_cvt_pk_bf16_f32 v124, v80, v81
    v_cvt_pk_bf16_f32 v125, v82, v83
    v_cvt_pk_bf16_f32 v126, v84, v85
    v_cvt_pk_bf16_f32 v127, v86, v87
    s_waitcnt lgkmcnt(0)
    s_nop 0
    v_mfma_f32_32x32x16_bf16 v[104:119], v[132:135], v[124:127], v[104:119]
    buffer_load_dwordx4 a[160:163], v2, s[28:31], s76 offen offset:0 sc1
    buffer_load_dwordx4 a[164:167], v2, s[28:31], s76 offen offset:1024 sc1
    buffer_load_dwordx4 a[168:171], v2, s[28:31], s76 offen offset:2048 sc1
    s_add_u32 s76, s76, 12288
    buffer_load_dwordx4 a[172:175], v2, s[28:31], s76 offen offset:0 sc1
    buffer_load_dwordx4 a[176:179], v2, s[28:31], s76 offen offset:1024 sc1
    buffer_load_dwordx4 a[180:183], v2, s[28:31], s76 offen offset:2048 sc1
    s_add_u32 s76, s76, 12288
    buffer_load_dwordx4 a[184:187], v2, s[28:31], s76 offen offset:0 sc1
    buffer_load_dwordx4 a[188:191], v2, s[28:31], s76 offen offset:1024 sc1
    buffer_load_dwordx4 a[192:195], v2, s[28:31], s76 offen offset:2048 sc1
    s_add_u32 s76, s76, 12288
    s_waitcnt vmcnt(19)
    v_xor_b32 v160, s40, v160
    v_xor_b32 v161, s41, v161
    v_xor_b32 v162, s42, v162
    v_xor_b32 v163, s43, v163
    v_or_b32 v180, v160, v161
    v_or3_b32 v180, v162, v163, v180
    s_waitcnt vmcnt(18)
    v_xor_b32 v164, s40, v164
    v_xor_b32 v165, s41, v165
    v_xor_b32 v166, s42, v166
    v_xor_b32 v167, s43, v167
    v_or3_b32 v180, v164, v165, v180
    v_or3_b32 v180, v166, v167, v180
    s_waitcnt vmcnt(17)
    v_xor_b32 v168, s40, v168
    v_xor_b32 v169, s41, v169
    v_xor_b32 v170, s42, v170
    v_xor_b32 v171, s43, v171
    v_or3_b32 v180, v168, v169, v180
    v_or3_b32 v180, v170, v171, v180
    s_waitcnt vmcnt(16)
    v_xor_b32 v172, s40, v172
    v_xor_b32 v173, s41, v173
    v_xor_b32 v174, s42, v174
    v_xor_b32 v175, s43, v175
    v_or3_b32 v180, v172, v173, v180
    v_or3_b32 v180, v174, v175, v180
    s_waitcnt vmcnt(15)
    v_xor_b32 v176, s40, v176
    v_xor_b32 v177, s41, v177
    v_xor_b32 v178, s42, v178
    v_xor_b32 v179, s43, v179
    v_or3_b32 v180, v176, v177, v180
    v_or3_b32 v180, v178, v179, v180
    v_and_b32 v180, 0xff, v180
    v_cmp_ne_u32 vcc, 0, v180
    s_cbranch_vccnz Lvs19
Lvj20:
    v_pk_add_f32 v[160:161], v[160:161], v[164:165]
    v_pk_add_f32 v[162:163], v[162:163], v[166:167]
    v_pk_add_f32 v[160:161], v[160:161], v[168:169]
    v_pk_add_f32 v[162:163], v[162:163], v[170:171]
    v_pk_add_f32 v[160:161], v[160:161], v[172:173]
    v_pk_add_f32 v[162:163], v[162:163], v[174:175]
    v_pk_add_f32 v[160:161], v[160:161], v[176:177]
    v_pk_add_f32 v[162:163], v[162:163], v[178:179]
    v_cvt_pk_bf16_f32 v164, v160, v161
    v_cvt_pk_bf16_f32 v165, v162, v163
    v_lshlrev_b32 v160, 16, v164
    v_and_b32 v161, 0xffff0000, v164
    v_lshlrev_b32 v162, 16, v165
    v_and_b32 v163, 0xffff0000, v165
    v_add_f32 v160, s67, v160
    v_add_f32 v161, s67, v161
    v_add_f32 v162, s67, v162
    v_add_f32 v163, s67, v163
    v_cvt_pk_bf16_f32 v164, v160, v161
    v_cvt_pk_bf16_f32 v165, v162, v163
    v_lshlrev_b32 v160, 16, v164
    v_and_b32 v161, 0xffff0000, v164
    v_lshlrev_b32 v162, 16, v165
    v_and_b32 v163, 0xffff0000, v165
    v_mul_f32 v160, s68, v160
    v_mul_f32 v161, s68, v161
    v_mul_f32 v162, s68, v162
    v_mul_f32 v163, s68, v163
    s_mul_i32 s60, s46, 320
    s_add_u32 s60, s60, 157696
    v_add_u32 v3, s60, v26
    ds_write_b128 v3, v[160:163]
    s_lshl_b32 s60, s44, 2
    s_add_u32 s60, s60, s46
    s_mul_i32 s60, s60, 40960
    s_mul_i32 s61, s45, 1280
    s_add_u32 s60, s60, s61
    s_add_u32 s60, s60, 1048576
    v_mov_b32 v8, v96
    v_mov_b32 v9, v96
    s_nop 1
    v_permlane32_swap_b32 v8, v9
    v_rcp_f32 v9, v9
    s_nop 0
    v_mul_f32 v88, v88, v9
    v_mul_f32 v89, v89, v9
    v_mul_f32 v90, v90, v9
    v_mul_f32 v91, v91, v9
    v_mul_f32 v92, v92, v9
    v_mul_f32 v93, v93, v9
    v_mul_f32 v94, v94, v9
    v_mul_f32 v95, v95, v9
    v_mul_f32 v96, v96, v9
    v_mul_f32 v97, v97, v9
    v_mul_f32 v98, v98, v9
    v_mul_f32 v99, v99, v9
    v_mov_b32 v8, v112
    v_mov_b32 v9, v112
    s_nop 1
    v_permlane32_swap_b32 v8, v9
    v_rcp_f32 v9, v9
    s_nop 0
    v_mul_f32 v104, v104, v9
    v_mul_f32 v105, v105, v9
    v_mul_f32 v106, v106, v9
    v_mul_f32 v107, v107, v9
    v_mul_f32 v108, v108, v9
    v_mul_f32 v109, v109, v9
    v_mul_f32 v110, v110, v9
    v_mul_f32 v111, v111, v9
    v_mul_f32 v112, v112, v9
    v_mul_f32 v113, v113, v9
    v_mul_f32 v114, v114, v9
    v_mul_f32 v115, v115, v9
    v_cvt_pk_bf16_f32 v40, v88, v89
    v_cvt_pk_bf16_f32 v41, v90, v91
    v_cvt_pk_bf16_f32 v42, v92, v93
    v_cvt_pk_bf16_f32 v43, v94, v95
    v_cvt_pk_bf16_f32 v44, v96, v97
    v_cvt_pk_bf16_f32 v45, v98, v99
    v_cvt_pk_bf16_f32 v46, v104, v105
    v_cvt_pk_bf16_f32 v47, v106, v107
    v_cvt_pk_bf16_f32 v48, v108, v109
    v_cvt_pk_bf16_f32 v49, v110, v111
    v_cvt_pk_bf16_f32 v50, v112, v113
    v_cvt_pk_bf16_f32 v51, v114, v115
    v_permlane32_swap_b32 v40, v42
    v_permlane32_swap_b32 v46, v50
    v_permlane32_swap_b32 v41, v43
    v_permlane32_swap_b32 v47, v51
    buffer_store_dwordx4 v[40:43], v24, s[28:31], s60 offen
    v_cndmask_b32 v52, v50, v48, s[56:57]
    v_cndmask_b32 v54, v48, v46, s[56:57]
    v_cndmask_b32 v53, v51, v49, s[56:57]
    v_cndmask_b32 v55, v49, v47, s[56:57]
    buffer_store_dwordx4 v[52:55], v24, s[28:31], s60 offen offset:768
    s_mov_b64 exec, 0xffffffff
    buffer_store_dwordx4 v[44:47], v24, s[28:31], s60 offen offset:512
    s_mov_b64 exec, -1
    s_waitcnt vmcnt(0)
    s_lshl_b32 s60, s44, 8
    s_add_u32 s60, s60, 12288
    s_lshl_b32 s61, s45, 4
    s_lshl_b32 s62, s46, 2
    s_add_u32 s61, s61, s62
    v_mov_b32 v8, s61
    v_mov_b32 v9, s47
    s_mov_b64 exec, 1
    s_cmp_eq_u32 s55, 0
    s_cbranch_scc1 Lslow21
    buffer_store_dword v9, v8, s[28:31], s60 offen
Ljoin22:
    s_mov_b64 exec, -1
    s_waitcnt lgkmcnt(0)
L_c3:
    s_barrier
    s_add_u32 m0, s73, 0
    s_nop 0
    buffer_load_dwordx4 v2, s[28:31], s72 offen offset:0 sc1 lds
    buffer_load_dwordx4 v2, s[28:31], s72 offen offset:1024 sc1 lds
    buffer_load_dwordx4 v2, s[28:31], s72 offen offset:2048 sc1 lds
    buffer_load_dwordx4 v2, s[28:31], s72 offen offset:3072 sc1 lds
    s_add_u32 m0, s73, 4096
    s_add_u32 s72, s72, 4096
    buffer_load_dwordx4 v2, s[28:31], s72 offen offset:0 sc1 lds
    s_mul_i32 s62, s52, 51200
    s_add_u32 s62, s62, 73728
    v_add_u32 v5, s62, v20
    s_cmp_eq_u32 s52, 0
    s_cselect_b32 s62, 104448, 0
    v_add_u32 v6, s62, v20
    v_lshrrev_b32 v13, 4, v1
    v_lshlrev_b32 v7, 4, v13
    v_add_u32 v7, 157696, v7
    ds_read_b128 v[120:123], v7 offset:0
    ds_read_b128 v[180:183], v7 offset:320
    ds_read_b128 v[124:127], v7 offset:64
    ds_read_b128 v[184:187], v7 offset:384
    ds_read_b128 v[128:131], v7 offset:128
    ds_read_b128 v[188:191], v7 offset:448
    ds_read_b128 v[132:135], v7 offset:192
    ds_read_b128 v[192:195], v7 offset:512
    ds_read_b128 v[136:139], v7 offset:256
    ds_read_b128 v[196:199], v7 offset:576
    ds_read_b128 v[200:203], v7 offset:640
    ds_read_b128 a[80:83], v7 offset:960
    ds_read_b128 v[204:207], v7 offset:704
    ds_read_b128 a[84:87], v7 offset:1024
    ds_read_b128 v[208:211], v7 offset:768
    ds_read_b128 a[88:91], v7 offset:1088
    ds_read_b128 v[212:215], v7 offset:832
    ds_read_b128 a[92:95], v7 offset:1152
    ds_read_b128 v[216:219], v7 offset:896
    ds_read_b128 a[96:99], v7 offset:1216
    v_lshlrev_b32 v140, 16, v240
    v_and_b32 v141, 0xffff0000, v240
    v_lshlrev_b32 v142, 16, v241
    v_and_b32 v143, 0xffff0000, v241
    v_lshlrev_b32 v144, 16, v242
    v_and_b32 v145, 0xffff0000, v242
    v_lshlrev_b32 v146, 16, v243
    v_and_b32 v147, 0xffff0000, v243
    v_lshlrev_b32 v148, 16, v244
    v_and_b32 v149, 0xffff0000, v244
    v_lshlrev_b32 v150, 16, v245
    v_and_b32 v151, 0xffff0000, v245
    v_lshlrev_b32 v152, 16, v246
    v_and_b32 v153, 0xffff0000, v246
    v_lshlrev_b32 v154, 16, v247
    v_and_b32 v155, 0xffff0000, v247
    v_lshlrev_b32 v156, 16, v248
    v_and_b32 v157, 0xffff0000, v248
    v_lshlrev_b32 v158, 16, v249
    v_and_b32 v159, 0xffff0000, v249
    s_lshl_b32 s74, s44, 1
    s_add_u32 s74, s74, s50
    s_lshl_b32 s74, s74, 2
    s_add_u32 s74, s74, s46
    s_xor_b32 s75, s74, 1
    s_mul_i32 s62, s52, 10240
    s_add_u32 s62, s62, 1048576
    s_mul_i32 s74, s74, 20480
    s_add_u32 s74, s74, s62
    s_mul_i32 s75, s75, 20480
    s_add_u32 s75, s75, s62
    s_mul_i32 s77, s46, 3072
    v_add_u32 v32, s77, v2
    v_add_u32 v33, 61440, v32
    v_add_u32 v34, 122880, v32
    v_and_b32 v12, 15, v1
    v_lshlrev_b32 v12, 4, v12
    v_lshl_add_u32 v14, v13, 12, v12
    v_bfe_u32 v16, v1, 4, 1
    v_lshlrev_b32 v16, 9, v16
    v_lshrrev_b32 v17, 5, v1
    v_lshl_add_u32 v17, v17, 8, v12
    v_add_u32 v16, v16, v17
    s_lshl_b32 s64, s44, 14
    s_lshl_b32 s61, s50, 2
    s_add_u32 s61, s61, s46
    s_lshl_b32 s62, s61, 8
    s_add_u32 s64, s64, s62
    s_add_u32 s64, s64, 327680
    s_lshl_b32 s65, s51, 11
    s_add_u32 s65, s65, s64
    s_lshl_b32 s66, s44, 3
    s_add_u32 s66, s66, s61
    s_mul_i32 s66, s66, 20480
    s_mul_i32 s61, s51, 2560
    s_add_u32 s66, s66, s61
    s_add_u32 s66, s66, 1048576
    s_waitcnt lgkmcnt(0)
    ds_read_b64_tr_b16 v[80:81], v5 offset:0
    ds_read_b64_tr_b16 v[82:83], v5 offset:2560
    ds_read_b64_tr_b16 v[84:85], v5 offset:32
    ds_read_b64_tr_b16 v[86:87], v5 offset:2592
    ds_read_b64_tr_b16 v[88:89], v5 offset:64
    ds_read_b64_tr_b16 v[90:91], v5 offset:2624
    ds_read_b64_tr_b16 v[92:93], v5 offset:96
    ds_read_b64_tr_b16 v[94:95], v5 offset:2656
    ds_read_b64_tr_b16 v[96:97], v5 offset:128
    ds_read_b64_tr_b16 v[98:99], v5 offset:2688
    s_lshl_b32 s60, s44, 8
    s_add_u32 s60, s60, 12288
    v_and_b32 v3, 7, v1
    s_lshl_b32 s61, s52, 3
    v_add_u32 v3, s61, v3
    v_lshlrev_b32 v3, 4, v3
    s_lshl_b32 s61, s50, 1
    s_add_u32 s61, s61, s53
    s_lshl_b32 s61, s61, 2
    v_add_u32 v3, s61, v3
    s_mov_b32 s54, 32768
Lp23:
    buffer_load_dword v4, v3, s[28:31], s60 offen offset:0 sc1
    s_waitcnt vmcnt(0)
    v_cmp_ne_u32 vcc, s47, v4
    s_cbranch_vccz Lpd24
    s_sub_u32 s54, s54, 1
    s_cbranch_scc0 Lp23
Lpd24:
    s_cmp_eq_u32 s55, 0
    s_cbranch_scc1 Lacq25
Lacqj26:
    buffer_load_dwordx4 a[0:3], v2, s[28:31], s74 offen offset:0 sc1
    buffer_load_dwordx4 a[40:43], v2, s[28:31], s75 offen offset:0 sc1
    buffer_load_dwordx4 a[4:7], v2, s[28:31], s74 offen offset:1024 sc1
    buffer_load_dwordx4 a[44:47], v2, s[28:31], s75 offen offset:1024 sc1
    buffer_load_dwordx4 a[8:11], v2, s[28:31], s74 offen offset:2048 sc1
    buffer_load_dwordx4 a[48:51], v2, s[28:31], s75 offen offset:2048 sc1
    s_waitcnt vmcnt(4) lgkmcnt(4)
    v_mfma_f32_16x16x32_bf16 v[40:43], v[80:83], a[0:3], 0
    ds_read_b64_tr_b16 v[100:101], v5 offset:5120
    v_mfma_f32_16x16x32_bf16 v[60:63], v[80:83], a[40:43], 0
    ds_read_b64_tr_b16 v[102:103], v5 offset:7680
    buffer_load_dwordx4 a[12:15], v2, s[28:31], s74 offen offset:3072 sc1
    s_add_u32 s74, s74, 4096
    v_mfma_f32_16x16x32_bf16 v[44:47], v[84:87], a[0:3], 0
    ds_read_b64_tr_b16 v[104:105], v5 offset:5152
    v_mfma_f32_16x16x32_bf16 v[64:67], v[84:87], a[40:43], 0
    ds_read_b64_tr_b16 v[106:107], v5 offset:7712
    v_mfma_f32_16x16x32_bf16 v[48:51], v[88:91], a[0:3], 0
    ds_read_b64_tr_b16 v[108:109], v5 offset:5184
    v_mfma_f32_16x16x32_bf16 v[68:71], v[88:91], a[40:43], 0
    ds_read_b64_tr_b16 v[110:111], v5 offset:7744
    s_waitcnt lgkmcnt(6)
    v_mfma_f32_16x16x32_bf16 v[52:55], v[92:95], a[0:3], 0
    ds_read_b64_tr_b16 v[112:113], v5 offset:5216
    buffer_load_dwordx4 a[52:55], v2, s[28:31], s75 offen offset:3072 sc1
    s_add_u32 s75, s75, 4096
    v_mfma_f32_16x16x32_bf16 v[72:75], v[92:95], a[40:43], 0
    ds_read_b64_tr_b16 v[114:115], v5 offset:7776
    v_mfma_f32_16x16x32_bf16 v[56:59], v[96:99], a[0:3], 0
    ds_read_b64_tr_b16 v[116:117], v5 offset:5248
    v_mfma_f32_16x16x32_bf16 v[76:79], v[96:99], a[40:43], 0
    ds_read_b64_tr_b16 v[118:119], v5 offset:7808
    s_waitcnt vmcnt(4) lgkmcnt(4)
    v_mfma_f32_16x16x32_bf16 v[40:43], v[100:103], a[4:7], v[40:43]
    ds_read_b64_tr_b16 v[80:81], v5 offset:10240
    v_mfma_f32_16x16x32_bf16 v[60:63], v[100:103], a[44:47], v[60:63]
    ds_read_b64_tr_b16 v[82:83], v5 offset:12800
    buffer_load_dwordx4 a[16:19], v2, s[28:31], s74 offen offset:0 sc1
    v_mfma_f32_16x16x32_bf16 v[44:47], v[104:107], a[4:7], v[44:47]
    ds_read_b64_tr_b16 v[84:85], v5 offset:10272
    v_mfma_f32_16x16x32_bf16 v[64:67], v[104:107], a[44:47], v[64:67]
    ds_read_b64_tr_b16 v[86:87], v5 offset:12832
    v_mfma_f32_16x16x32_bf16 v[48:51], v[108:111], a[4:7], v[48:51]
    ds_read_b64_tr_b16 v[88:89], v5 offset:10304
    v_mfma_f32_16x16x32_bf16 v[68:71], v[108:111], a[44:47], v[68:71]
    ds_read_b64_tr_b16 v[90:91], v5 offset:12864
    s_waitcnt lgkmcnt(6)
    v_mfma_f32_16x16x32_bf16 v[52:55], v[112:115], a[4:7], v[52:55]
    ds_read_b64_tr_b16 v[92:93], v5 offset:10336
    buffer_load_dwordx4 a[56:59], v2, s[28:31], s75 offen offset:0 sc1
    v_mfma_f32_16x16x32_bf16 v[72:75], v[112:115], a[44:47], v[72:75]
    ds_read_b64_tr_b16 v[94:95], v5 offset:12896
    v_mfma_f32_16x16x32_bf16 v[56:59], v[116:119], a[4:7], v[56:59]
    ds_read_b64_tr_b16 v[96:97], v5 offset:10368
    v_mfma_f32_16x16x32_bf16 v[76:79], v[116:119], a[44:47], v[76:79]
    ds_read_b64_tr_b16 v[98:99], v5 offset:12928
    s_waitcnt vmcnt(4) lgkmcnt(4)
    v_mfma_f32_16x16x32_bf16 v[40:43], v[80:83], a[8:11], v[40:43]
    ds_read_b64_tr_b16 v[100:101], v5 offset:15360
    v_mfma_f32_16x16x32_bf16 v[60:63], v[80:83], a[48:51], v[60:63]
    ds_read_b64_tr_b16 v[102:103], v5 offset:17920
    buffer_load_dwordx4 a[20:23], v2, s[28:31], s74 offen offset:1024 sc1
    v_mfma_f32_16x16x32_bf16 v[44:47], v[84:87], a[8:11], v[44:47]
    ds_read_b64_tr_b16 v[104:105], v5 offset:15392
    v_mfma_f32_16x16x32_bf16 v[64:67], v[84:87], a[48:51], v[64:67]
    ds_read_b64_tr_b16 v[106:107], v5 offset:17952
    v_mfma_f32_16x16x32_bf16 v[48:51], v[88:91], a[8:11], v[48:51]
    ds_read_b64_tr_b16 v[108:109], v5 offset:15424
    v_mfma_f32_16x16x32_bf16 v[68:71], v[88:91], a[48:51], v[68:71]
    ds_read_b64_tr_b16 v[110:111], v5 offset:17984
    s_waitcnt lgkmcnt(6)
    v_mfma_f32_16x16x32_bf16 v[52:55], v[92:95], a[8:11], v[52:55]
    ds_read_b64_tr_b16 v[112:113], v5 offset:15456
    buffer_load_dwordx4 a[60:63], v2, s[28:31], s75 offen offset:1024 sc1
    v_mfma_f32_16x16x32_bf16 v[72:75], v[92:95], a[48:51], v[72:75]
    ds_read_b64_tr_b16 v[114:115], v5 offset:18016
    v_mfma_f32_16x16x32_bf16 v[56:59], v[96:99], a[8:11], v[56:59]
    ds_read_b64_tr_b16 v[116:117], v5 offset:15488
    v_mfma_f32_16x16x32_bf16 v[76:79], v[96:99], a[48:51], v[76:79]
    ds_read_b64_tr_b16 v[118:119], v5 offset:18048
    s_waitcnt vmcnt(4) lgkmcnt(4)
    v_mfma_f32_16x16x32_bf16 v[40:43], v[100:103], a[12:15], v[40:43]
    ds_read_b64_tr_b16 v[80:81], v5 offset:20480
    v_mfma_f32_16x16x32_bf16 v[60:63], v[100:103], a[52:55], v[60:63]
    ds_read_b64_tr_b16 v[82:83], v5 offset:23040
    buffer_load_dwordx4 a[24:27], v2, s[28:31], s74 offen offset:2048 sc1
    v_mfma_f32_16x16x32_bf16 v[44:47], v[104:107], a[12:15], v[44:47]
    ds_read_b64_tr_b16 v[84:85], v5 offset:20512
    v_mfma_f32_16x16x32_bf16 v[64:67], v[104:107], a[52:55], v[64:67]
    ds_read_b64_tr_b16 v[86:87], v5 offset:23072
    v_mfma_f32_16x16x32_bf16 v[48:51], v[108:111], a[12:15], v[48:51]
    ds_read_b64_tr_b16 v[88:89], v5 offset:20544
    v_mfma_f32_16x16x32_bf16 v[68:71], v[108:111], a[52:55], v[68:71]
    ds_read_b64_tr_b16 v[90:91], v5 offset:23104
    s_waitcnt lgkmcnt(6)
    v_mfma_f32_16x16x32_bf16 v[52:55], v[112:115], a[12:15], v[52:55]
    ds_read_b64_tr_b16 v[92:93], v5 offset:20576
    buffer_load_dwordx4 a[64:67], v2, s[28:31], s75 offen offset:2048 sc1
    v_mfma_f32_16x16x32_bf16 v[72:75], v[112:115], a[52:55], v[72:75]
    ds_read_b64_tr_b16 v[94:95], v5 offset:23136
    v_mfma_f32_16x16x32_bf16 v[56:59], v[116:119], a[12:15], v[56:59]
    ds_read_b64_tr_b16 v[96:97], v5 offset:20608
    v_mfma_f32_16x16x32_bf16 v[76:79], v[116:119], a[52:55], v[76:79]
    ds_read_b64_tr_b16 v[98:99], v5 offset:23168
    s_waitcnt vmcnt(4) lgkmcnt(4)
    v_mfma_f32_16x16x32_bf16 v[40:43], v[80:83], a[16:19], v[40:43]
    ds_read_b64_tr_b16 v[100:101], v5 offset:25600
    v_mfma_f32_16x16x32_bf16 v[60:63], v[80:83], a[56:59], v[60:63]
    ds_read_b64_tr_b16 v[102:103], v5 offset:28160
    buffer_load_dwordx4 a[28:31], v2, s[28:31], s74 offen offset:3072 sc1
    s_add_u32 s74, s74, 4096
    v_mfma_f32_16x16x32_bf16 v[44:47], v[84:87], a[16:19], v[44:47]
    ds_read_b64_tr_b16 v[104:105], v5 offset:25632
    v_mfma_f32_16x16x32_bf16 v[64:67], v[84:87], a[56:59], v[64:67]
    ds_read_b64_tr_b16 v[106:107], v5 offset:28192
    v_mfma_f32_16x16x32_bf16 v[48:51], v[88:91], a[16:19], v[48:51]
    ds_read_b64_tr_b16 v[108:109], v5 offset:25664
    v_mfma_f32_16x16x32_bf16 v[68:71], v[88:91], a[56:59], v[68:71]
    ds_read_b64_tr_b16 v[110:111], v5 offset:28224
    s_waitcnt lgkmcnt(6)
    v_mfma_f32_16x16x32_bf16 v[52:55], v[92:95], a[16:19], v[52:55]
    ds_read_b64_tr_b16 v[112:113], v5 offset:25696
    buffer_load_dwordx4 a[68:71], v2, s[28:31], s75 offen offset:3072 sc1
    s_add_u32 s75, s75, 4096
    v_mfma_f32_16x16x32_bf16 v[72:75], v[92:95], a[56:59], v[72:75]
    ds_read_b64_tr_b16 v[114:115], v5 offset:28256
    v_mfma_f32_16x16x32_bf16 v[56:59], v[96:99], a[16:19], v[56:59]
    ds_read_b64_tr_b16 v[116:117], v5 offset:25728
    v_mfma_f32_16x16x32_bf16 v[76:79], v[96:99], a[56:59], v[76:79]
    ds_read_b64_tr_b16 v[118:119], v5 offset:28288
    s_barrier
    s_waitcnt vmcnt(4) lgkmcnt(4)
    v_mfma_f32_16x16x32_bf16 v[40:43], v[100:103], a[20:23], v[40:43]
    ds_read_b64_tr_b16 v[80:81], v6 offset:0
    v_mfma_f32_16x16x32_bf16 v[60:63], v[100:103], a[60:63], v[60:63]
    ds_read_b64_tr_b16 v[82:83], v6 offset:2560
    buffer_load_dwordx4 a[32:35], v2, s[28:31], s74 offen offset:0 sc1
    v_mfma_f32_16x16x32_bf16 v[44:47], v[104:107], a[20:23], v[44:47]
    ds_read_b64_tr_b16 v[84:85], v6 offset:32
    v_mfma_f32_16x16x32_bf16 v[64:67], v[104:107], a[60:63], v[64:67]
    ds_read_b64_tr_b16 v[86:87], v6 offset:2592
    v_mfma_f32_16x16x32_bf16 v[48:51], v[108:111], a[20:23], v[48:51]
    ds_read_b64_tr_b16 v[88:89], v6 offset:64
    v_mfma_f32_16x16x32_bf16 v[68:71], v[108:111], a[60:63], v[68:71]
    ds_read_b64_tr_b16 v[90:91], v6 offset:2624
    s_waitcnt lgkmcnt(6)
    v_mfma_f32_16x16x32_bf16 v[52:55], v[112:115], a[20:23], v[52:55]
    ds_read_b64_tr_b16 v[92:93], v6 offset:96
    buffer_load_dwordx4 a[72:75], v2, s[28:31], s75 offen offset:0 sc1
    v_mfma_f32_16x16x32_bf16 v[72:75], v[112:115], a[60:63], v[72:75]
    ds_read_b64_tr_b16 v[94:95], v6 offset:2656
    v_mfma_f32_16x16x32_bf16 v[56:59], v[116:119], a[20:23], v[56:59]
    ds_read_b64_tr_b16 v[96:97], v6 offset:128
    v_mfma_f32_16x16x32_bf16 v[76:79], v[116:119], a[60:63], v[76:79]
    ds_read_b64_tr_b16 v[98:99], v6 offset:2688
    s_waitcnt vmcnt(4) lgkmcnt(4)
    v_mfma_f32_16x16x32_bf16 v[40:43], v[80:83], a[24:27], v[40:43]
    ds_read_b64_tr_b16 v[100:101], v6 offset:5120
    v_mfma_f32_16x16x32_bf16 v[60:63], v[80:83], a[64:67], v[60:63]
    ds_read_b64_tr_b16 v[102:103], v6 offset:7680
    buffer_load_dwordx4 a[36:39], v2, s[28:31], s74 offen offset:1024 sc1
    v_mfma_f32_16x16x32_bf16 v[44:47], v[84:87], a[24:27], v[44:47]
    ds_read_b64_tr_b16 v[104:105], v6 offset:5152
    v_mfma_f32_16x16x32_bf16 v[64:67], v[84:87], a[64:67], v[64:67]
    ds_read_b64_tr_b16 v[106:107], v6 offset:7712
    v_mfma_f32_16x16x32_bf16 v[48:51], v[88:91], a[24:27], v[48:51]
    ds_read_b64_tr_b16 v[108:109], v6 offset:5184
    v_mfma_f32_16x16x32_bf16 v[68:71], v[88:91], a[64:67], v[68:71]
    ds_read_b64_tr_b16 v[110:111], v6 offset:7744
    s_waitcnt lgkmcnt(6)
    v_mfma_f32_16x16x32_bf16 v[52:55], v[92:95], a[24:27], v[52:55]
    ds_read_b64_tr_b16 v[112:113], v6 offset:5216
    buffer_load_dwordx4 a[76:79], v2, s[28:31], s75 offen offset:1024 sc1
    v_mfma_f32_16x16x32_bf16 v[72:75], v[92:95], a[64:67], v[72:75]
    ds_read_b64_tr_b16 v[114:115], v6 offset:7776
    v_mfma_f32_16x16x32_bf16 v[56:59], v[96:99], a[24:27], v[56:59]
    ds_read_b64_tr_b16 v[116:117], v6 offset:5248
    v_mfma_f32_16x16x32_bf16 v[76:79], v[96:99], a[64:67], v[76:79]
    ds_read_b64_tr_b16 v[118:119], v6 offset:7808
    s_waitcnt vmcnt(4) lgkmcnt(4)
    v_mfma_f32_16x16x32_bf16 v[40:43], v[100:103], a[28:31], v[40:43]
    ds_read_b64_tr_b16 v[80:81], v6 offset:10240
    v_mfma_f32_16x16x32_bf16 v[60:63], v[100:103], a[68:71], v[60:63]
    ds_read_b64_tr_b16 v[82:83], v6 offset:12800
    v_mfma_f32_16x16x32_bf16 v[44:47], v[104:107], a[28:31], v[44:47]
    ds_read_b64_tr_b16 v[84:85], v6 offset:10272
    v_mfma_f32_16x16x32_bf16 v[64:67], v[104:107], a[68:71], v[64:67]
    ds_read_b64_tr_b16 v[86:87], v6 offset:12832
    v_mfma_f32_16x16x32_bf16 v[48:51], v[108:111], a[28:31], v[48:51]
    ds_read_b64_tr_b16 v[88:89], v6 offset:10304
    v_mfma_f32_16x16x32_bf16 v[68:71], v[108:111], a[68:71], v[68:71]
    ds_read_b64_tr_b16 v[90:91], v6 offset:12864
    s_waitcnt lgkmcnt(6)
    v_mfma_f32_16x16x32_bf16 v[52:55], v[112:115], a[28:31], v[52:55]
    ds_read_b64_tr_b16 v[92:93], v6 offset:10336
    v_mfma_f32_16x16x32_bf16 v[72:75], v[112:115], a[68:71], v[72:75]
    ds_read_b64_tr_b16 v[94:95], v6 offset:12896
    v_mfma_f32_16x16x32_bf16 v[56:59], v[116:119], a[28:31], v[56:59]
    ds_read_b64_tr_b16 v[96:97], v6 offset:10368
    v_mfma_f32_16x16x32_bf16 v[76:79], v[116:119], a[68:71], v[76:79]
    ds_read_b64_tr_b16 v[98:99], v6 offset:12928
    s_waitcnt vmcnt(2) lgkmcnt(4)
    v_mfma_f32_16x16x32_bf16 v[40:43], v[80:83], a[32:35], v[40:43]
    ds_read_b64_tr_b16 v[100:101], v6 offset:15360
    v_mfma_f32_16x16x32_bf16 v[60:63], v[80:83], a[72:75], v[60:63]
    ds_read_b64_tr_b16 v[102:103], v6 offset:17920
    v_mfma_f32_16x16x32_bf16 v[44:47], v[84:87], a[32:35], v[44:47]
    ds_read_b64_tr_b16 v[104:105], v6 offset:15392
    v_mfma_f32_16x16x32_bf16 v[64:67], v[84:87], a[72:75], v[64:67]
    ds_read_b64_tr_b16 v[106:107], v6 offset:17952
    v_mfma_f32_16x16x32_bf16 v[48:51], v[88:91], a[32:35], v[48:51]
    ds_read_b64_tr_b16 v[108:109], v6 offset:15424
    v_mfma_f32_16x16x32_bf16 v[68:71], v[88:91], a[72:75], v[68:71]
    ds_read_b64_tr_b16 v[110:111], v6 offset:17984
    s_waitcnt lgkmcnt(6)
    v_mfma_f32_16x16x32_bf16 v[52:55], v[92:95], a[32:35], v[52:55]
    ds_read_b64_tr_b16 v[112:113], v6 offset:15456
    v_mfma_f32_16x16x32_bf16 v[72:75], v[92:95], a[72:75], v[72:75]
    ds_read_b64_tr_b16 v[114:115], v6 offset:18016
    v_mfma_f32_16x16x32_bf16 v[56:59], v[96:99], a[32:35], v[56:59]
    ds_read_b64_tr_b16 v[116:117], v6 offset:15488
    v_mfma_f32_16x16x32_bf16 v[76:79], v[96:99], a[72:75], v[76:79]
    ds_read_b64_tr_b16 v[118:119], v6 offset:18048
    s_waitcnt vmcnt(0) lgkmcnt(4)
    v_mfma_f32_16x16x32_bf16 v[40:43], v[100:103], a[36:39], v[40:43]
    v_mfma_f32_16x16x32_bf16 v[60:63], v[100:103], a[76:79], v[60:63]
    v_mfma_f32_16x16x32_bf16 v[44:47], v[104:107], a[36:39], v[44:47]
    v_mfma_f32_16x16x32_bf16 v[64:67], v[104:107], a[76:79], v[64:67]
    v_mfma_f32_16x16x32_bf16 v[48:51], v[108:111], a[36:39], v[48:51]
    v_mfma_f32_16x16x32_bf16 v[68:71], v[108:111], a[76:79], v[68:71]
    s_waitcnt lgkmcnt(0)
    v_mfma_f32_16x16x32_bf16 v[52:55], v[112:115], a[36:39], v[52:55]
    v_mfma_f32_16x16x32_bf16 v[72:75], v[112:115], a[76:79], v[72:75]
    v_mfma_f32_16x16x32_bf16 v[56:59], v[116:119], a[36:39], v[56:59]
    v_mfma_f32_16x16x32_bf16 v[76:79], v[116:119], a[76:79], v[76:79]
    s_mul_i32 s60, s46, 5120
    s_add_u32 s60, s60, 20480
    v_add_u32 v3, s60, v2
    s_xor_b32 s61, s46, 1
    s_mul_i32 s61, s61, 5120
    s_add_u32 s61, s61, 20480
    v_add_u32 v4, s61, v2
    ds_write_b128 v3, v[60:63] offset:0
    ds_write_b128 v3, v[64:67] offset:1024
    ds_write_b128 v3, v[68:71] offset:2048
    ds_write_b128 v3, v[72:75] offset:3072
    ds_write_b128 v3, v[76:79] offset:4096
    s_waitcnt lgkmcnt(0)
    s_barrier
    ds_read_b128 v[60:63], v4 offset:0
    ds_read_b128 v[64:67], v4 offset:1024
    ds_read_b128 v[68:71], v4 offset:2048
    ds_read_b128 v[72:75], v4 offset:3072
    ds_read_b128 v[76:79], v4 offset:4096
    s_waitcnt lgkmcnt(4)
    v_pk_add_f32 v[40:41], v[40:41], v[60:61]
    v_pk_fma_f32 v[140:141], v[40:41], v[120:121], v[140:141]
    v_pk_add_f32 v[42:43], v[42:43], v[62:63]
    v_pk_fma_f32 v[142:143], v[42:43], v[122:123], v[142:143]
    s_waitcnt lgkmcnt(3)
    v_pk_add_f32 v[44:45], v[44:45], v[64:65]
    v_pk_fma_f32 v[144:145], v[44:45], v[124:125], v[144:145]
    v_pk_add_f32 v[46:47], v[46:47], v[66:67]
    v_pk_fma_f32 v[146:147], v[46:47], v[126:127], v[146:147]
    s_waitcnt lgkmcnt(2)
    v_pk_add_f32 v[48:49], v[48:49], v[68:69]
    v_pk_fma_f32 v[148:149], v[48:49], v[128:129], v[148:149]
    v_pk_add_f32 v[50:51], v[50:51], v[70:71]
    v_pk_fma_f32 v[150:151], v[50:51], v[130:131], v[150:151]
    s_waitcnt lgkmcnt(1)
    v_pk_add_f32 v[52:53], v[52:53], v[72:73]
    v_pk_fma_f32 v[152:153], v[52:53], v[132:133], v[152:153]
    v_pk_add_f32 v[54:55], v[54:55], v[74:75]
    v_pk_fma_f32 v[154:155], v[54:55], v[134:135], v[154:155]
    s_waitcnt lgkmcnt(0)
    v_pk_add_f32 v[56:57], v[56:57], v[76:77]
    v_pk_fma_f32 v[156:157], v[56:57], v[136:137], v[156:157]
    v_pk_add_f32 v[58:59], v[58:59], v[78:79]
    v_pk_fma_f32 v[158:159], v[58:59], v[138:139], v[158:159]
    v_cvt_pk_bf16_f32 v230, v140, v141
    v_cvt_pk_bf16_f32 v231, v142, v143
    v_cvt_pk_bf16_f32 v232, v144, v145
    v_cvt_pk_bf16_f32 v233, v146, v147
    v_cvt_pk_bf16_f32 v234, v148, v149
    v_cvt_pk_bf16_f32 v235, v150, v151
    v_cvt_pk_bf16_f32 v236, v152, v153
    v_cvt_pk_bf16_f32 v237, v154, v155
    v_cvt_pk_bf16_f32 v238, v156, v157
    v_cvt_pk_bf16_f32 v239, v158, v159
    v_mov_b32 v5, 0x3f803f80
    v_mov_b32 v8, 0
    v_mov_b32 v9, 0
    v_dot2_f32_bf16 v8, v230, v5, v8
    v_dot2_f32_bf16 v9, v230, v230, v9
    v_dot2_f32_bf16 v8, v231, v5, v8
    v_dot2_f32_bf16 v9, v231, v231, v9
    v_dot2_f32_bf16 v8, v232, v5, v8
    v_dot2_f32_bf16 v9, v232, v232, v9
    v_dot2_f32_bf16 v8, v233, v5, v8
    v_dot2_f32_bf16 v9, v233, v233, v9
    v_dot2_f32_bf16 v8, v234, v5, v8
    v_dot2_f32_bf16 v9, v234, v234, v9
    v_dot2_f32_bf16 v8, v235, v5, v8
    v_dot2_f32_bf16 v9, v235, v235, v9
    v_dot2_f32_bf16 v8, v236, v5, v8
    v_dot2_f32_bf16 v9, v236, v236, v9
    v_dot2_f32_bf16 v8, v237, v5, v8
    v_dot2_f32_bf16 v9, v237, v237, v9
    v_dot2_f32_bf16 v8, v238, v5, v8
    v_dot2_f32_bf16 v9, v238, v238, v9
    v_dot2_f32_bf16 v8, v239, v5, v8
    v_dot2_f32_bf16 v9, v239, v239, v9
    s_nop 1
    v_mov_b32 v10, v8
    v_mov_b32 v11, v9
    s_nop 0
    v_permlane16_swap_b32 v8, v10
    v_permlane16_swap_b32 v9, v11
    v_add_f32 v8, v8, v10
    v_add_f32 v9, v9, v11
    v_mov_b32 v10, v8
    v_mov_b32 v11, v9
    s_nop 0
    v_permlane32_swap_b32 v8, v10
    v_permlane32_swap_b32 v9, v11
    v_add_f32 v8, v8, v10
    v_add_f32 v9, v9, v11
    v_mov_b32 v10, s47
    v_mov_b32 v11, s47
    s_mov_b64 exec, 0xffff
    s_cmp_eq_u32 s55, 0
    s_cbranch_scc1 Lslow27
    buffer_store_dwordx4 v[8:11], v12, s[28:31], s65 offen
Ljoin28:
    s_mov_b64 exec, -1
    ds_write_b128 v32, a[100:103] offset:49152
    ds_write_b128 v32, a[104:107] offset:50176
    ds_write_b128 v32, a[108:111] offset:51200
    ds_write_b128 v33, a[112:115] offset:0
    ds_write_b128 v33, a[116:119] offset:1024
    ds_write_b128 v33, a[120:123] offset:2048
    ds_write_b128 v33, a[124:127] offset:12288
    ds_write_b128 v33, a[128:131] offset:13312
    ds_write_b128 v33, a[132:135] offset:14336
    ds_write_b128 v33, a[136:139] offset:24576
    ds_write_b128 v33, a[140:143] offset:25600
    ds_write_b128 v33, a[144:147] offset:26624
    v_lshlrev_b32 v140, 16, v230
    v_and_b32 v141, 0xffff0000, v230
    v_lshlrev_b32 v142, 16, v231
    v_and_b32 v143, 0xffff0000, v231
    v_lshlrev_b32 v144, 16, v232
    v_and_b32 v145, 0xffff0000, v232
    v_lshlrev_b32 v146, 16, v233
    v_and_b32 v147, 0xffff0000, v233
    v_lshlrev_b32 v148, 16, v234
    v_and_b32 v149, 0xffff0000, v234
    v_lshlrev_b32 v150, 16, v235
    v_and_b32 v151, 0xffff0000, v235
    v_lshlrev_b32 v152, 16, v236
    v_and_b32 v153, 0xffff0000, v236
    v_lshlrev_b32 v154, 16, v237
    v_and_b32 v155, 0xffff0000, v237
    v_lshlrev_b32 v156, 16, v238
    v_and_b32 v157, 0xffff0000, v238
    v_lshlrev_b32 v158, 16, v239
    v_and_b32 v159, 0xffff0000, v239
    s_mov_b32 s54, 32768
Ls29:
    buffer_load_dwordx4 v[40:43], v14, s[28:31], s64 offen sc1
    buffer_load_dwordx4 v[44:47], v14, s[28:31], s64 offen offset:2048 sc1
    s_waitcnt vmcnt(0)
    v_xor_b32 v15, s47, v42
    v_bitop3_b32 v15, v15, v46, s47 bitop3:0xf6
    v_cmp_ne_u32 vcc, 0, v15
    s_cbranch_vccz Lsd30
    s_sub_u32 s54, s54, 1
    s_cbranch_scc0 Ls29
Lsd30:
    v_add_f32 v8, v40, v44
    v_add_f32 v9, v41, v45
    v_mov_b32 v10, v8
    v_mov_b32 v11, v9
    s_nop 0
    v_permlane16_swap_b32 v8, v10
    v_permlane16_swap_b32 v9, v11
    v_add_f32 v8, v8, v10
    v_add_f32 v9, v9, v11
    v_mov_b32 v10, v8
    v_mov_b32 v11, v9
    s_nop 0
    v_permlane32_swap_b32 v8, v10
    v_permlane32_swap_b32 v9, v11
    v_add_f32 v8, v8, v10
    v_add_f32 v9, v9, v11
    v_mul_f32 v8, 0x3acccccd, v8
    v_mul_f32 v10, v8, v8
    v_mov_b32 v11, 0x3acccccd
    v_fma_f32 v9, v9, v11, -v10
    v_max_f32 v9, 0, v9
    v_add_f32 v9, 0x3727c5ac, v9
    v_rsq_f32 v9, v9
    s_nop 0
    v_mul_f32 v8, v8, v9
    v_sub_f32 v8, 0, v8
    v_mov_b32 v10, v9
    v_mov_b32 v11, v9
    v_mov_b32 v9, v8
    v_pk_fma_f32 v[140:141], v[140:141], v[10:11], v[8:9]
    v_pk_fma_f32 v[142:143], v[142:143], v[10:11], v[8:9]
    v_pk_fma_f32 v[144:145], v[144:145], v[10:11], v[8:9]
    v_pk_fma_f32 v[146:147], v[146:147], v[10:11], v[8:9]
    v_pk_fma_f32 v[148:149], v[148:149], v[10:11], v[8:9]
    v_pk_fma_f32 v[150:151], v[150:151], v[10:11], v[8:9]
    v_pk_fma_f32 v[152:153], v[152:153], v[10:11], v[8:9]
    v_pk_fma_f32 v[154:155], v[154:155], v[10:11], v[8:9]
    v_pk_fma_f32 v[156:157], v[156:157], v[10:11], v[8:9]
    v_pk_fma_f32 v[158:159], v[158:159], v[10:11], v[8:9]
    v_pk_fma_f32 v[140:141], v[140:141], v[200:201], v[180:181]
    v_pk_fma_f32 v[142:143], v[142:143], v[202:203], v[182:183]
    v_pk_fma_f32 v[144:145], v[144:145], v[204:205], v[184:185]
    v_pk_fma_f32 v[146:147], v[146:147], v[206:207], v[186:187]
    v_pk_fma_f32 v[148:149], v[148:149], v[208:209], v[188:189]
    v_pk_fma_f32 v[150:151], v[150:151], v[210:211], v[190:191]
    v_pk_fma_f32 v[152:153], v[152:153], v[212:213], v[192:193]
    v_pk_fma_f32 v[154:155], v[154:155], v[214:215], v[194:195]
    v_pk_fma_f32 v[156:157], v[156:157], v[216:217], v[196:197]
    v_pk_fma_f32 v[158:159], v[158:159], v[218:219], v[198:199]
    v_cvt_pk_bf16_f32 v40, v140, v141
    v_cvt_pk_bf16_f32 v41, v142, v143
    v_cvt_pk_bf16_f32 v42, v144, v145
    v_cvt_pk_bf16_f32 v43, v146, v147
    v_cvt_pk_bf16_f32 v44, v148, v149
    v_cvt_pk_bf16_f32 v45, v150, v151
    v_cvt_pk_bf16_f32 v46, v152, v153
    v_cvt_pk_bf16_f32 v47, v154, v155
    v_cvt_pk_bf16_f32 v48, v156, v157
    v_cvt_pk_bf16_f32 v49, v158, v159
    v_mov_b32 v50, v48
    v_mov_b32 v51, v49
    v_permlane16_swap_b32 v40, v42
    v_permlane16_swap_b32 v41, v43
    v_permlane16_swap_b32 v44, v46
    v_permlane16_swap_b32 v45, v47
    v_permlane16_swap_b32 v48, v50
    v_permlane16_swap_b32 v49, v51
    buffer_store_dwordx4 v[40:43], v16, s[28:31], s66 offen
    buffer_store_dwordx4 v[44:47], v16, s[28:31], s66 offen offset:1024
    buffer_store_dwordx4 v[48:51], v17, s[28:31], s66 offen offset:2048
    s_waitcnt vmcnt(0)
    s_lshl_b32 s60, s44, 8
    s_add_u32 s60, s60, 16384
    s_lshl_b32 s61, s45, 4
    s_lshl_b32 s62, s46, 2
    s_add_u32 s61, s61, s62
    v_mov_b32 v8, s61
    v_mov_b32 v9, s47
    s_mov_b64 exec, 1
    s_cmp_eq_u32 s55, 0
    s_cbranch_scc1 Lslow31
    buffer_store_dword v9, v8, s[28:31], s60 offen
Ljoin32:
    s_mov_b64 exec, -1
    s_or_b32 s60, s2, s46
    s_cmp_lg_u32 s60, 0
    s_cbranch_scc1 L_noepoch
    v_mov_b32 v8, 0
    v_mov_b32 v9, s47
    s_mov_b64 exec, 1
    buffer_store_dword v9, v8, s[28:31], 0 offen sc1
    s_mov_b64 exec, -1
L_noepoch:
    ds_write_b128 v33, a[148:151] offset:36864
    ds_write_b128 v33, a[152:155] offset:37888
    ds_write_b128 v33, a[156:159] offset:38912
    ds_write_b128 v33, a[160:163] offset:49152
    ds_write_b128 v33, a[164:167] offset:50176
    ds_write_b128 v33, a[168:171] offset:51200
    ds_write_b128 v34, a[172:175] offset:0
    ds_write_b128 v34, a[176:179] offset:1024
    ds_write_b128 v34, a[180:183] offset:2048
    ds_write_b128 v34, a[184:187] offset:12288
    ds_write_b128 v34, a[188:191] offset:13312
    ds_write_b128 v34, a[192:195] offset:14336
    s_mul_i32 s72, s51, 48
    s_mul_i32 s60, s52, 24
    s_add_u32 s72, s72, s60
    s_add_u32 s72, s72, s53
    s_mul_i32 s72, s72, 5120
    s_add_u32 s72, s72, 26214400
    s_mul_i32 s73, s46, 5120
    v_lshrrev_b32 v3, 2, v1
    v_mul_u32_u24 v3, 96, v3
    v_and_b32 v4, 3, v1
    v_lshl_add_u32 v5, v4, 3, v3
    v_add_u32 v6, 61440, v5
    v_add_u32 v7, 122880, v5
    s_lshl_b32 s74, s44, 2
    s_add_u32 s74, s74, s46
    s_mul_i32 s64, s74, 98304
    s_mul_i32 s61, s45, 3072
    s_add_u32 s64, s64, s61
    s_add_u32 s64, s64, 16777216
    s_add_u32 s65, s64, 49152
    s_mul_i32 s74, s74, 40960
    s_add_u32 s74, s74, 1048576
    s_add_u32 s75, s74, 20480
    s_lshl_b32 s60, s44, 8
    s_add_u32 s60, s60, 16384
    v_bfe_u32 v3, v1, 1, 3
    v_lshlrev_b32 v3, 5, v3
    v_and_b32 v4, 1, v1
    v_lshl_add_u32 v3, v4, 2, v3
    s_lshl_b32 s61, s53, 4
    s_lshl_b32 s62, s52, 3
    s_add_u32 s61, s61, s62
    v_add_u32 v3, s61, v3
    s_waitcnt lgkmcnt(0)
    s_mov_b32 s54, 32768
Lp33:
    buffer_load_dword v4, v3, s[28:31], s60 offen offset:0 sc1
    s_waitcnt vmcnt(0)
    v_cmp_ne_u32 vcc, s47, v4
    s_cbranch_vccz Lpd34
    s_sub_u32 s54, s54, 1
    s_cbranch_scc0 Lp33
Lpd34:
    s_cmp_eq_u32 s55, 0
    s_cbranch_scc1 Lacq35
Lacqj36:
    s_cmp_lg_u32 s46, 1
    s_cbranch_scc1 Lct37
    s_getpc_b64 s[58:59]
Lpc38:
    s_add_u32 s58, s58, L_c5-Lpc38
    s_addc_u32 s59, s59, 0
    s_lshr_b32 s100, s2, 3
    v_lshl_add_u32 v204, v1, 5, s100
    v_lshlrev_b32 v204, 7, v204
    v_min_u32 v204, L_last-L_c5, v204
    s_mov_b64 exec, 7
    global_load_dword v205, v204, s[58:59]
    s_mov_b64 exec, -1
Lct37:
    buffer_load_dwordx4 a[0:3], v2, s[28:31], s74 offen offset:0 sc1
    buffer_load_dwordx4 a[100:103], v2, s[28:31], s75 offen offset:0 sc1
    buffer_load_dwordx4 a[4:7], v2, s[28:31], s74 offen offset:1024 sc1
    buffer_load_dwordx4 a[104:107], v2, s[28:31], s75 offen offset:1024 sc1
    buffer_load_dwordx4 a[8:11], v2, s[28:31], s74 offen offset:2048 sc1
    buffer_load_dwordx4 a[108:111], v2, s[28:31], s75 offen offset:2048 sc1
    v_and_b32 v8, 7, v1
    v_bfe_u32 v9, v1, 3, 1
    v_mul_u32_u24 v9, 49152, v9
    v_lshl_add_u32 v9, v8, 7, v9
    s_barrier
    ds_read_b64_tr_b16 v[136:137], v5 offset:49152
    ds_read_b64_tr_b16 v[138:139], v5 offset:50688
    ds_read_b64_tr_b16 v[140:141], v5 offset:52224
    ds_read_b64_tr_b16 v[142:143], v5 offset:53760
    ds_read_b64_tr_b16 v[144:145], v5 offset:49184
    ds_read_b64_tr_b16 v[146:147], v5 offset:50720
    ds_read_b64_tr_b16 v[148:149], v5 offset:52256
    ds_read_b64_tr_b16 v[150:151], v5 offset:53792
    ds_read_b64_tr_b16 v[152:153], v5 offset:49216
    ds_read_b64_tr_b16 v[154:155], v5 offset:50752
    ds_read_b64_tr_b16 v[156:157], v5 offset:52288
    ds_read_b64_tr_b16 v[158:159], v5 offset:53824
    s_waitcnt vmcnt(4) lgkmcnt(6)
    v_mfma_f32_16x16x32_bf16 v[40:43], v[136:139], a[0:3], 0
    ds_read_b64_tr_b16 v[160:161], v5 offset:55296
    buffer_load_dwordx4 a[12:15], v2, s[28:31], s74 offen offset:3072 sc1
    s_add_u32 s74, s74, 4096
    v_mfma_f32_16x16x32_bf16 v[44:47], v[136:139], a[100:103], 0
    ds_read_b64_tr_b16 v[162:163], v5 offset:56832
    v_mfma_f32_16x16x32_bf16 v[48:51], v[140:143], a[0:3], 0
    ds_read_b64_tr_b16 v[164:165], v5 offset:58368
    v_mfma_f32_16x16x32_bf16 v[52:55], v[140:143], a[100:103], 0
    ds_read_b64_tr_b16 v[166:167], v5 offset:59904
    buffer_load_dwordx4 a[112:115], v2, s[28:31], s75 offen offset:3072 sc1
    s_add_u32 s75, s75, 4096
    v_mfma_f32_16x16x32_bf16 v[56:59], v[144:147], a[0:3], 0
    ds_read_b64_tr_b16 v[136:137], v5 offset:55328
    v_mfma_f32_16x16x32_bf16 v[60:63], v[144:147], a[100:103], 0
    ds_read_b64_tr_b16 v[138:139], v5 offset:56864
    s_waitcnt lgkmcnt(6)
    v_mfma_f32_16x16x32_bf16 v[64:67], v[148:151], a[0:3], 0
    ds_read_b64_tr_b16 v[140:141], v5 offset:58400
    buffer_load_dwordx4 a[16:19], v2, s[28:31], s74 offen offset:0 sc1
    v_mfma_f32_16x16x32_bf16 v[68:71], v[148:151], a[100:103], 0
    ds_read_b64_tr_b16 v[142:143], v5 offset:59936
    v_mfma_f32_16x16x32_bf16 v[72:75], v[152:155], a[0:3], 0
    ds_read_b64_tr_b16 v[144:145], v5 offset:55360
    v_mfma_f32_16x16x32_bf16 v[76:79], v[152:155], a[100:103], 0
    ds_read_b64_tr_b16 v[146:147], v5 offset:56896
    buffer_load_dwordx4 a[116:119], v2, s[28:31], s75 offen offset:0 sc1
    v_mfma_f32_16x16x32_bf16 v[80:83], v[156:159], a[0:3], 0
    ds_read_b64_tr_b16 v[148:149], v5 offset:58432
    v_mfma_f32_16x16x32_bf16 v[84:87], v[156:159], a[100:103], 0
    ds_read_b64_tr_b16 v[150:151], v5 offset:59968
    s_waitcnt vmcnt(6) lgkmcnt(6)
    v_mfma_f32_16x16x32_bf16 v[40:43], v[160:163], a[4:7], v[40:43]
    ds_read_b64_tr_b16 v[152:153], v6 offset:0
    buffer_load_dwordx4 a[20:23], v2, s[28:31], s74 offen offset:1024 sc1
    v_mfma_f32_16x16x32_bf16 v[44:47], v[160:163], a[104:107], v[44:47]
    ds_read_b64_tr_b16 v[154:155], v6 offset:1536
    v_mfma_f32_16x16x32_bf16 v[48:51], v[164:167], a[4:7], v[48:51]
    ds_read_b64_tr_b16 v[156:157], v6 offset:3072
    v_mfma_f32_16x16x32_bf16 v[52:55], v[164:167], a[104:107], v[52:55]
    ds_read_b64_tr_b16 v[158:159], v6 offset:4608
    buffer_load_dwordx4 a[120:123], v2, s[28:31], s75 offen offset:1024 sc1
    v_mfma_f32_16x16x32_bf16 v[56:59], v[136:139], a[4:7], v[56:59]
    ds_read_b64_tr_b16 v[160:161], v6 offset:32
    v_mfma_f32_16x16x32_bf16 v[60:63], v[136:139], a[104:107], v[60:63]
    ds_read_b64_tr_b16 v[162:163], v6 offset:1568
    s_waitcnt lgkmcnt(6)
    v_mfma_f32_16x16x32_bf16 v[64:67], v[140:143], a[4:7], v[64:67]
    ds_read_b64_tr_b16 v[164:165], v6 offset:3104
    buffer_load_dwordx4 a[24:27], v2, s[28:31], s74 offen offset:2048 sc1
    v_mfma_f32_16x16x32_bf16 v[68:71], v[140:143], a[104:107], v[68:71]
    ds_read_b64_tr_b16 v[166:167], v6 offset:4640
    v_mfma_f32_16x16x32_bf16 v[72:75], v[144:147], a[4:7], v[72:75]
    ds_read_b64_tr_b16 v[136:137], v6 offset:64
    v_mfma_f32_16x16x32_bf16 v[76:79], v[144:147], a[104:107], v[76:79]
    ds_read_b64_tr_b16 v[138:139], v6 offset:1600
    buffer_load_dwordx4 a[124:127], v2, s[28:31], s75 offen offset:2048 sc1
    v_mfma_f32_16x16x32_bf16 v[80:83], v[148:151], a[4:7], v[80:83]
    ds_read_b64_tr_b16 v[140:141], v6 offset:3136
    v_mfma_f32_16x16x32_bf16 v[84:87], v[148:151], a[104:107], v[84:87]
    ds_read_b64_tr_b16 v[142:143], v6 offset:4672
    s_waitcnt vmcnt(8) lgkmcnt(6)
    v_mfma_f32_16x16x32_bf16 v[40:43], v[152:155], a[8:11], v[40:43]
    ds_read_b64_tr_b16 v[144:145], v6 offset:6144
    buffer_load_dwordx4 a[28:31], v2, s[28:31], s74 offen offset:3072 sc1
    s_add_u32 s74, s74, 4096
    v_mfma_f32_16x16x32_bf16 v[44:47], v[152:155], a[108:111], v[44:47]
    ds_read_b64_tr_b16 v[146:147], v6 offset:7680
    v_mfma_f32_16x16x32_bf16 v[48:51], v[156:159], a[8:11], v[48:51]
    ds_read_b64_tr_b16 v[148:149], v6 offset:9216
    v_mfma_f32_16x16x32_bf16 v[52:55], v[156:159], a[108:111], v[52:55]
    ds_read_b64_tr_b16 v[150:151], v6 offset:10752
    buffer_load_dwordx4 a[128:131], v2, s[28:31], s75 offen offset:3072 sc1
    s_add_u32 s75, s75, 4096
    v_mfma_f32_16x16x32_bf16 v[56:59], v[160:163], a[8:11], v[56:59]
    ds_read_b64_tr_b16 v[152:153], v6 offset:6176
    v_mfma_f32_16x16x32_bf16 v[60:63], v[160:163], a[108:111], v[60:63]
    ds_read_b64_tr_b16 v[154:155], v6 offset:7712
    s_waitcnt lgkmcnt(6)
    v_mfma_f32_16x16x32_bf16 v[64:67], v[164:167], a[8:11], v[64:67]
    ds_read_b64_tr_b16 v[156:157], v6 offset:9248
    buffer_load_dwordx4 a[32:35], v2, s[28:31], s74 offen offset:0 sc1
    v_mfma_f32_16x16x32_bf16 v[68:71], v[164:167], a[108:111], v[68:71]
    ds_read_b64_tr_b16 v[158:159], v6 offset:10784
    v_mfma_f32_16x16x32_bf16 v[72:75], v[136:139], a[8:11], v[72:75]
    ds_read_b64_tr_b16 v[160:161], v6 offset:6208
    v_mfma_f32_16x16x32_bf16 v[76:79], v[136:139], a[108:111], v[76:79]
    ds_read_b64_tr_b16 v[162:163], v6 offset:7744
    buffer_load_dwordx4 a[132:135], v2, s[28:31], s75 offen offset:0 sc1
    v_mfma_f32_16x16x32_bf16 v[80:83], v[140:143], a[8:11], v[80:83]
    ds_read_b64_tr_b16 v[164:165], v6 offset:9280
    v_mfma_f32_16x16x32_bf16 v[84:87], v[140:143], a[108:111], v[84:87]
    ds_read_b64_tr_b16 v[166:167], v6 offset:10816
    s_barrier
    s_waitcnt vmcnt(10) lgkmcnt(6)
    v_mfma_f32_16x16x32_bf16 v[40:43], v[144:147], a[12:15], v[40:43]
    ds_read_b64_tr_b16 v[136:137], v6 offset:12288
    buffer_load_dwordx4 a[36:39], v2, s[28:31], s74 offen offset:1024 sc1
    v_mfma_f32_16x16x32_bf16 v[44:47], v[144:147], a[112:115], v[44:47]
    ds_read_b64_tr_b16 v[138:139], v6 offset:13824
    v_mfma_f32_16x16x32_bf16 v[48:51], v[148:151], a[12:15], v[48:51]
    ds_read_b64_tr_b16 v[140:141], v6 offset:15360
    v_mfma_f32_16x16x32_bf16 v[52:55], v[148:151], a[112:115], v[52:55]
    ds_read_b64_tr_b16 v[142:143], v6 offset:16896
    buffer_load_dwordx4 a[136:139], v2, s[28:31], s75 offen offset:1024 sc1
    v_mfma_f32_16x16x32_bf16 v[56:59], v[152:155], a[12:15], v[56:59]
    ds_read_b64_tr_b16 v[144:145], v6 offset:12320
    v_mfma_f32_16x16x32_bf16 v[60:63], v[152:155], a[112:115], v[60:63]
    ds_read_b64_tr_b16 v[146:147], v6 offset:13856
    s_waitcnt lgkmcnt(6)
    v_mfma_f32_16x16x32_bf16 v[64:67], v[156:159], a[12:15], v[64:67]
    ds_read_b64_tr_b16 v[148:149], v6 offset:15392
    buffer_load_dwordx4 a[40:43], v2, s[28:31], s74 offen offset:2048 sc1
    v_mfma_f32_16x16x32_bf16 v[68:71], v[156:159], a[112:115], v[68:71]
    ds_read_b64_tr_b16 v[150:151], v6 offset:16928
    v_mfma_f32_16x16x32_bf16 v[72:75], v[160:163], a[12:15], v[72:75]
    ds_read_b64_tr_b16 v[152:153], v6 offset:12352
    v_mfma_f32_16x16x32_bf16 v[76:79], v[160:163], a[112:115], v[76:79]
    ds_read_b64_tr_b16 v[154:155], v6 offset:13888
    buffer_load_dwordx4 a[140:143], v2, s[28:31], s75 offen offset:2048 sc1
    v_mfma_f32_16x16x32_bf16 v[80:83], v[164:167], a[12:15], v[80:83]
    ds_read_b64_tr_b16 v[156:157], v6 offset:15424
    v_mfma_f32_16x16x32_bf16 v[84:87], v[164:167], a[112:115], v[84:87]
    ds_read_b64_tr_b16 v[158:159], v6 offset:16960
    s_waitcnt vmcnt(12) lgkmcnt(6)
    v_mfma_f32_16x16x32_bf16 v[40:43], v[136:139], a[16:19], v[40:43]
    ds_read_b64_tr_b16 v[160:161], v6 offset:18432
    v_mfma_f32_16x16x32_bf16 v[44:47], v[136:139], a[116:119], v[44:47]
    ds_read_b64_tr_b16 v[162:163], v6 offset:19968
    buffer_load_dwordx4 a[44:47], v2, s[28:31], s74 offen offset:3072 sc1
    s_add_u32 s74, s74, 4096
    v_mfma_f32_16x16x32_bf16 v[48:51], v[140:143], a[16:19], v[48:51]
    ds_read_b64_tr_b16 v[164:165], v6 offset:21504
    v_mfma_f32_16x16x32_bf16 v[52:55], v[140:143], a[116:119], v[52:55]
    ds_read_b64_tr_b16 v[166:167], v6 offset:23040
    v_mfma_f32_16x16x32_bf16 v[56:59], v[144:147], a[16:19], v[56:59]
    ds_read_b64_tr_b16 v[136:137], v6 offset:18464
    v_mfma_f32_16x16x32_bf16 v[60:63], v[144:147], a[116:119], v[60:63]
    ds_read_b64_tr_b16 v[138:139], v6 offset:20000
    s_waitcnt lgkmcnt(6)
    v_mfma_f32_16x16x32_bf16 v[64:67], v[148:151], a[16:19], v[64:67]
    ds_read_b64_tr_b16 v[140:141], v6 offset:21536
    v_mfma_f32_16x16x32_bf16 v[68:71], v[148:151], a[116:119], v[68:71]
    ds_read_b64_tr_b16 v[142:143], v6 offset:23072
    buffer_load_dwordx4 a[144:147], v2, s[28:31], s75 offen offset:3072 sc1
    s_add_u32 s75, s75, 4096
    v_mfma_f32_16x16x32_bf16 v[72:75], v[152:155], a[16:19], v[72:75]
    ds_read_b64_tr_b16 v[144:145], v6 offset:18496
    v_mfma_f32_16x16x32_bf16 v[76:79], v[152:155], a[116:119], v[76:79]
    ds_read_b64_tr_b16 v[146:147], v6 offset:20032
    v_mfma_f32_16x16x32_bf16 v[80:83], v[156:159], a[16:19], v[80:83]
    ds_read_b64_tr_b16 v[148:149], v6 offset:21568
    v_mfma_f32_16x16x32_bf16 v[84:87], v[156:159], a[116:119], v[84:87]
    ds_read_b64_tr_b16 v[150:151], v6 offset:23104
    s_waitcnt vmcnt(12) lgkmcnt(6)
    v_mfma_f32_16x16x32_bf16 v[40:43], v[160:163], a[20:23], v[40:43]
    ds_read_b64_tr_b16 v[152:153], v6 offset:24576
    buffer_load_dwordx4 a[48:51], v2, s[28:31], s74 offen offset:0 sc1
    v_mfma_f32_16x16x32_bf16 v[44:47], v[160:163], a[120:123], v[44:47]
    ds_read_b64_tr_b16 v[154:155], v6 offset:26112
    v_mfma_f32_16x16x32_bf16 v[48:51], v[164:167], a[20:23], v[48:51]
    ds_read_b64_tr_b16 v[156:157], v6 offset:27648
    v_mfma_f32_16x16x32_bf16 v[52:55], v[164:167], a[120:123], v[52:55]
    ds_read_b64_tr_b16 v[158:159], v6 offset:29184
    buffer_load_dwordx4 a[148:151], v2, s[28:31], s75 offen offset:0 sc1
    v_mfma_f32_16x16x32_bf16 v[56:59], v[136:139], a[20:23], v[56:59]
    ds_read_b64_tr_b16 v[160:161], v6 offset:24608
    v_mfma_f32_16x16x32_bf16 v[60:63], v[136:139], a[120:123], v[60:63]
    ds_read_b64_tr_b16 v[162:163], v6 offset:26144
    s_waitcnt lgkmcnt(6)
    v_mfma_f32_16x16x32_bf16 v[64:67], v[140:143], a[20:23], v[64:67]
    ds_read_b64_tr_b16 v[164:165], v6 offset:27680
    s_add_u32 m0, s77, 147456
    s_nop 0
    buffer_load_dwordx4 v2, s[28:31], s76 offen offset:0 sc1 lds
    v_mfma_f32_16x16x32_bf16 v[68:71], v[140:143], a[120:123], v[68:71]
    ds_read_b64_tr_b16 v[166:167], v6 offset:29216
    v_mfma_f32_16x16x32_bf16 v[72:75], v[144:147], a[20:23], v[72:75]
    ds_read_b64_tr_b16 v[136:137], v6 offset:24640
    v_mfma_f32_16x16x32_bf16 v[76:79], v[144:147], a[120:123], v[76:79]
    ds_read_b64_tr_b16 v[138:139], v6 offset:26176
    buffer_load_dwordx4 v2, s[28:31], s76 offen offset:1024 sc1 lds
    v_mfma_f32_16x16x32_bf16 v[80:83], v[148:151], a[20:23], v[80:83]
    ds_read_b64_tr_b16 v[140:141], v6 offset:27712
    v_mfma_f32_16x16x32_bf16 v[84:87], v[148:151], a[120:123], v[84:87]
    ds_read_b64_tr_b16 v[142:143], v6 offset:29248
    s_waitcnt vmcnt(14) lgkmcnt(6)
    v_mfma_f32_16x16x32_bf16 v[40:43], v[152:155], a[24:27], v[40:43]
    ds_read_b64_tr_b16 v[144:145], v6 offset:30720
    buffer_load_dwordx4 v2, s[28:31], s76 offen offset:2048 sc1 lds
    s_add_u32 s76, s76, 12288
    v_mfma_f32_16x16x32_bf16 v[44:47], v[152:155], a[124:127], v[44:47]
    ds_read_b64_tr_b16 v[146:147], v6 offset:32256
    v_mfma_f32_16x16x32_bf16 v[48:51], v[156:159], a[24:27], v[48:51]
    ds_read_b64_tr_b16 v[148:149], v6 offset:33792
    v_mfma_f32_16x16x32_bf16 v[52:55], v[156:159], a[124:127], v[52:55]
    ds_read_b64_tr_b16 v[150:151], v6 offset:35328
    s_add_u32 m0, s77, 0
    s_nop 0
    buffer_load_dwordx4 v2, s[28:31], s76 offen offset:0 sc1 lds
    v_mfma_f32_16x16x32_bf16 v[56:59], v[160:163], a[24:27], v[56:59]
    ds_read_b64_tr_b16 v[152:153], v6 offset:30752
    v_mfma_f32_16x16x32_bf16 v[60:63], v[160:163], a[124:127], v[60:63]
    ds_read_b64_tr_b16 v[154:155], v6 offset:32288
    s_waitcnt lgkmcnt(6)
    v_mfma_f32_16x16x32_bf16 v[64:67], v[164:167], a[24:27], v[64:67]
    ds_read_b64_tr_b16 v[156:157], v6 offset:33824
    buffer_load_dwordx4 v2, s[28:31], s76 offen offset:1024 sc1 lds
    v_mfma_f32_16x16x32_bf16 v[68:71], v[164:167], a[124:127], v[68:71]
    ds_read_b64_tr_b16 v[158:159], v6 offset:35360
    v_mfma_f32_16x16x32_bf16 v[72:75], v[136:139], a[24:27], v[72:75]
    ds_read_b64_tr_b16 v[160:161], v6 offset:30784
    v_mfma_f32_16x16x32_bf16 v[76:79], v[136:139], a[124:127], v[76:79]
    ds_read_b64_tr_b16 v[162:163], v6 offset:32320
    buffer_load_dwordx4 v2, s[28:31], s76 offen offset:2048 sc1 lds
    s_add_u32 s76, s76, 12288
    v_mfma_f32_16x16x32_bf16 v[80:83], v[140:143], a[24:27], v[80:83]
    ds_read_b64_tr_b16 v[164:165], v6 offset:33856
    v_mfma_f32_16x16x32_bf16 v[84:87], v[140:143], a[124:127], v[84:87]
    ds_read_b64_tr_b16 v[166:167], v6 offset:35392
    s_barrier
    s_waitcnt vmcnt(16) lgkmcnt(6)
    v_mfma_f32_16x16x32_bf16 v[40:43], v[144:147], a[28:31], v[40:43]
    ds_read_b64_tr_b16 v[136:137], v6 offset:36864
    buffer_load_dwordx4 a[52:55], v2, s[28:31], s74 offen offset:1024 sc1
    v_mfma_f32_16x16x32_bf16 v[44:47], v[144:147], a[128:131], v[44:47]
    ds_read_b64_tr_b16 v[138:139], v6 offset:38400
    v_mfma_f32_16x16x32_bf16 v[48:51], v[148:151], a[28:31], v[48:51]
    ds_read_b64_tr_b16 v[140:141], v6 offset:39936
    v_mfma_f32_16x16x32_bf16 v[52:55], v[148:151], a[128:131], v[52:55]
    ds_read_b64_tr_b16 v[142:143], v6 offset:41472
    buffer_load_dwordx4 a[152:155], v2, s[28:31], s75 offen offset:1024 sc1
    v_mfma_f32_16x16x32_bf16 v[56:59], v[152:155], a[28:31], v[56:59]
    ds_read_b64_tr_b16 v[144:145], v6 offset:36896
    v_mfma_f32_16x16x32_bf16 v[60:63], v[152:155], a[128:131], v[60:63]
    ds_read_b64_tr_b16 v[146:147], v6 offset:38432
    s_waitcnt lgkmcnt(6)
    v_mfma_f32_16x16x32_bf16 v[64:67], v[156:159], a[28:31], v[64:67]
    ds_read_b64_tr_b16 v[148:149], v6 offset:39968
    buffer_load_dwordx4 a[56:59], v2, s[28:31], s74 offen offset:2048 sc1
    v_mfma_f32_16x16x32_bf16 v[68:71], v[156:159], a[128:131], v[68:71]
    ds_read_b64_tr_b16 v[150:151], v6 offset:41504
    v_mfma_f32_16x16x32_bf16 v[72:75], v[160:163], a[28:31], v[72:75]
    ds_read_b64_tr_b16 v[152:153], v6 offset:36928
    v_mfma_f32_16x16x32_bf16 v[76:79], v[160:163], a[128:131], v[76:79]
    ds_read_b64_tr_b16 v[154:155], v6 offset:38464
    buffer_load_dwordx4 a[156:159], v2, s[28:31], s75 offen offset:2048 sc1
    v_mfma_f32_16x16x32_bf16 v[80:83], v[164:167], a[28:31], v[80:83]
    ds_read_b64_tr_b16 v[156:157], v6 offset:40000
    v_mfma_f32_16x16x32_bf16 v[84:87], v[164:167], a[128:131], v[84:87]
    ds_read_b64_tr_b16 v[158:159], v6 offset:41536
    s_waitcnt vmcnt(18) lgkmcnt(6)
    v_mfma_f32_16x16x32_bf16 v[40:43], v[136:139], a[32:35], v[40:43]
    ds_read_b64_tr_b16 v[160:161], v6 offset:43008
    v_mfma_f32_16x16x32_bf16 v[44:47], v[136:139], a[132:135], v[44:47]
    ds_read_b64_tr_b16 v[162:163], v6 offset:44544
    buffer_load_dwordx4 a[60:63], v2, s[28:31], s74 offen offset:3072 sc1
    s_add_u32 s74, s74, 4096
    v_mfma_f32_16x16x32_bf16 v[48:51], v[140:143], a[32:35], v[48:51]
    ds_read_b64_tr_b16 v[164:165], v6 offset:46080
    v_mfma_f32_16x16x32_bf16 v[52:55], v[140:143], a[132:135], v[52:55]
    ds_read_b64_tr_b16 v[166:167], v6 offset:47616
    v_mfma_f32_16x16x32_bf16 v[56:59], v[144:147], a[32:35], v[56:59]
    ds_read_b64_tr_b16 v[136:137], v6 offset:43040
    v_mfma_f32_16x16x32_bf16 v[60:63], v[144:147], a[132:135], v[60:63]
    ds_read_b64_tr_b16 v[138:139], v6 offset:44576
    s_waitcnt lgkmcnt(6)
    v_mfma_f32_16x16x32_bf16 v[64:67], v[148:151], a[32:35], v[64:67]
    ds_read_b64_tr_b16 v[140:141], v6 offset:46112
    v_mfma_f32_16x16x32_bf16 v[68:71], v[148:151], a[132:135], v[68:71]
    ds_read_b64_tr_b16 v[142:143], v6 offset:47648
    buffer_load_dwordx4 a[160:163], v2, s[28:31], s75 offen offset:3072 sc1
    s_add_u32 s75, s75, 4096
    v_mfma_f32_16x16x32_bf16 v[72:75], v[152:155], a[32:35], v[72:75]
    ds_read_b64_tr_b16 v[144:145], v6 offset:43072
    v_mfma_f32_16x16x32_bf16 v[76:79], v[152:155], a[132:135], v[76:79]
    ds_read_b64_tr_b16 v[146:147], v6 offset:44608
    v_mfma_f32_16x16x32_bf16 v[80:83], v[156:159], a[32:35], v[80:83]
    ds_read_b64_tr_b16 v[148:149], v6 offset:46144
    v_mfma_f32_16x16x32_bf16 v[84:87], v[156:159], a[132:135], v[84:87]
    ds_read_b64_tr_b16 v[150:151], v6 offset:47680
    s_waitcnt vmcnt(18) lgkmcnt(6)
    v_mfma_f32_16x16x32_bf16 v[40:43], v[160:163], a[36:39], v[40:43]
    ds_read_b64_tr_b16 v[152:153], v6 offset:49152
    buffer_load_dwordx4 a[64:67], v2, s[28:31], s74 offen offset:0 sc1
    v_mfma_f32_16x16x32_bf16 v[44:47], v[160:163], a[136:139], v[44:47]
    ds_read_b64_tr_b16 v[154:155], v6 offset:50688
    v_mfma_f32_16x16x32_bf16 v[48:51], v[164:167], a[36:39], v[48:51]
    ds_read_b64_tr_b16 v[156:157], v6 offset:52224
    v_mfma_f32_16x16x32_bf16 v[52:55], v[164:167], a[136:139], v[52:55]
    ds_read_b64_tr_b16 v[158:159], v6 offset:53760
    buffer_load_dwordx4 a[164:167], v2, s[28:31], s75 offen offset:0 sc1
    v_mfma_f32_16x16x32_bf16 v[56:59], v[136:139], a[36:39], v[56:59]
    ds_read_b64_tr_b16 v[160:161], v6 offset:49184
    v_mfma_f32_16x16x32_bf16 v[60:63], v[136:139], a[136:139], v[60:63]
    ds_read_b64_tr_b16 v[162:163], v6 offset:50720
    s_waitcnt lgkmcnt(6)
    v_mfma_f32_16x16x32_bf16 v[64:67], v[140:143], a[36:39], v[64:67]
    ds_read_b64_tr_b16 v[164:165], v6 offset:52256
    s_add_u32 m0, s77, 12288
    s_nop 0
    buffer_load_dwordx4 v2, s[28:31], s76 offen offset:0 sc1 lds
    v_mfma_f32_16x16x32_bf16 v[68:71], v[140:143], a[136:139], v[68:71]
    ds_read_b64_tr_b16 v[166:167], v6 offset:53792
    v_mfma_f32_16x16x32_bf16 v[72:75], v[144:147], a[36:39], v[72:75]
    ds_read_b64_tr_b16 v[136:137], v6 offset:49216
    v_mfma_f32_16x16x32_bf16 v[76:79], v[144:147], a[136:139], v[76:79]
    ds_read_b64_tr_b16 v[138:139], v6 offset:50752
    buffer_load_dwordx4 v2, s[28:31], s76 offen offset:1024 sc1 lds
    v_mfma_f32_16x16x32_bf16 v[80:83], v[148:151], a[36:39], v[80:83]
    ds_read_b64_tr_b16 v[140:141], v6 offset:52288
    v_mfma_f32_16x16x32_bf16 v[84:87], v[148:151], a[136:139], v[84:87]
    ds_read_b64_tr_b16 v[142:143], v6 offset:53824
    s_waitcnt vmcnt(20) lgkmcnt(6)
    v_mfma_f32_16x16x32_bf16 v[40:43], v[152:155], a[40:43], v[40:43]
    ds_read_b64_tr_b16 v[144:145], v6 offset:55296
    buffer_load_dwordx4 v2, s[28:31], s76 offen offset:2048 sc1 lds
    s_add_u32 s76, s76, 12288
    v_mfma_f32_16x16x32_bf16 v[44:47], v[152:155], a[140:143], v[44:47]
    ds_read_b64_tr_b16 v[146:147], v6 offset:56832
    v_mfma_f32_16x16x32_bf16 v[48:51], v[156:159], a[40:43], v[48:51]
    ds_read_b64_tr_b16 v[148:149], v6 offset:58368
    v_mfma_f32_16x16x32_bf16 v[52:55], v[156:159], a[140:143], v[52:55]
    ds_read_b64_tr_b16 v[150:151], v6 offset:59904
    s_add_u32 m0, s77, 24576
    s_nop 0
    buffer_load_dwordx4 v2, s[28:31], s76 offen offset:0 sc1 lds
    v_mfma_f32_16x16x32_bf16 v[56:59], v[160:163], a[40:43], v[56:59]
    ds_read_b64_tr_b16 v[152:153], v6 offset:55328
    v_mfma_f32_16x16x32_bf16 v[60:63], v[160:163], a[140:143], v[60:63]
    ds_read_b64_tr_b16 v[154:155], v6 offset:56864
    s_waitcnt lgkmcnt(6)
    v_mfma_f32_16x16x32_bf16 v[64:67], v[164:167], a[40:43], v[64:67]
    ds_read_b64_tr_b16 v[156:157], v6 offset:58400
    buffer_load_dwordx4 v2, s[28:31], s76 offen offset:1024 sc1 lds
    v_mfma_f32_16x16x32_bf16 v[68:71], v[164:167], a[140:143], v[68:71]
    ds_read_b64_tr_b16 v[158:159], v6 offset:59936
    v_mfma_f32_16x16x32_bf16 v[72:75], v[136:139], a[40:43], v[72:75]
    ds_read_b64_tr_b16 v[160:161], v6 offset:55360
    v_mfma_f32_16x16x32_bf16 v[76:79], v[136:139], a[140:143], v[76:79]
    ds_read_b64_tr_b16 v[162:163], v6 offset:56896
    buffer_load_dwordx4 v2, s[28:31], s76 offen offset:2048 sc1 lds
    s_add_u32 s76, s76, 12288
    v_mfma_f32_16x16x32_bf16 v[80:83], v[140:143], a[40:43], v[80:83]
    ds_read_b64_tr_b16 v[164:165], v6 offset:58432
    v_mfma_f32_16x16x32_bf16 v[84:87], v[140:143], a[140:143], v[84:87]
    ds_read_b64_tr_b16 v[166:167], v6 offset:59968
    s_barrier
    s_waitcnt vmcnt(22) lgkmcnt(6)
    v_mfma_f32_16x16x32_bf16 v[40:43], v[144:147], a[44:47], v[40:43]
    ds_read_b64_tr_b16 v[136:137], v7 offset:0
    buffer_load_dwordx4 a[68:71], v2, s[28:31], s74 offen offset:1024 sc1
    v_mfma_f32_16x16x32_bf16 v[44:47], v[144:147], a[144:147], v[44:47]
    ds_read_b64_tr_b16 v[138:139], v7 offset:1536
    v_mfma_f32_16x16x32_bf16 v[48:51], v[148:151], a[44:47], v[48:51]
    ds_read_b64_tr_b16 v[140:141], v7 offset:3072
    v_mfma_f32_16x16x32_bf16 v[52:55], v[148:151], a[144:147], v[52:55]
    ds_read_b64_tr_b16 v[142:143], v7 offset:4608
    buffer_load_dwordx4 a[168:171], v2, s[28:31], s75 offen offset:1024 sc1
    v_mfma_f32_16x16x32_bf16 v[56:59], v[152:155], a[44:47], v[56:59]
    ds_read_b64_tr_b16 v[144:145], v7 offset:32
    v_mfma_f32_16x16x32_bf16 v[60:63], v[152:155], a[144:147], v[60:63]
    ds_read_b64_tr_b16 v[146:147], v7 offset:1568
    s_waitcnt lgkmcnt(6)
    v_mfma_f32_16x16x32_bf16 v[64:67], v[156:159], a[44:47], v[64:67]
    ds_read_b64_tr_b16 v[148:149], v7 offset:3104
    buffer_load_dwordx4 a[72:75], v2, s[28:31], s74 offen offset:2048 sc1
    v_mfma_f32_16x16x32_bf16 v[68:71], v[156:159], a[144:147], v[68:71]
    ds_read_b64_tr_b16 v[150:151], v7 offset:4640
    v_mfma_f32_16x16x32_bf16 v[72:75], v[160:163], a[44:47], v[72:75]
    ds_read_b64_tr_b16 v[152:153], v7 offset:64
    v_mfma_f32_16x16x32_bf16 v[76:79], v[160:163], a[144:147], v[76:79]
    ds_read_b64_tr_b16 v[154:155], v7 offset:1600
    buffer_load_dwordx4 a[172:175], v2, s[28:31], s75 offen offset:2048 sc1
    v_mfma_f32_16x16x32_bf16 v[80:83], v[164:167], a[44:47], v[80:83]
    ds_read_b64_tr_b16 v[156:157], v7 offset:3136
    v_mfma_f32_16x16x32_bf16 v[84:87], v[164:167], a[144:147], v[84:87]
    ds_read_b64_tr_b16 v[158:159], v7 offset:4672
    s_waitcnt vmcnt(24) lgkmcnt(6)
    v_mfma_f32_16x16x32_bf16 v[40:43], v[136:139], a[48:51], v[40:43]
    ds_read_b64_tr_b16 v[160:161], v7 offset:6144
    v_mfma_f32_16x16x32_bf16 v[44:47], v[136:139], a[148:151], v[44:47]
    ds_read_b64_tr_b16 v[162:163], v7 offset:7680
    buffer_load_dwordx4 a[76:79], v2, s[28:31], s74 offen offset:3072 sc1
    v_mfma_f32_16x16x32_bf16 v[48:51], v[140:143], a[48:51], v[48:51]
    ds_read_b64_tr_b16 v[164:165], v7 offset:9216
    v_mfma_f32_16x16x32_bf16 v[52:55], v[140:143], a[148:151], v[52:55]
    ds_read_b64_tr_b16 v[166:167], v7 offset:10752
    v_mfma_f32_16x16x32_bf16 v[56:59], v[144:147], a[48:51], v[56:59]
    ds_read_b64_tr_b16 v[136:137], v7 offset:6176
    v_mfma_f32_16x16x32_bf16 v[60:63], v[144:147], a[148:151], v[60:63]
    ds_read_b64_tr_b16 v[138:139], v7 offset:7712
    s_waitcnt lgkmcnt(6)
    v_mfma_f32_16x16x32_bf16 v[64:67], v[148:151], a[48:51], v[64:67]
    ds_read_b64_tr_b16 v[140:141], v7 offset:9248
    v_mfma_f32_16x16x32_bf16 v[68:71], v[148:151], a[148:151], v[68:71]
    ds_read_b64_tr_b16 v[142:143], v7 offset:10784
    buffer_load_dwordx4 a[176:179], v2, s[28:31], s75 offen offset:3072 sc1
    v_mfma_f32_16x16x32_bf16 v[72:75], v[152:155], a[48:51], v[72:75]
    ds_read_b64_tr_b16 v[144:145], v7 offset:6208
    v_mfma_f32_16x16x32_bf16 v[76:79], v[152:155], a[148:151], v[76:79]
    ds_read_b64_tr_b16 v[146:147], v7 offset:7744
    v_mfma_f32_16x16x32_bf16 v[80:83], v[156:159], a[48:51], v[80:83]
    ds_read_b64_tr_b16 v[148:149], v7 offset:9280
    v_mfma_f32_16x16x32_bf16 v[84:87], v[156:159], a[148:151], v[84:87]
    ds_read_b64_tr_b16 v[150:151], v7 offset:10816
    s_waitcnt vmcnt(18) lgkmcnt(6)
    v_mfma_f32_16x16x32_bf16 v[40:43], v[160:163], a[52:55], v[40:43]
    ds_read_b64_tr_b16 v[152:153], v7 offset:12288
    s_add_u32 m0, s77, 36864
    s_nop 0
    buffer_load_dwordx4 v2, s[28:31], s76 offen offset:0 sc1 lds
    v_mfma_f32_16x16x32_bf16 v[44:47], v[160:163], a[152:155], v[44:47]
    ds_read_b64_tr_b16 v[154:155], v7 offset:13824
    v_mfma_f32_16x16x32_bf16 v[48:51], v[164:167], a[52:55], v[48:51]
    ds_read_b64_tr_b16 v[156:157], v7 offset:15360
    v_mfma_f32_16x16x32_bf16 v[52:55], v[164:167], a[152:155], v[52:55]
    ds_read_b64_tr_b16 v[158:159], v7 offset:16896
    buffer_load_dwordx4 v2, s[28:31], s76 offen offset:1024 sc1 lds
    v_mfma_f32_16x16x32_bf16 v[56:59], v[136:139], a[52:55], v[56:59]
    ds_read_b64_tr_b16 v[160:161], v7 offset:12320
    v_mfma_f32_16x16x32_bf16 v[60:63], v[136:139], a[152:155], v[60:63]
    ds_read_b64_tr_b16 v[162:163], v7 offset:13856
    s_waitcnt lgkmcnt(6)
    v_mfma_f32_16x16x32_bf16 v[64:67], v[140:143], a[52:55], v[64:67]
    ds_read_b64_tr_b16 v[164:165], v7 offset:15392
    buffer_load_dwordx4 v2, s[28:31], s76 offen offset:2048 sc1 lds
    s_add_u32 s76, s76, 12288
    v_mfma_f32_16x16x32_bf16 v[68:71], v[140:143], a[152:155], v[68:71]
    ds_read_b64_tr_b16 v[166:167], v7 offset:16928
    v_mfma_f32_16x16x32_bf16 v[72:75], v[144:147], a[52:55], v[72:75]
    ds_read_b64_tr_b16 v[136:137], v7 offset:12352
    v_mfma_f32_16x16x32_bf16 v[76:79], v[144:147], a[152:155], v[76:79]
    ds_read_b64_tr_b16 v[138:139], v7 offset:13888
    s_add_u32 m0, s77, 49152
    s_nop 0
    buffer_load_dwordx4 v2, s[28:31], s76 offen offset:0 sc1 lds
    v_mfma_f32_16x16x32_bf16 v[80:83], v[148:151], a[52:55], v[80:83]
    ds_read_b64_tr_b16 v[140:141], v7 offset:15424
    v_mfma_f32_16x16x32_bf16 v[84:87], v[148:151], a[152:155], v[84:87]
    ds_read_b64_tr_b16 v[142:143], v7 offset:16960
    s_waitcnt vmcnt(20) lgkmcnt(6)
    v_mfma_f32_16x16x32_bf16 v[40:43], v[152:155], a[56:59], v[40:43]
    ds_read_b64_tr_b16 v[144:145], v7 offset:18432
    v_mfma_f32_16x16x32_bf16 v[44:47], v[152:155], a[156:159], v[44:47]
    ds_read_b64_tr_b16 v[146:147], v7 offset:19968
    buffer_load_dwordx4 v2, s[28:31], s76 offen offset:1024 sc1 lds
    v_mfma_f32_16x16x32_bf16 v[48:51], v[156:159], a[56:59], v[48:51]
    ds_read_b64_tr_b16 v[148:149], v7 offset:21504
    v_mfma_f32_16x16x32_bf16 v[52:55], v[156:159], a[156:159], v[52:55]
    ds_read_b64_tr_b16 v[150:151], v7 offset:23040
    v_mfma_f32_16x16x32_bf16 v[56:59], v[160:163], a[56:59], v[56:59]
    ds_read_b64_tr_b16 v[152:153], v7 offset:18464
    v_mfma_f32_16x16x32_bf16 v[60:63], v[160:163], a[156:159], v[60:63]
    ds_read_b64_tr_b16 v[154:155], v7 offset:20000
    buffer_load_dwordx4 v2, s[28:31], s76 offen offset:2048 sc1 lds
    s_add_u32 s76, s76, 12288
    s_waitcnt lgkmcnt(6)
    v_mfma_f32_16x16x32_bf16 v[64:67], v[164:167], a[56:59], v[64:67]
    ds_read_b64_tr_b16 v[156:157], v7 offset:21536
    v_mfma_f32_16x16x32_bf16 v[68:71], v[164:167], a[156:159], v[68:71]
    ds_read_b64_tr_b16 v[158:159], v7 offset:23072
    v_mfma_f32_16x16x32_bf16 v[72:75], v[136:139], a[56:59], v[72:75]
    ds_read_b64_tr_b16 v[160:161], v7 offset:18496
    v_mfma_f32_16x16x32_bf16 v[76:79], v[136:139], a[156:159], v[76:79]
    ds_read_b64_tr_b16 v[162:163], v7 offset:20032
    s_mov_b64 exec, 0xffff
    buffer_load_dword v10, v9, s[28:31], s64 offen offset:0
    s_mov_b64 exec, -1
    v_mfma_f32_16x16x32_bf16 v[80:83], v[140:143], a[56:59], v[80:83]
    ds_read_b64_tr_b16 v[164:165], v7 offset:21568
    v_mfma_f32_16x16x32_bf16 v[84:87], v[140:143], a[156:159], v[84:87]
    ds_read_b64_tr_b16 v[166:167], v7 offset:23104
    s_barrier
    s_waitcnt vmcnt(21) lgkmcnt(6)
    v_mfma_f32_16x16x32_bf16 v[40:43], v[144:147], a[60:63], v[40:43]
    ds_read_b64_tr_b16 v[136:137], v7 offset:24576
    v_mfma_f32_16x16x32_bf16 v[44:47], v[144:147], a[160:163], v[44:47]
    ds_read_b64_tr_b16 v[138:139], v7 offset:26112
    v_mfma_f32_16x16x32_bf16 v[48:51], v[148:151], a[60:63], v[48:51]
    ds_read_b64_tr_b16 v[140:141], v7 offset:27648
    v_mfma_f32_16x16x32_bf16 v[52:55], v[148:151], a[160:163], v[52:55]
    ds_read_b64_tr_b16 v[142:143], v7 offset:29184
    v_mfma_f32_16x16x32_bf16 v[56:59], v[152:155], a[60:63], v[56:59]
    ds_read_b64_tr_b16 v[144:145], v7 offset:24608
    v_mfma_f32_16x16x32_bf16 v[60:63], v[152:155], a[160:163], v[60:63]
    ds_read_b64_tr_b16 v[146:147], v7 offset:26144
    s_waitcnt lgkmcnt(6)
    v_mfma_f32_16x16x32_bf16 v[64:67], v[156:159], a[60:63], v[64:67]
    ds_read_b64_tr_b16 v[148:149], v7 offset:27680
    v_mfma_f32_16x16x32_bf16 v[68:71], v[156:159], a[160:163], v[68:71]
    ds_read_b64_tr_b16 v[150:151], v7 offset:29216
    v_mfma_f32_16x16x32_bf16 v[72:75], v[160:163], a[60:63], v[72:75]
    ds_read_b64_tr_b16 v[152:153], v7 offset:24640
    v_mfma_f32_16x16x32_bf16 v[76:79], v[160:163], a[160:163], v[76:79]
    ds_read_b64_tr_b16 v[154:155], v7 offset:26176
    v_mfma_f32_16x16x32_bf16 v[80:83], v[164:167], a[60:63], v[80:83]
    ds_read_b64_tr_b16 v[156:157], v7 offset:27712
    v_mfma_f32_16x16x32_bf16 v[84:87], v[164:167], a[160:163], v[84:87]
    ds_read_b64_tr_b16 v[158:159], v7 offset:29248
    s_waitcnt vmcnt(19) lgkmcnt(6)
    v_mfma_f32_16x16x32_bf16 v[40:43], v[136:139], a[64:67], v[40:43]
    ds_read_b64_tr_b16 v[160:161], v7 offset:30720
    v_mfma_f32_16x16x32_bf16 v[44:47], v[136:139], a[164:167], v[44:47]
    ds_read_b64_tr_b16 v[162:163], v7 offset:32256
    v_mfma_f32_16x16x32_bf16 v[48:51], v[140:143], a[64:67], v[48:51]
    ds_read_b64_tr_b16 v[164:165], v7 offset:33792
    v_mfma_f32_16x16x32_bf16 v[52:55], v[140:143], a[164:167], v[52:55]
    ds_read_b64_tr_b16 v[166:167], v7 offset:35328
    v_mfma_f32_16x16x32_bf16 v[56:59], v[144:147], a[64:67], v[56:59]
    ds_read_b64_tr_b16 v[136:137], v7 offset:30752
    v_mfma_f32_16x16x32_bf16 v[60:63], v[144:147], a[164:167], v[60:63]
    ds_read_b64_tr_b16 v[138:139], v7 offset:32288
    s_waitcnt lgkmcnt(6)
    v_mfma_f32_16x16x32_bf16 v[64:67], v[148:151], a[64:67], v[64:67]
    ds_read_b64_tr_b16 v[140:141], v7 offset:33824
    v_mfma_f32_16x16x32_bf16 v[68:71], v[148:151], a[164:167], v[68:71]
    ds_read_b64_tr_b16 v[142:143], v7 offset:35360
    v_mfma_f32_16x16x32_bf16 v[72:75], v[152:155], a[64:67], v[72:75]
    ds_read_b64_tr_b16 v[144:145], v7 offset:30784
    v_mfma_f32_16x16x32_bf16 v[76:79], v[152:155], a[164:167], v[76:79]
    ds_read_b64_tr_b16 v[146:147], v7 offset:32320
    v_mfma_f32_16x16x32_bf16 v[80:83], v[156:159], a[64:67], v[80:83]
    ds_read_b64_tr_b16 v[148:149], v7 offset:33856
    v_mfma_f32_16x16x32_bf16 v[84:87], v[156:159], a[164:167], v[84:87]
    ds_read_b64_tr_b16 v[150:151], v7 offset:35392
    s_waitcnt vmcnt(11) lgkmcnt(6)
    v_mfma_f32_16x16x32_bf16 v[40:43], v[160:163], a[68:71], v[40:43]
    ds_read_b64_tr_b16 v[152:153], v5 offset:0
    s_add_u32 m0, s77, 61440
    s_nop 0
    buffer_load_dwordx4 v2, s[28:31], s76 offen offset:0 sc1 lds
    v_mfma_f32_16x16x32_bf16 v[44:47], v[160:163], a[168:171], v[44:47]
    ds_read_b64_tr_b16 v[154:155], v5 offset:1536
    v_mfma_f32_16x16x32_bf16 v[48:51], v[164:167], a[68:71], v[48:51]
    ds_read_b64_tr_b16 v[156:157], v5 offset:3072
    v_mfma_f32_16x16x32_bf16 v[52:55], v[164:167], a[168:171], v[52:55]
    ds_read_b64_tr_b16 v[158:159], v5 offset:4608
    buffer_load_dwordx4 v2, s[28:31], s76 offen offset:1024 sc1 lds
    v_mfma_f32_16x16x32_bf16 v[56:59], v[136:139], a[68:71], v[56:59]
    ds_read_b64_tr_b16 v[160:161], v5 offset:32
    v_mfma_f32_16x16x32_bf16 v[60:63], v[136:139], a[168:171], v[60:63]
    ds_read_b64_tr_b16 v[162:163], v5 offset:1568
    s_waitcnt lgkmcnt(6)
    v_mfma_f32_16x16x32_bf16 v[64:67], v[140:143], a[68:71], v[64:67]
    ds_read_b64_tr_b16 v[164:165], v5 offset:3104
    buffer_load_dwordx4 v2, s[28:31], s76 offen offset:2048 sc1 lds
    s_add_u32 s76, s76, 12288
    v_mfma_f32_16x16x32_bf16 v[68:71], v[140:143], a[168:171], v[68:71]
    ds_read_b64_tr_b16 v[166:167], v5 offset:4640
    v_mfma_f32_16x16x32_bf16 v[72:75], v[144:147], a[68:71], v[72:75]
    ds_read_b64_tr_b16 v[136:137], v5 offset:64
    v_mfma_f32_16x16x32_bf16 v[76:79], v[144:147], a[168:171], v[76:79]
    ds_read_b64_tr_b16 v[138:139], v5 offset:1600
    s_add_u32 m0, s77, 73728
    s_nop 0
    buffer_load_dwordx4 v2, s[28:31], s76 offen offset:0 sc1 lds
    v_mfma_f32_16x16x32_bf16 v[80:83], v[148:151], a[68:71], v[80:83]
    ds_read_b64_tr_b16 v[140:141], v5 offset:3136
    v_mfma_f32_16x16x32_bf16 v[84:87], v[148:151], a[168:171], v[84:87]
    ds_read_b64_tr_b16 v[142:143], v5 offset:4672
    s_waitcnt vmcnt(13) lgkmcnt(6)
    v_mfma_f32_16x16x32_bf16 v[40:43], v[152:155], a[72:75], v[40:43]
    ds_read_b64_tr_b16 v[144:145], v5 offset:6144
    v_mfma_f32_16x16x32_bf16 v[44:47], v[152:155], a[172:175], v[44:47]
    ds_read_b64_tr_b16 v[146:147], v5 offset:7680
    buffer_load_dwordx4 v2, s[28:31], s76 offen offset:1024 sc1 lds
    v_mfma_f32_16x16x32_bf16 v[48:51], v[156:159], a[72:75], v[48:51]
    ds_read_b64_tr_b16 v[148:149], v5 offset:9216
    v_mfma_f32_16x16x32_bf16 v[52:55], v[156:159], a[172:175], v[52:55]
    ds_read_b64_tr_b16 v[150:151], v5 offset:10752
    v_mfma_f32_16x16x32_bf16 v[56:59], v[160:163], a[72:75], v[56:59]
    ds_read_b64_tr_b16 v[152:153], v5 offset:6176
    v_mfma_f32_16x16x32_bf16 v[60:63], v[160:163], a[172:175], v[60:63]
    ds_read_b64_tr_b16 v[154:155], v5 offset:7712
    s_waitcnt lgkmcnt(6)
    v_mfma_f32_16x16x32_bf16 v[64:67], v[164:167], a[72:75], v[64:67]
    ds_read_b64_tr_b16 v[156:157], v5 offset:9248
    v_mfma_f32_16x16x32_bf16 v[68:71], v[164:167], a[172:175], v[68:71]
    ds_read_b64_tr_b16 v[158:159], v5 offset:10784
    buffer_load_dwordx4 v2, s[28:31], s76 offen offset:2048 sc1 lds
    s_add_u32 s76, s76, 12288
    v_mfma_f32_16x16x32_bf16 v[72:75], v[136:139], a[72:75], v[72:75]
    ds_read_b64_tr_b16 v[160:161], v5 offset:6208
    v_mfma_f32_16x16x32_bf16 v[76:79], v[136:139], a[172:175], v[76:79]
    ds_read_b64_tr_b16 v[162:163], v5 offset:7744
    v_mfma_f32_16x16x32_bf16 v[80:83], v[140:143], a[72:75], v[80:83]
    ds_read_b64_tr_b16 v[164:165], v5 offset:9280
    v_mfma_f32_16x16x32_bf16 v[84:87], v[140:143], a[172:175], v[84:87]
    ds_read_b64_tr_b16 v[166:167], v5 offset:10816
    s_barrier
    s_waitcnt vmcnt(13) lgkmcnt(6)
    v_mfma_f32_16x16x32_bf16 v[40:43], v[144:147], a[76:79], v[40:43]
    ds_read_b64_tr_b16 v[136:137], v5 offset:12288
    v_mfma_f32_16x16x32_bf16 v[44:47], v[144:147], a[176:179], v[44:47]
    ds_read_b64_tr_b16 v[138:139], v5 offset:13824
    v_mfma_f32_16x16x32_bf16 v[48:51], v[148:151], a[76:79], v[48:51]
    ds_read_b64_tr_b16 v[140:141], v5 offset:15360
    v_mfma_f32_16x16x32_bf16 v[52:55], v[148:151], a[176:179], v[52:55]
    ds_read_b64_tr_b16 v[142:143], v5 offset:16896
    v_mfma_f32_16x16x32_bf16 v[56:59], v[152:155], a[76:79], v[56:59]
    ds_read_b64_tr_b16 v[144:145], v5 offset:12320
    v_mfma_f32_16x16x32_bf16 v[60:63], v[152:155], a[176:179], v[60:63]
    ds_read_b64_tr_b16 v[146:147], v5 offset:13856
    s_waitcnt lgkmcnt(6)
    v_mfma_f32_16x16x32_bf16 v[64:67], v[156:159], a[76:79], v[64:67]
    ds_read_b64_tr_b16 v[148:149], v5 offset:15392
    v_mfma_f32_16x16x32_bf16 v[68:71], v[156:159], a[176:179], v[68:71]
    ds_read_b64_tr_b16 v[150:151], v5 offset:16928
    v_mfma_f32_16x16x32_bf16 v[72:75], v[160:163], a[76:79], v[72:75]
    ds_read_b64_tr_b16 v[152:153], v5 offset:12352
    v_mfma_f32_16x16x32_bf16 v[76:79], v[160:163], a[176:179], v[76:79]
    ds_read_b64_tr_b16 v[154:155], v5 offset:13888
    v_mfma_f32_16x16x32_bf16 v[80:83], v[164:167], a[76:79], v[80:83]
    ds_read_b64_tr_b16 v[156:157], v5 offset:15424
    v_mfma_f32_16x16x32_bf16 v[84:87], v[164:167], a[176:179], v[84:87]
    ds_read_b64_tr_b16 v[158:159], v5 offset:16960
    s_waitcnt lgkmcnt(6)
    v_mfma_f32_16x16x32_bf16 v[88:91], v[136:139], a[0:3], 0
    ds_read_b64_tr_b16 v[160:161], v5 offset:18432
    v_mfma_f32_16x16x32_bf16 v[92:95], v[136:139], a[100:103], 0
    ds_read_b64_tr_b16 v[162:163], v5 offset:19968
    v_mfma_f32_16x16x32_bf16 v[96:99], v[140:143], a[0:3], 0
    ds_read_b64_tr_b16 v[164:165], v5 offset:21504
    v_mfma_f32_16x16x32_bf16 v[100:103], v[140:143], a[100:103], 0
    ds_read_b64_tr_b16 v[166:167], v5 offset:23040
    s_mov_b64 exec, 0xffff
    buffer_load_dword v11, v9, s[28:31], s64 offen offset:1024
    s_mov_b64 exec, -1
    v_mfma_f32_16x16x32_bf16 v[104:107], v[144:147], a[0:3], 0
    ds_read_b64_tr_b16 v[136:137], v5 offset:18464
    v_mfma_f32_16x16x32_bf16 v[108:111], v[144:147], a[100:103], 0
    ds_read_b64_tr_b16 v[138:139], v5 offset:20000
    s_waitcnt lgkmcnt(6)
    v_mfma_f32_16x16x32_bf16 v[112:115], v[148:151], a[0:3], 0
    ds_read_b64_tr_b16 v[140:141], v5 offset:21536
    v_mfma_f32_16x16x32_bf16 v[116:119], v[148:151], a[100:103], 0
    ds_read_b64_tr_b16 v[142:143], v5 offset:23072
    v_mfma_f32_16x16x32_bf16 v[120:123], v[152:155], a[0:3], 0
    ds_read_b64_tr_b16 v[144:145], v5 offset:18496
    v_mfma_f32_16x16x32_bf16 v[124:127], v[152:155], a[100:103], 0
    ds_read_b64_tr_b16 v[146:147], v5 offset:20032
    v_mfma_f32_16x16x32_bf16 v[128:131], v[156:159], a[0:3], 0
    ds_read_b64_tr_b16 v[148:149], v5 offset:21568
    v_mfma_f32_16x16x32_bf16 v[132:135], v[156:159], a[100:103], 0
    ds_read_b64_tr_b16 v[150:151], v5 offset:23104
    s_waitcnt lgkmcnt(6)
    v_mfma_f32_16x16x32_bf16 v[88:91], v[160:163], a[4:7], v[88:91]
    ds_read_b64_tr_b16 v[152:153], v5 offset:24576
    s_add_u32 m0, s77, 86016
    s_nop 0
    buffer_load_dwordx4 v2, s[28:31], s76 offen offset:0 sc1 lds
    v_mfma_f32_16x16x32_bf16 v[92:95], v[160:163], a[104:107], v[92:95]
    ds_read_b64_tr_b16 v[154:155], v5 offset:26112
    v_mfma_f32_16x16x32_bf16 v[96:99], v[164:167], a[4:7], v[96:99]
    ds_read_b64_tr_b16 v[156:157], v5 offset:27648
    v_exp_f32 v40, v40
    v_mfma_f32_16x16x32_bf16 v[100:103], v[164:167], a[104:107], v[100:103]
    ds_read_b64_tr_b16 v[158:159], v5 offset:29184
    buffer_load_dwordx4 v2, s[28:31], s76 offen offset:1024 sc1 lds
    v_mfma_f32_16x16x32_bf16 v[104:107], v[136:139], a[4:7], v[104:107]
    ds_read_b64_tr_b16 v[160:161], v5 offset:24608
    v_exp_f32 v41, v41
    v_mfma_f32_16x16x32_bf16 v[108:111], v[136:139], a[104:107], v[108:111]
    ds_read_b64_tr_b16 v[162:163], v5 offset:26144
    s_waitcnt lgkmcnt(6)
    v_mfma_f32_16x16x32_bf16 v[112:115], v[140:143], a[4:7], v[112:115]
    ds_read_b64_tr_b16 v[164:165], v5 offset:27680
    buffer_load_dwordx4 v2, s[28:31], s76 offen offset:2048 sc1 lds
    s_add_u32 s76, s76, 12288
    v_mfma_f32_16x16x32_bf16 v[116:119], v[140:143], a[104:107], v[116:119]
    ds_read_b64_tr_b16 v[166:167], v5 offset:29216
    v_mfma_f32_16x16x32_bf16 v[120:123], v[144:147], a[4:7], v[120:123]
    ds_read_b64_tr_b16 v[136:137], v5 offset:24640
    v_exp_f32 v42, v42
    v_mfma_f32_16x16x32_bf16 v[124:127], v[144:147], a[104:107], v[124:127]
    ds_read_b64_tr_b16 v[138:139], v5 offset:26176
    s_add_u32 m0, s77, 98304
    s_nop 0
    buffer_load_dwordx4 v2, s[28:31], s76 offen offset:0 sc1 lds
    v_mfma_f32_16x16x32_bf16 v[128:131], v[148:151], a[4:7], v[128:131]
    ds_read_b64_tr_b16 v[140:141], v5 offset:27712
    v_exp_f32 v43, v43
    v_mfma_f32_16x16x32_bf16 v[132:135], v[148:151], a[104:107], v[132:135]
    ds_read_b64_tr_b16 v[142:143], v5 offset:29248
    s_waitcnt lgkmcnt(6)
    v_mfma_f32_16x16x32_bf16 v[88:91], v[152:155], a[8:11], v[88:91]
    ds_read_b64_tr_b16 v[144:145], v5 offset:30720
    v_add_f32 v40, 1.0, v40
    v_mfma_f32_16x16x32_bf16 v[92:95], v[152:155], a[108:111], v[92:95]
    ds_read_b64_tr_b16 v[146:147], v5 offset:32256
    buffer_load_dwordx4 v2, s[28:31], s76 offen offset:1024 sc1 lds
    v_mfma_f32_16x16x32_bf16 v[96:99], v[156:159], a[8:11], v[96:99]
    ds_read_b64_tr_b16 v[148:149], v5 offset:33792
    v_add_f32 v41, 1.0, v41
    v_mfma_f32_16x16x32_bf16 v[100:103], v[156:159], a[108:111], v[100:103]
    ds_read_b64_tr_b16 v[150:151], v5 offset:35328
    v_mfma_f32_16x16x32_bf16 v[104:107], v[160:163], a[8:11], v[104:107]
    ds_read_b64_tr_b16 v[152:153], v5 offset:30752
    v_add_f32 v42, 1.0, v42
    v_mfma_f32_16x16x32_bf16 v[108:111], v[160:163], a[108:111], v[108:111]
    ds_read_b64_tr_b16 v[154:155], v5 offset:32288
    s_waitcnt lgkmcnt(6)
    v_mfma_f32_16x16x32_bf16 v[112:115], v[164:167], a[8:11], v[112:115]
    ds_read_b64_tr_b16 v[156:157], v5 offset:33824
    v_add_f32 v43, 1.0, v43
    v_mfma_f32_16x16x32_bf16 v[116:119], v[164:167], a[108:111], v[116:119]
    ds_read_b64_tr_b16 v[158:159], v5 offset:35360
    buffer_load_dwordx4 v2, s[28:31], s76 offen offset:2048 sc1 lds
    s_add_u32 s76, s76, 12288
    v_mfma_f32_16x16x32_bf16 v[120:123], v[136:139], a[8:11], v[120:123]
    ds_read_b64_tr_b16 v[160:161], v5 offset:30784
    v_rcp_f32 v40, v40
    v_mfma_f32_16x16x32_bf16 v[124:127], v[136:139], a[108:111], v[124:127]
    ds_read_b64_tr_b16 v[162:163], v5 offset:32320
    v_mfma_f32_16x16x32_bf16 v[128:131], v[140:143], a[8:11], v[128:131]
    ds_read_b64_tr_b16 v[164:165], v5 offset:33856
    v_rcp_f32 v41, v41
    v_mfma_f32_16x16x32_bf16 v[132:135], v[140:143], a[108:111], v[132:135]
    ds_read_b64_tr_b16 v[166:167], v5 offset:35392
    s_waitcnt vmcnt(14)
    s_barrier
    s_waitcnt lgkmcnt(6)
    v_mfma_f32_16x16x32_bf16 v[88:91], v[144:147], a[12:15], v[88:91]
    ds_read_b64_tr_b16 v[136:137], v5 offset:36864
    v_rcp_f32 v42, v42
    v_mfma_f32_16x16x32_bf16 v[92:95], v[144:147], a[112:115], v[92:95]
    ds_read_b64_tr_b16 v[138:139], v5 offset:38400
    v_mfma_f32_16x16x32_bf16 v[96:99], v[148:151], a[12:15], v[96:99]
    ds_read_b64_tr_b16 v[140:141], v5 offset:39936
    v_rcp_f32 v43, v43
    v_mfma_f32_16x16x32_bf16 v[100:103], v[148:151], a[112:115], v[100:103]
    ds_read_b64_tr_b16 v[142:143], v5 offset:41472
    v_mfma_f32_16x16x32_bf16 v[104:107], v[152:155], a[12:15], v[104:107]
    ds_read_b64_tr_b16 v[144:145], v5 offset:36896
    v_mul_f32 v48, v48, v40
    v_mfma_f32_16x16x32_bf16 v[108:111], v[152:155], a[112:115], v[108:111]
    ds_read_b64_tr_b16 v[146:147], v5 offset:38432
    s_waitcnt lgkmcnt(6)
    v_mfma_f32_16x16x32_bf16 v[112:115], v[156:159], a[12:15], v[112:115]
    ds_read_b64_tr_b16 v[148:149], v5 offset:39968
    v_mul_f32 v49, v49, v41
    v_mfma_f32_16x16x32_bf16 v[116:119], v[156:159], a[112:115], v[116:119]
    ds_read_b64_tr_b16 v[150:151], v5 offset:41504
    v_mfma_f32_16x16x32_bf16 v[120:123], v[160:163], a[12:15], v[120:123]
    ds_read_b64_tr_b16 v[152:153], v5 offset:36928
    v_mul_f32 v50, v50, v42
    v_mfma_f32_16x16x32_bf16 v[124:127], v[160:163], a[112:115], v[124:127]
    ds_read_b64_tr_b16 v[154:155], v5 offset:38464
    v_mfma_f32_16x16x32_bf16 v[128:131], v[164:167], a[12:15], v[128:131]
    ds_read_b64_tr_b16 v[156:157], v5 offset:40000
    v_mul_f32 v51, v51, v43
    v_mfma_f32_16x16x32_bf16 v[132:135], v[164:167], a[112:115], v[132:135]
    ds_read_b64_tr_b16 v[158:159], v5 offset:41536
    s_waitcnt lgkmcnt(6)
    v_mfma_f32_16x16x32_bf16 v[88:91], v[136:139], a[16:19], v[88:91]
    ds_read_b64_tr_b16 v[160:161], v5 offset:43008
    v_cvt_pk_bf16_f32 v168, v48, v49
    v_mfma_f32_16x16x32_bf16 v[92:95], v[136:139], a[116:119], v[92:95]
    ds_read_b64_tr_b16 v[162:163], v5 offset:44544
    v_mfma_f32_16x16x32_bf16 v[96:99], v[140:143], a[16:19], v[96:99]
    ds_read_b64_tr_b16 v[164:165], v5 offset:46080
    v_cvt_pk_bf16_f32 v169, v50, v51
    v_mfma_f32_16x16x32_bf16 v[100:103], v[140:143], a[116:119], v[100:103]
    ds_read_b64_tr_b16 v[166:167], v5 offset:47616
    v_mfma_f32_16x16x32_bf16 v[104:107], v[144:147], a[16:19], v[104:107]
    ds_read_b64_tr_b16 v[136:137], v5 offset:43040
    v_exp_f32 v44, v44
    v_mfma_f32_16x16x32_bf16 v[108:111], v[144:147], a[116:119], v[108:111]
    ds_read_b64_tr_b16 v[138:139], v5 offset:44576
    s_waitcnt lgkmcnt(6)
    v_mfma_f32_16x16x32_bf16 v[112:115], v[148:151], a[16:19], v[112:115]
    ds_read_b64_tr_b16 v[140:141], v5 offset:46112
    v_exp_f32 v45, v45
    v_mfma_f32_16x16x32_bf16 v[116:119], v[148:151], a[116:119], v[116:119]
    ds_read_b64_tr_b16 v[142:143], v5 offset:47648
    v_mfma_f32_16x16x32_bf16 v[120:123], v[152:155], a[16:19], v[120:123]
    ds_read_b64_tr_b16 v[144:145], v5 offset:43072
    v_exp_f32 v46, v46
    v_mfma_f32_16x16x32_bf16 v[124:127], v[152:155], a[116:119], v[124:127]
    ds_read_b64_tr_b16 v[146:147], v5 offset:44608
    v_mfma_f32_16x16x32_bf16 v[128:131], v[156:159], a[16:19], v[128:131]
    ds_read_b64_tr_b16 v[148:149], v5 offset:46144
    v_exp_f32 v47, v47
    v_mfma_f32_16x16x32_bf16 v[132:135], v[156:159], a[116:119], v[132:135]
    ds_read_b64_tr_b16 v[150:151], v5 offset:47680
    s_waitcnt lgkmcnt(6)
    v_mfma_f32_16x16x32_bf16 v[88:91], v[160:163], a[20:23], v[88:91]
    ds_read_b64_tr_b16 v[152:153], v5 offset:49152
    s_add_u32 m0, s77, 110592
    s_nop 0
    buffer_load_dwordx4 v2, s[28:31], s76 offen offset:0 sc1 lds
    v_mfma_f32_16x16x32_bf16 v[92:95], v[160:163], a[120:123], v[92:95]
    ds_read_b64_tr_b16 v[154:155], v5 offset:50688
    v_mfma_f32_16x16x32_bf16 v[96:99], v[164:167], a[20:23], v[96:99]
    ds_read_b64_tr_b16 v[156:157], v5 offset:52224
    v_add_f32 v44, 1.0, v44
    v_mfma_f32_16x16x32_bf16 v[100:103], v[164:167], a[120:123], v[100:103]
    ds_read_b64_tr_b16 v[158:159], v5 offset:53760
    buffer_load_dwordx4 v2, s[28:31], s76 offen offset:1024 sc1 lds
    v_mfma_f32_16x16x32_bf16 v[104:107], v[136:139], a[20:23], v[104:107]
    ds_read_b64_tr_b16 v[160:161], v5 offset:49184
    v_add_f32 v45, 1.0, v45
    v_mfma_f32_16x16x32_bf16 v[108:111], v[136:139], a[120:123], v[108:111]
    ds_read_b64_tr_b16 v[162:163], v5 offset:50720
    s_waitcnt lgkmcnt(6)
    v_mfma_f32_16x16x32_bf16 v[112:115], v[140:143], a[20:23], v[112:115]
    ds_read_b64_tr_b16 v[164:165], v5 offset:52256
    buffer_load_dwordx4 v2, s[28:31], s76 offen offset:2048 sc1 lds
    s_add_u32 s76, s76, 12288
    v_mfma_f32_16x16x32_bf16 v[116:119], v[140:143], a[120:123], v[116:119]
    ds_read_b64_tr_b16 v[166:167], v5 offset:53792
    v_mfma_f32_16x16x32_bf16 v[120:123], v[144:147], a[20:23], v[120:123]
    ds_read_b64_tr_b16 v[136:137], v5 offset:49216
    v_add_f32 v46, 1.0, v46
    v_mfma_f32_16x16x32_bf16 v[124:127], v[144:147], a[120:123], v[124:127]
    ds_read_b64_tr_b16 v[138:139], v5 offset:50752
    s_add_u32 m0, s77, 122880
    s_nop 0
    buffer_load_dwordx4 v2, s[28:31], s76 offen offset:0 sc1 lds
    v_mfma_f32_16x16x32_bf16 v[128:131], v[148:151], a[20:23], v[128:131]
    ds_read_b64_tr_b16 v[140:141], v5 offset:52288
    v_add_f32 v47, 1.0, v47
    v_mfma_f32_16x16x32_bf16 v[132:135], v[148:151], a[120:123], v[132:135]
    ds_read_b64_tr_b16 v[142:143], v5 offset:53824
    s_waitcnt lgkmcnt(6)
    v_mfma_f32_16x16x32_bf16 v[88:91], v[152:155], a[24:27], v[88:91]
    ds_read_b64_tr_b16 v[144:145], v5 offset:55296
    v_rcp_f32 v44, v44
    v_mfma_f32_16x16x32_bf16 v[92:95], v[152:155], a[124:127], v[92:95]
    ds_read_b64_tr_b16 v[146:147], v5 offset:56832
    buffer_load_dwordx4 v2, s[28:31], s76 offen offset:1024 sc1 lds
    v_mfma_f32_16x16x32_bf16 v[96:99], v[156:159], a[24:27], v[96:99]
    ds_read_b64_tr_b16 v[148:149], v5 offset:58368
    v_rcp_f32 v45, v45
    v_mfma_f32_16x16x32_bf16 v[100:103], v[156:159], a[124:127], v[100:103]
    ds_read_b64_tr_b16 v[150:151], v5 offset:59904
    v_mfma_f32_16x16x32_bf16 v[104:107], v[160:163], a[24:27], v[104:107]
    ds_read_b64_tr_b16 v[152:153], v5 offset:55328
    v_rcp_f32 v46, v46
    v_mfma_f32_16x16x32_bf16 v[108:111], v[160:163], a[124:127], v[108:111]
    ds_read_b64_tr_b16 v[154:155], v5 offset:56864
    buffer_load_dwordx4 v2, s[28:31], s76 offen offset:2048 sc1 lds
    s_add_u32 s76, s76, 12288
    s_waitcnt lgkmcnt(6)
    v_mfma_f32_16x16x32_bf16 v[112:115], v[164:167], a[24:27], v[112:115]
    ds_read_b64_tr_b16 v[156:157], v5 offset:58400
    v_rcp_f32 v47, v47
    v_mfma_f32_16x16x32_bf16 v[116:119], v[164:167], a[124:127], v[116:119]
    ds_read_b64_tr_b16 v[158:159], v5 offset:59936
    v_mfma_f32_16x16x32_bf16 v[120:123], v[136:139], a[24:27], v[120:123]
    ds_read_b64_tr_b16 v[160:161], v5 offset:55360
    v_mul_f32 v52, v52, v44
    v_mfma_f32_16x16x32_bf16 v[124:127], v[136:139], a[124:127], v[124:127]
    ds_read_b64_tr_b16 v[162:163], v5 offset:56896
    s_mov_b64 exec, 0xffff
    buffer_load_dword v12, v9, s[28:31], s64 offen offset:2048
    s_mov_b64 exec, -1
    v_mfma_f32_16x16x32_bf16 v[128:131], v[140:143], a[24:27], v[128:131]
    ds_read_b64_tr_b16 v[164:165], v5 offset:58432
    v_mul_f32 v53, v53, v45
    v_mfma_f32_16x16x32_bf16 v[132:135], v[140:143], a[124:127], v[132:135]
    ds_read_b64_tr_b16 v[166:167], v5 offset:59968
    s_waitcnt vmcnt(14)
    s_barrier
    s_waitcnt lgkmcnt(6)
    v_mfma_f32_16x16x32_bf16 v[88:91], v[144:147], a[28:31], v[88:91]
    ds_read_b64_tr_b16 v[136:137], v6 offset:0
    v_mul_f32 v54, v54, v46
    v_mfma_f32_16x16x32_bf16 v[92:95], v[144:147], a[128:131], v[92:95]
    ds_read_b64_tr_b16 v[138:139], v6 offset:1536
    v_mfma_f32_16x16x32_bf16 v[96:99], v[148:151], a[28:31], v[96:99]
    ds_read_b64_tr_b16 v[140:141], v6 offset:3072
    v_mul_f32 v55, v55, v47
    v_mfma_f32_16x16x32_bf16 v[100:103], v[148:151], a[128:131], v[100:103]
    ds_read_b64_tr_b16 v[142:143], v6 offset:4608
    v_mfma_f32_16x16x32_bf16 v[104:107], v[152:155], a[28:31], v[104:107]
    ds_read_b64_tr_b16 v[144:145], v6 offset:32
    v_cvt_pk_bf16_f32 v180, v52, v53
    v_mfma_f32_16x16x32_bf16 v[108:111], v[152:155], a[128:131], v[108:111]
    ds_read_b64_tr_b16 v[146:147], v6 offset:1568
    s_waitcnt lgkmcnt(6)
    v_mfma_f32_16x16x32_bf16 v[112:115], v[156:159], a[28:31], v[112:115]
    ds_read_b64_tr_b16 v[148:149], v6 offset:3104
    v_cvt_pk_bf16_f32 v181, v54, v55
    v_mfma_f32_16x16x32_bf16 v[116:119], v[156:159], a[128:131], v[116:119]
    ds_read_b64_tr_b16 v[150:151], v6 offset:4640
    v_mfma_f32_16x16x32_bf16 v[120:123], v[160:163], a[28:31], v[120:123]
    ds_read_b64_tr_b16 v[152:153], v6 offset:64
    v_exp_f32 v56, v56
    v_mfma_f32_16x16x32_bf16 v[124:127], v[160:163], a[128:131], v[124:127]
    ds_read_b64_tr_b16 v[154:155], v6 offset:1600
    v_mfma_f32_16x16x32_bf16 v[128:131], v[164:167], a[28:31], v[128:131]
    ds_read_b64_tr_b16 v[156:157], v6 offset:3136
    v_exp_f32 v57, v57
    v_mfma_f32_16x16x32_bf16 v[132:135], v[164:167], a[128:131], v[132:135]
    ds_read_b64_tr_b16 v[158:159], v6 offset:4672
    s_waitcnt lgkmcnt(6)
    v_mfma_f32_16x16x32_bf16 v[88:91], v[136:139], a[32:35], v[88:91]
    ds_read_b64_tr_b16 v[160:161], v6 offset:6144
    v_exp_f32 v58, v58
    v_mfma_f32_16x16x32_bf16 v[92:95], v[136:139], a[132:135], v[92:95]
    ds_read_b64_tr_b16 v[162:163], v6 offset:7680
    v_mfma_f32_16x16x32_bf16 v[96:99], v[140:143], a[32:35], v[96:99]
    ds_read_b64_tr_b16 v[164:165], v6 offset:9216
    v_exp_f32 v59, v59
    v_mfma_f32_16x16x32_bf16 v[100:103], v[140:143], a[132:135], v[100:103]
    ds_read_b64_tr_b16 v[166:167], v6 offset:10752
    v_mfma_f32_16x16x32_bf16 v[104:107], v[144:147], a[32:35], v[104:107]
    ds_read_b64_tr_b16 v[136:137], v6 offset:6176
    v_add_f32 v56, 1.0, v56
    v_mfma_f32_16x16x32_bf16 v[108:111], v[144:147], a[132:135], v[108:111]
    ds_read_b64_tr_b16 v[138:139], v6 offset:7712
    s_waitcnt lgkmcnt(6)
    v_mfma_f32_16x16x32_bf16 v[112:115], v[148:151], a[32:35], v[112:115]
    ds_read_b64_tr_b16 v[140:141], v6 offset:9248
    v_add_f32 v57, 1.0, v57
    v_mfma_f32_16x16x32_bf16 v[116:119], v[148:151], a[132:135], v[116:119]
    ds_read_b64_tr_b16 v[142:143], v6 offset:10784
    v_mfma_f32_16x16x32_bf16 v[120:123], v[152:155], a[32:35], v[120:123]
    ds_read_b64_tr_b16 v[144:145], v6 offset:6208
    v_add_f32 v58, 1.0, v58
    v_mfma_f32_16x16x32_bf16 v[124:127], v[152:155], a[132:135], v[124:127]
    ds_read_b64_tr_b16 v[146:147], v6 offset:7744
    v_mfma_f32_16x16x32_bf16 v[128:131], v[156:159], a[32:35], v[128:131]
    ds_read_b64_tr_b16 v[148:149], v6 offset:9280
    v_add_f32 v59, 1.0, v59
    v_mfma_f32_16x16x32_bf16 v[132:135], v[156:159], a[132:135], v[132:135]
    ds_read_b64_tr_b16 v[150:151], v6 offset:10816
    s_waitcnt lgkmcnt(6)
    v_mfma_f32_16x16x32_bf16 v[88:91], v[160:163], a[36:39], v[88:91]
    ds_read_b64_tr_b16 v[152:153], v6 offset:12288
    v_rcp_f32 v56, v56
    v_mfma_f32_16x16x32_bf16 v[92:95], v[160:163], a[136:139], v[92:95]
    ds_read_b64_tr_b16 v[154:155], v6 offset:13824
    v_mfma_f32_16x16x32_bf16 v[96:99], v[164:167], a[36:39], v[96:99]
    ds_read_b64_tr_b16 v[156:157], v6 offset:15360
    v_rcp_f32 v57, v57
    v_mfma_f32_16x16x32_bf16 v[100:103], v[164:167], a[136:139], v[100:103]
    ds_read_b64_tr_b16 v[158:159], v6 offset:16896
    v_mfma_f32_16x16x32_bf16 v[104:107], v[136:139], a[36:39], v[104:107]
    ds_read_b64_tr_b16 v[160:161], v6 offset:12320
    v_rcp_f32 v58, v58
    v_mfma_f32_16x16x32_bf16 v[108:111], v[136:139], a[136:139], v[108:111]
    ds_read_b64_tr_b16 v[162:163], v6 offset:13856
    s_waitcnt lgkmcnt(6)
    v_mfma_f32_16x16x32_bf16 v[112:115], v[140:143], a[36:39], v[112:115]
    ds_read_b64_tr_b16 v[164:165], v6 offset:15392
    v_rcp_f32 v59, v59
    v_mfma_f32_16x16x32_bf16 v[116:119], v[140:143], a[136:139], v[116:119]
    ds_read_b64_tr_b16 v[166:167], v6 offset:16928
    v_mfma_f32_16x16x32_bf16 v[120:123], v[144:147], a[36:39], v[120:123]
    ds_read_b64_tr_b16 v[136:137], v6 offset:12352
    v_mul_f32 v64, v64, v56
    v_mfma_f32_16x16x32_bf16 v[124:127], v[144:147], a[136:139], v[124:127]
    ds_read_b64_tr_b16 v[138:139], v6 offset:13888
    v_mfma_f32_16x16x32_bf16 v[128:131], v[148:151], a[36:39], v[128:131]
    ds_read_b64_tr_b16 v[140:141], v6 offset:15424
    v_mul_f32 v65, v65, v57
    v_mfma_f32_16x16x32_bf16 v[132:135], v[148:151], a[136:139], v[132:135]
    ds_read_b64_tr_b16 v[142:143], v6 offset:16960
    s_waitcnt lgkmcnt(6)
    v_mfma_f32_16x16x32_bf16 v[88:91], v[152:155], a[40:43], v[88:91]
    ds_read_b64_tr_b16 v[144:145], v6 offset:18432
    v_mul_f32 v66, v66, v58
    v_mfma_f32_16x16x32_bf16 v[92:95], v[152:155], a[140:143], v[92:95]
    ds_read_b64_tr_b16 v[146:147], v6 offset:19968
    v_mfma_f32_16x16x32_bf16 v[96:99], v[156:159], a[40:43], v[96:99]
    ds_read_b64_tr_b16 v[148:149], v6 offset:21504
    v_mul_f32 v67, v67, v59
    v_mfma_f32_16x16x32_bf16 v[100:103], v[156:159], a[140:143], v[100:103]
    ds_read_b64_tr_b16 v[150:151], v6 offset:23040
    v_mfma_f32_16x16x32_bf16 v[104:107], v[160:163], a[40:43], v[104:107]
    ds_read_b64_tr_b16 v[152:153], v6 offset:18464
    v_cvt_pk_bf16_f32 v170, v64, v65
    v_mfma_f32_16x16x32_bf16 v[108:111], v[160:163], a[140:143], v[108:111]
    ds_read_b64_tr_b16 v[154:155], v6 offset:20000
    s_waitcnt lgkmcnt(6)
    v_mfma_f32_16x16x32_bf16 v[112:115], v[164:167], a[40:43], v[112:115]
    ds_read_b64_tr_b16 v[156:157], v6 offset:21536
    v_cvt_pk_bf16_f32 v171, v66, v67
    v_mfma_f32_16x16x32_bf16 v[116:119], v[164:167], a[140:143], v[116:119]
    ds_read_b64_tr_b16 v[158:159], v6 offset:23072
    v_mfma_f32_16x16x32_bf16 v[120:123], v[136:139], a[40:43], v[120:123]
    ds_read_b64_tr_b16 v[160:161], v6 offset:18496
    buffer_store_dwordx4 v[168:171], v2, s[28:31], s64 offen offset:0
    v_mfma_f32_16x16x32_bf16 v[124:127], v[136:139], a[140:143], v[124:127]
    ds_read_b64_tr_b16 v[162:163], v6 offset:20032
    v_mfma_f32_16x16x32_bf16 v[128:131], v[140:143], a[40:43], v[128:131]
    ds_read_b64_tr_b16 v[164:165], v6 offset:21568
    v_exp_f32 v60, v60
    v_mfma_f32_16x16x32_bf16 v[132:135], v[140:143], a[140:143], v[132:135]
    ds_read_b64_tr_b16 v[166:167], v6 offset:23104
    s_waitcnt vmcnt(8)
    s_barrier
    s_waitcnt lgkmcnt(6)
    v_mfma_f32_16x16x32_bf16 v[88:91], v[144:147], a[44:47], v[88:91]
    ds_read_b64_tr_b16 v[136:137], v6 offset:24576
    v_exp_f32 v61, v61
    v_mfma_f32_16x16x32_bf16 v[92:95], v[144:147], a[144:147], v[92:95]
    ds_read_b64_tr_b16 v[138:139], v6 offset:26112
    v_mfma_f32_16x16x32_bf16 v[96:99], v[148:151], a[44:47], v[96:99]
    ds_read_b64_tr_b16 v[140:141], v6 offset:27648
    v_exp_f32 v62, v62
    v_mfma_f32_16x16x32_bf16 v[100:103], v[148:151], a[144:147], v[100:103]
    ds_read_b64_tr_b16 v[142:143], v6 offset:29184
    v_mfma_f32_16x16x32_bf16 v[104:107], v[152:155], a[44:47], v[104:107]
    ds_read_b64_tr_b16 v[144:145], v6 offset:24608
    v_exp_f32 v63, v63
    v_mfma_f32_16x16x32_bf16 v[108:111], v[152:155], a[144:147], v[108:111]
    ds_read_b64_tr_b16 v[146:147], v6 offset:26144
    s_waitcnt lgkmcnt(6)
    v_mfma_f32_16x16x32_bf16 v[112:115], v[156:159], a[44:47], v[112:115]
    ds_read_b64_tr_b16 v[148:149], v6 offset:27680
    v_add_f32 v60, 1.0, v60
    v_mfma_f32_16x16x32_bf16 v[116:119], v[156:159], a[144:147], v[116:119]
    ds_read_b64_tr_b16 v[150:151], v6 offset:29216
    v_mfma_f32_16x16x32_bf16 v[120:123], v[160:163], a[44:47], v[120:123]
    ds_read_b64_tr_b16 v[152:153], v6 offset:24640
    v_add_f32 v61, 1.0, v61
    v_mfma_f32_16x16x32_bf16 v[124:127], v[160:163], a[144:147], v[124:127]
    ds_read_b64_tr_b16 v[154:155], v6 offset:26176
    v_mfma_f32_16x16x32_bf16 v[128:131], v[164:167], a[44:47], v[128:131]
    ds_read_b64_tr_b16 v[156:157], v6 offset:27712
    v_add_f32 v62, 1.0, v62
    v_mfma_f32_16x16x32_bf16 v[132:135], v[164:167], a[144:147], v[132:135]
    ds_read_b64_tr_b16 v[158:159], v6 offset:29248
    s_waitcnt lgkmcnt(6)
    v_mfma_f32_16x16x32_bf16 v[88:91], v[136:139], a[48:51], v[88:91]
    ds_read_b64_tr_b16 v[160:161], v6 offset:30720
    v_add_f32 v63, 1.0, v63
    v_mfma_f32_16x16x32_bf16 v[92:95], v[136:139], a[148:151], v[92:95]
    ds_read_b64_tr_b16 v[162:163], v6 offset:32256
    v_mfma_f32_16x16x32_bf16 v[96:99], v[140:143], a[48:51], v[96:99]
    ds_read_b64_tr_b16 v[164:165], v6 offset:33792
    v_rcp_f32 v60, v60
    v_mfma_f32_16x16x32_bf16 v[100:103], v[140:143], a[148:151], v[100:103]
    ds_read_b64_tr_b16 v[166:167], v6 offset:35328
    v_mfma_f32_16x16x32_bf16 v[104:107], v[144:147], a[48:51], v[104:107]
    ds_read_b64_tr_b16 v[136:137], v6 offset:30752
    v_rcp_f32 v61, v61
    v_mfma_f32_16x16x32_bf16 v[108:111], v[144:147], a[148:151], v[108:111]
    ds_read_b64_tr_b16 v[138:139], v6 offset:32288
    s_waitcnt lgkmcnt(6)
    v_mfma_f32_16x16x32_bf16 v[112:115], v[148:151], a[48:51], v[112:115]
    ds_read_b64_tr_b16 v[140:141], v6 offset:33824
    v_rcp_f32 v62, v62
    v_mfma_f32_16x16x32_bf16 v[116:119], v[148:151], a[148:151], v[116:119]
    ds_read_b64_tr_b16 v[142:143], v6 offset:35360
    v_mfma_f32_16x16x32_bf16 v[120:123], v[152:155], a[48:51], v[120:123]
    ds_read_b64_tr_b16 v[144:145], v6 offset:30784
    v_rcp_f32 v63, v63
    v_mfma_f32_16x16x32_bf16 v[124:127], v[152:155], a[148:151], v[124:127]
    ds_read_b64_tr_b16 v[146:147], v6 offset:32320
    v_mfma_f32_16x16x32_bf16 v[128:131], v[156:159], a[48:51], v[128:131]
    ds_read_b64_tr_b16 v[148:149], v6 offset:33856
    v_mul_f32 v68, v68, v60
    v_mfma_f32_16x16x32_bf16 v[132:135], v[156:159], a[148:151], v[132:135]
    ds_read_b64_tr_b16 v[150:151], v6 offset:35392
    s_waitcnt lgkmcnt(6)
    v_mfma_f32_16x16x32_bf16 v[88:91], v[160:163], a[52:55], v[88:91]
    ds_read_b64_tr_b16 v[152:153], v6 offset:36864
    v_mul_f32 v69, v69, v61
    v_mfma_f32_16x16x32_bf16 v[92:95], v[160:163], a[152:155], v[92:95]
    ds_read_b64_tr_b16 v[154:155], v6 offset:38400
    v_mfma_f32_16x16x32_bf16 v[96:99], v[164:167], a[52:55], v[96:99]
    ds_read_b64_tr_b16 v[156:157], v6 offset:39936
    v_mul_f32 v70, v70, v62
    v_mfma_f32_16x16x32_bf16 v[100:103], v[164:167], a[152:155], v[100:103]
    ds_read_b64_tr_b16 v[158:159], v6 offset:41472
    s_add_u32 m0, s73, 143360
    s_nop 0
    buffer_load_dwordx4 v2, s[28:31], s72 offen offset:0 sc1 lds
    v_mfma_f32_16x16x32_bf16 v[104:107], v[136:139], a[52:55], v[104:107]
    ds_read_b64_tr_b16 v[160:161], v6 offset:36896
    v_mul_f32 v71, v71, v63
    v_mfma_f32_16x16x32_bf16 v[108:111], v[136:139], a[152:155], v[108:111]
    ds_read_b64_tr_b16 v[162:163], v6 offset:38432
    s_waitcnt lgkmcnt(6)
    v_mfma_f32_16x16x32_bf16 v[112:115], v[140:143], a[52:55], v[112:115]
    ds_read_b64_tr_b16 v[164:165], v6 offset:39968
    v_cvt_pk_bf16_f32 v182, v68, v69
    v_mfma_f32_16x16x32_bf16 v[116:119], v[140:143], a[152:155], v[116:119]
    ds_read_b64_tr_b16 v[166:167], v6 offset:41504
    v_mfma_f32_16x16x32_bf16 v[120:123], v[144:147], a[52:55], v[120:123]
    ds_read_b64_tr_b16 v[136:137], v6 offset:36928
    v_cvt_pk_bf16_f32 v183, v70, v71
    v_mfma_f32_16x16x32_bf16 v[124:127], v[144:147], a[152:155], v[124:127]
    ds_read_b64_tr_b16 v[138:139], v6 offset:38464
    v_mfma_f32_16x16x32_bf16 v[128:131], v[148:151], a[52:55], v[128:131]
    ds_read_b64_tr_b16 v[140:141], v6 offset:40000
    buffer_store_dwordx4 v[180:183], v2, s[28:31], s65 offen offset:0
    v_mfma_f32_16x16x32_bf16 v[132:135], v[148:151], a[152:155], v[132:135]
    ds_read_b64_tr_b16 v[142:143], v6 offset:41536
    s_waitcnt lgkmcnt(6)
    v_mfma_f32_16x16x32_bf16 v[88:91], v[152:155], a[56:59], v[88:91]
    ds_read_b64_tr_b16 v[144:145], v6 offset:43008
    v_exp_f32 v72, v72
    v_mfma_f32_16x16x32_bf16 v[92:95], v[152:155], a[156:159], v[92:95]
    ds_read_b64_tr_b16 v[146:147], v6 offset:44544
    buffer_load_dwordx4 v2, s[28:31], s72 offen offset:1024 sc1 lds
    v_mfma_f32_16x16x32_bf16 v[96:99], v[156:159], a[56:59], v[96:99]
    ds_read_b64_tr_b16 v[148:149], v6 offset:46080
    v_exp_f32 v73, v73
    v_mfma_f32_16x16x32_bf16 v[100:103], v[156:159], a[156:159], v[100:103]
    ds_read_b64_tr_b16 v[150:151], v6 offset:47616
    v_mfma_f32_16x16x32_bf16 v[104:107], v[160:163], a[56:59], v[104:107]
    ds_read_b64_tr_b16 v[152:153], v6 offset:43040
    v_exp_f32 v74, v74
    v_mfma_f32_16x16x32_bf16 v[108:111], v[160:163], a[156:159], v[108:111]
    ds_read_b64_tr_b16 v[154:155], v6 offset:44576
    s_waitcnt lgkmcnt(6)
    v_mfma_f32_16x16x32_bf16 v[112:115], v[164:167], a[56:59], v[112:115]
    ds_read_b64_tr_b16 v[156:157], v6 offset:46112
    v_exp_f32 v75, v75
    v_mfma_f32_16x16x32_bf16 v[116:119], v[164:167], a[156:159], v[116:119]
    ds_read_b64_tr_b16 v[158:159], v6 offset:47648
    buffer_load_dwordx4 v2, s[28:31], s72 offen offset:2048 sc1 lds
    v_mfma_f32_16x16x32_bf16 v[120:123], v[136:139], a[56:59], v[120:123]
    ds_read_b64_tr_b16 v[160:161], v6 offset:43072
    v_add_f32 v72, 1.0, v72
    v_mfma_f32_16x16x32_bf16 v[124:127], v[136:139], a[156:159], v[124:127]
    ds_read_b64_tr_b16 v[162:163], v6 offset:44608
    v_mfma_f32_16x16x32_bf16 v[128:131], v[140:143], a[56:59], v[128:131]
    ds_read_b64_tr_b16 v[164:165], v6 offset:46144
    v_add_f32 v73, 1.0, v73
    v_mfma_f32_16x16x32_bf16 v[132:135], v[140:143], a[156:159], v[132:135]
    ds_read_b64_tr_b16 v[166:167], v6 offset:47680
    s_waitcnt vmcnt(6)
    s_barrier
    s_waitcnt lgkmcnt(6)
    v_mfma_f32_16x16x32_bf16 v[88:91], v[144:147], a[60:63], v[88:91]
    ds_read_b64_tr_b16 v[136:137], v6 offset:49152
    v_add_f32 v74, 1.0, v74
    v_mfma_f32_16x16x32_bf16 v[92:95], v[144:147], a[160:163], v[92:95]
    ds_read_b64_tr_b16 v[138:139], v6 offset:50688
    buffer_load_dwordx4 v2, s[28:31], s72 offen offset:3072 sc1 lds
    v_mfma_f32_16x16x32_bf16 v[96:99], v[148:151], a[60:63], v[96:99]
    ds_read_b64_tr_b16 v[140:141], v6 offset:52224
    v_add_f32 v75, 1.0, v75
    v_mfma_f32_16x16x32_bf16 v[100:103], v[148:151], a[160:163], v[100:103]
    ds_read_b64_tr_b16 v[142:143], v6 offset:53760
    v_mfma_f32_16x16x32_bf16 v[104:107], v[152:155], a[60:63], v[104:107]
    ds_read_b64_tr_b16 v[144:145], v6 offset:49184
    v_rcp_f32 v72, v72
    v_mfma_f32_16x16x32_bf16 v[108:111], v[152:155], a[160:163], v[108:111]
    ds_read_b64_tr_b16 v[146:147], v6 offset:50720
    s_waitcnt lgkmcnt(6)
    v_mfma_f32_16x16x32_bf16 v[112:115], v[156:159], a[60:63], v[112:115]
    ds_read_b64_tr_b16 v[148:149], v6 offset:52256
    v_rcp_f32 v73, v73
    v_mfma_f32_16x16x32_bf16 v[116:119], v[156:159], a[160:163], v[116:119]
    ds_read_b64_tr_b16 v[150:151], v6 offset:53792
    s_add_u32 m0, s73, 147456
    s_add_u32 s72, s72, 4096
    buffer_load_dwordx4 v2, s[28:31], s72 offen offset:0 sc1 lds
    s_add_u32 s72, s72, 6144
    v_mfma_f32_16x16x32_bf16 v[120:123], v[160:163], a[60:63], v[120:123]
    ds_read_b64_tr_b16 v[152:153], v6 offset:49216
    v_rcp_f32 v74, v74
    v_mfma_f32_16x16x32_bf16 v[124:127], v[160:163], a[160:163], v[124:127]
    ds_read_b64_tr_b16 v[154:155], v6 offset:50752
    v_mfma_f32_16x16x32_bf16 v[128:131], v[164:167], a[60:63], v[128:131]
    ds_read_b64_tr_b16 v[156:157], v6 offset:52288
    v_rcp_f32 v75, v75
    v_mfma_f32_16x16x32_bf16 v[132:135], v[164:167], a[160:163], v[132:135]
    ds_read_b64_tr_b16 v[158:159], v6 offset:53824
    s_waitcnt lgkmcnt(6)
    v_mfma_f32_16x16x32_bf16 v[88:91], v[136:139], a[64:67], v[88:91]
    ds_read_b64_tr_b16 v[160:161], v6 offset:55296
    v_mul_f32 v80, v80, v72
    v_mfma_f32_16x16x32_bf16 v[92:95], v[136:139], a[164:167], v[92:95]
    ds_read_b64_tr_b16 v[162:163], v6 offset:56832
    s_add_u32 m0, s73, 0
    s_nop 0
    buffer_load_dwordx4 v2, s[28:31], s72 offen offset:0 sc1 lds
    v_mfma_f32_16x16x32_bf16 v[96:99], v[140:143], a[64:67], v[96:99]
    ds_read_b64_tr_b16 v[164:165], v6 offset:58368
    v_mul_f32 v81, v81, v73
    v_mfma_f32_16x16x32_bf16 v[100:103], v[140:143], a[164:167], v[100:103]
    ds_read_b64_tr_b16 v[166:167], v6 offset:59904
    v_mfma_f32_16x16x32_bf16 v[104:107], v[144:147], a[64:67], v[104:107]
    ds_read_b64_tr_b16 v[136:137], v6 offset:55328
    v_mul_f32 v82, v82, v74
    v_mfma_f32_16x16x32_bf16 v[108:111], v[144:147], a[164:167], v[108:111]
    ds_read_b64_tr_b16 v[138:139], v6 offset:56864
    s_waitcnt lgkmcnt(6)
    v_mfma_f32_16x16x32_bf16 v[112:115], v[148:151], a[64:67], v[112:115]
    ds_read_b64_tr_b16 v[140:141], v6 offset:58400
    v_mul_f32 v83, v83, v75
    v_mfma_f32_16x16x32_bf16 v[116:119], v[148:151], a[164:167], v[116:119]
    ds_read_b64_tr_b16 v[142:143], v6 offset:59936
    buffer_load_dwordx4 v2, s[28:31], s72 offen offset:1024 sc1 lds
    v_mfma_f32_16x16x32_bf16 v[120:123], v[152:155], a[64:67], v[120:123]
    ds_read_b64_tr_b16 v[144:145], v6 offset:55360
    v_cvt_pk_bf16_f32 v172, v80, v81
    v_mfma_f32_16x16x32_bf16 v[124:127], v[152:155], a[164:167], v[124:127]
    ds_read_b64_tr_b16 v[146:147], v6 offset:56896
    v_mfma_f32_16x16x32_bf16 v[128:131], v[156:159], a[64:67], v[128:131]
    ds_read_b64_tr_b16 v[148:149], v6 offset:58432
    v_cvt_pk_bf16_f32 v173, v82, v83
    v_mfma_f32_16x16x32_bf16 v[132:135], v[156:159], a[164:167], v[132:135]
    ds_read_b64_tr_b16 v[150:151], v6 offset:59968
    s_waitcnt lgkmcnt(6)
    v_mfma_f32_16x16x32_bf16 v[88:91], v[160:163], a[68:71], v[88:91]
    ds_read_b64_tr_b16 v[152:153], v7 offset:0
    v_exp_f32 v76, v76
    v_mfma_f32_16x16x32_bf16 v[92:95], v[160:163], a[168:171], v[92:95]
    ds_read_b64_tr_b16 v[154:155], v7 offset:1536
    buffer_load_dwordx4 v2, s[28:31], s72 offen offset:2048 sc1 lds
    v_mfma_f32_16x16x32_bf16 v[96:99], v[164:167], a[68:71], v[96:99]
    ds_read_b64_tr_b16 v[156:157], v7 offset:3072
    v_exp_f32 v77, v77
    v_mfma_f32_16x16x32_bf16 v[100:103], v[164:167], a[168:171], v[100:103]
    ds_read_b64_tr_b16 v[158:159], v7 offset:4608
    v_mfma_f32_16x16x32_bf16 v[104:107], v[136:139], a[68:71], v[104:107]
    ds_read_b64_tr_b16 v[160:161], v7 offset:32
    v_exp_f32 v78, v78
    v_mfma_f32_16x16x32_bf16 v[108:111], v[136:139], a[168:171], v[108:111]
    ds_read_b64_tr_b16 v[162:163], v7 offset:1568
    s_waitcnt lgkmcnt(6)
    v_mfma_f32_16x16x32_bf16 v[112:115], v[140:143], a[68:71], v[112:115]
    ds_read_b64_tr_b16 v[164:165], v7 offset:3104
    v_exp_f32 v79, v79
    v_mfma_f32_16x16x32_bf16 v[116:119], v[140:143], a[168:171], v[116:119]
    ds_read_b64_tr_b16 v[166:167], v7 offset:4640
    buffer_load_dwordx4 v2, s[28:31], s72 offen offset:3072 sc1 lds
    v_mfma_f32_16x16x32_bf16 v[120:123], v[144:147], a[68:71], v[120:123]
    ds_read_b64_tr_b16 v[136:137], v7 offset:64
    v_add_f32 v76, 1.0, v76
    v_mfma_f32_16x16x32_bf16 v[124:127], v[144:147], a[168:171], v[124:127]
    ds_read_b64_tr_b16 v[138:139], v7 offset:1600
    v_mfma_f32_16x16x32_bf16 v[128:131], v[148:151], a[68:71], v[128:131]
    ds_read_b64_tr_b16 v[140:141], v7 offset:3136
    v_add_f32 v77, 1.0, v77
    v_mfma_f32_16x16x32_bf16 v[132:135], v[148:151], a[168:171], v[132:135]
    ds_read_b64_tr_b16 v[142:143], v7 offset:4672
    s_waitcnt lgkmcnt(6)
    v_mfma_f32_16x16x32_bf16 v[88:91], v[152:155], a[72:75], v[88:91]
    ds_read_b64_tr_b16 v[144:145], v7 offset:6144
    v_add_f32 v78, 1.0, v78
    v_mfma_f32_16x16x32_bf16 v[92:95], v[152:155], a[172:175], v[92:95]
    ds_read_b64_tr_b16 v[146:147], v7 offset:7680
    s_add_u32 m0, s73, 4096
    s_add_u32 s72, s72, 4096
    buffer_load_dwordx4 v2, s[28:31], s72 offen offset:0 sc1 lds
    s_add_u32 s72, s72, 6144
    v_mfma_f32_16x16x32_bf16 v[96:99], v[156:159], a[72:75], v[96:99]
    ds_read_b64_tr_b16 v[148:149], v7 offset:9216
    v_add_f32 v79, 1.0, v79
    v_mfma_f32_16x16x32_bf16 v[100:103], v[156:159], a[172:175], v[100:103]
    ds_read_b64_tr_b16 v[150:151], v7 offset:10752
    v_mfma_f32_16x16x32_bf16 v[104:107], v[160:163], a[72:75], v[104:107]
    ds_read_b64_tr_b16 v[152:153], v7 offset:6176
    v_rcp_f32 v76, v76
    v_mfma_f32_16x16x32_bf16 v[108:111], v[160:163], a[172:175], v[108:111]
    ds_read_b64_tr_b16 v[154:155], v7 offset:7712
    s_waitcnt lgkmcnt(6)
    v_mfma_f32_16x16x32_bf16 v[112:115], v[164:167], a[72:75], v[112:115]
    ds_read_b64_tr_b16 v[156:157], v7 offset:9248
    v_rcp_f32 v77, v77
    v_mfma_f32_16x16x32_bf16 v[116:119], v[164:167], a[172:175], v[116:119]
    ds_read_b64_tr_b16 v[158:159], v7 offset:10784
    s_add_u32 m0, s73, 20480
    s_nop 0
    buffer_load_dwordx4 v2, s[28:31], s72 offen offset:0 sc1 lds
    v_mfma_f32_16x16x32_bf16 v[120:123], v[136:139], a[72:75], v[120:123]
    ds_read_b64_tr_b16 v[160:161], v7 offset:6208
    v_rcp_f32 v78, v78
    v_mfma_f32_16x16x32_bf16 v[124:127], v[136:139], a[172:175], v[124:127]
    ds_read_b64_tr_b16 v[162:163], v7 offset:7744
    v_mfma_f32_16x16x32_bf16 v[128:131], v[140:143], a[72:75], v[128:131]
    ds_read_b64_tr_b16 v[164:165], v7 offset:9280
    v_rcp_f32 v79, v79
    v_mfma_f32_16x16x32_bf16 v[132:135], v[140:143], a[172:175], v[132:135]
    ds_read_b64_tr_b16 v[166:167], v7 offset:10816
    s_waitcnt lgkmcnt(6)
    v_mfma_f32_16x16x32_bf16 v[88:91], v[144:147], a[76:79], v[88:91]
    v_mul_f32 v84, v84, v76
    v_mfma_f32_16x16x32_bf16 v[92:95], v[144:147], a[176:179], v[92:95]
    buffer_load_dwordx4 v2, s[28:31], s72 offen offset:1024 sc1 lds
    v_mfma_f32_16x16x32_bf16 v[96:99], v[148:151], a[76:79], v[96:99]
    v_mul_f32 v85, v85, v77
    v_mfma_f32_16x16x32_bf16 v[100:103], v[148:151], a[176:179], v[100:103]
    v_mfma_f32_16x16x32_bf16 v[104:107], v[152:155], a[76:79], v[104:107]
    v_mul_f32 v86, v86, v78
    v_mfma_f32_16x16x32_bf16 v[108:111], v[152:155], a[176:179], v[108:111]
    s_waitcnt lgkmcnt(0)
    v_mfma_f32_16x16x32_bf16 v[112:115], v[156:159], a[76:79], v[112:115]
    v_mul_f32 v87, v87, v79
    v_mfma_f32_16x16x32_bf16 v[116:119], v[156:159], a[176:179], v[116:119]
    buffer_load_dwordx4 v2, s[28:31], s72 offen offset:2048 sc1 lds
    v_mfma_f32_16x16x32_bf16 v[120:123], v[160:163], a[76:79], v[120:123]
    v_cvt_pk_bf16_f32 v184, v84, v85
    v_mfma_f32_16x16x32_bf16 v[124:127], v[160:163], a[176:179], v[124:127]
    v_mfma_f32_16x16x32_bf16 v[128:131], v[164:167], a[76:79], v[128:131]
    v_cvt_pk_bf16_f32 v185, v86, v87
    v_mfma_f32_16x16x32_bf16 v[132:135], v[164:167], a[176:179], v[132:135]
    buffer_load_dwordx4 v2, s[28:31], s72 offen offset:3072 sc1 lds
    s_add_u32 m0, s73, 24576
    s_add_u32 s72, s72, 4096
    buffer_load_dwordx4 v2, s[28:31], s72 offen offset:0 sc1 lds
    s_add_u32 s72, s72, 6144
    s_barrier
    v_exp_f32 v88, v88
    v_exp_f32 v89, v89
    v_exp_f32 v90, v90
    v_exp_f32 v91, v91
    s_add_u32 m0, s73, 40960
    s_nop 0
    buffer_load_dwordx4 v2, s[28:31], s72 offen offset:0 sc1 lds
    v_add_f32 v88, 1.0, v88
    v_add_f32 v89, 1.0, v89
    v_add_f32 v90, 1.0, v90
    v_add_f32 v91, 1.0, v91
    v_rcp_f32 v88, v88
    v_rcp_f32 v89, v89
    v_rcp_f32 v90, v90
    v_rcp_f32 v91, v91
    v_mul_f32 v96, v96, v88
    buffer_load_dwordx4 v2, s[28:31], s72 offen offset:1024 sc1 lds
    v_mul_f32 v97, v97, v89
    v_mul_f32 v98, v98, v90
    v_mul_f32 v99, v99, v91
    v_cvt_pk_bf16_f32 v174, v96, v97
    v_cvt_pk_bf16_f32 v175, v98, v99
    buffer_store_dwordx4 v[172:175], v2, s[28:31], s64 offen offset:1024
    v_exp_f32 v92, v92
    v_exp_f32 v93, v93
    v_exp_f32 v94, v94
    buffer_load_dwordx4 v2, s[28:31], s72 offen offset:2048 sc1 lds
    v_exp_f32 v95, v95
    v_add_f32 v92, 1.0, v92
    v_add_f32 v93, 1.0, v93
    v_add_f32 v94, 1.0, v94
    v_add_f32 v95, 1.0, v95
    v_rcp_f32 v92, v92
    v_rcp_f32 v93, v93
    v_rcp_f32 v94, v94
    v_rcp_f32 v95, v95
    buffer_load_dwordx4 v2, s[28:31], s72 offen offset:3072 sc1 lds
    v_mul_f32 v100, v100, v92
    v_mul_f32 v101, v101, v93
    v_mul_f32 v102, v102, v94
    v_mul_f32 v103, v103, v95
    v_cvt_pk_bf16_f32 v186, v100, v101
    v_cvt_pk_bf16_f32 v187, v102, v103
    buffer_store_dwordx4 v[184:187], v2, s[28:31], s65 offen offset:1024
    v_exp_f32 v104, v104
    v_exp_f32 v105, v105
    s_add_u32 m0, s73, 45056
    s_add_u32 s72, s72, 4096
    buffer_load_dwordx4 v2, s[28:31], s72 offen offset:0 sc1 lds
    s_add_u32 s72, s72, 6144
    v_exp_f32 v106, v106
    v_exp_f32 v107, v107
    v_add_f32 v104, 1.0, v104
    v_add_f32 v105, 1.0, v105
    v_add_f32 v106, 1.0, v106
    v_add_f32 v107, 1.0, v107
    v_rcp_f32 v104, v104
    v_rcp_f32 v105, v105
    v_rcp_f32 v106, v106
    s_add_u32 m0, s73, 61440
    s_nop 0
    buffer_load_dwordx4 v2, s[28:31], s72 offen offset:0 sc1 lds
    v_rcp_f32 v107, v107
    v_mul_f32 v112, v112, v104
    v_mul_f32 v113, v113, v105
    v_mul_f32 v114, v114, v106
    v_mul_f32 v115, v115, v107
    v_cvt_pk_bf16_f32 v176, v112, v113
    v_cvt_pk_bf16_f32 v177, v114, v115
    v_exp_f32 v108, v108
    v_exp_f32 v109, v109
    buffer_load_dwordx4 v2, s[28:31], s72 offen offset:1024 sc1 lds
    v_exp_f32 v110, v110
    v_exp_f32 v111, v111
    v_add_f32 v108, 1.0, v108
    v_add_f32 v109, 1.0, v109
    v_add_f32 v110, 1.0, v110
    v_add_f32 v111, 1.0, v111
    v_rcp_f32 v108, v108
    v_rcp_f32 v109, v109
    v_rcp_f32 v110, v110
    buffer_load_dwordx4 v2, s[28:31], s72 offen offset:2048 sc1 lds
    v_rcp_f32 v111, v111
    v_mul_f32 v116, v116, v108
    v_mul_f32 v117, v117, v109
    v_mul_f32 v118, v118, v110
    v_mul_f32 v119, v119, v111
    v_cvt_pk_bf16_f32 v188, v116, v117
    v_cvt_pk_bf16_f32 v189, v118, v119
    v_exp_f32 v120, v120
    v_exp_f32 v121, v121
    buffer_load_dwordx4 v2, s[28:31], s72 offen offset:3072 sc1 lds
    v_exp_f32 v122, v122
    v_exp_f32 v123, v123
    v_add_f32 v120, 1.0, v120
    v_add_f32 v121, 1.0, v121
    v_add_f32 v122, 1.0, v122
    v_add_f32 v123, 1.0, v123
    v_rcp_f32 v120, v120
    v_rcp_f32 v121, v121
    v_rcp_f32 v122, v122
    s_add_u32 m0, s73, 65536
    s_add_u32 s72, s72, 4096
    buffer_load_dwordx4 v2, s[28:31], s72 offen offset:0 sc1 lds
    s_add_u32 s72, s72, 6144
    v_rcp_f32 v123, v123
    v_mul_f32 v128, v128, v120
    v_mul_f32 v129, v129, v121
    v_mul_f32 v130, v130, v122
    v_mul_f32 v131, v131, v123
    v_cvt_pk_bf16_f32 v178, v128, v129
    v_cvt_pk_bf16_f32 v179, v130, v131
    buffer_store_dwordx4 v[176:179], v2, s[28:31], s64 offen offset:2048
    v_exp_f32 v124, v124
    v_exp_f32 v125, v125
    v_exp_f32 v126, v126
    v_exp_f32 v127, v127
    v_add_f32 v124, 1.0, v124
    v_add_f32 v125, 1.0, v125
    v_add_f32 v126, 1.0, v126
    v_add_f32 v127, 1.0, v127
    v_rcp_f32 v124, v124
    v_rcp_f32 v125, v125
    v_rcp_f32 v126, v126
    v_rcp_f32 v127, v127
    v_mul_f32 v132, v132, v124
    v_mul_f32 v133, v133, v125
    v_mul_f32 v134, v134, v126
    v_mul_f32 v135, v135, v127
    v_cvt_pk_bf16_f32 v190, v132, v133
    v_cvt_pk_bf16_f32 v191, v134, v135
    buffer_store_dwordx4 v[188:191], v2, s[28:31], s65 offen offset:2048
    s_waitcnt vmcnt(0)
    s_lshl_b32 s60, s44, 8
    s_add_u32 s60, s60, 20480
    s_lshl_b32 s61, s45, 4
    s_lshl_b32 s62, s46, 2
    s_add_u32 s61, s61, s62
    v_mov_b32 v8, s61
    v_mov_b32 v9, s47
    s_mov_b64 exec, 1
    s_cmp_eq_u32 s55, 0
    s_cbranch_scc1 Lslow39
    buffer_store_dword v9, v8, s[28:31], s60 offen
Ljoin40:
    s_mov_b64 exec, -1
L_c5:
    s_add_u32 m0, s73, 81920
    s_nop 0
    buffer_load_dwordx4 v2, s[28:31], s72 offen offset:0 sc1 lds
    buffer_load_dwordx4 v2, s[28:31], s72 offen offset:1024 sc1 lds
    buffer_load_dwordx4 v2, s[28:31], s72 offen offset:2048 sc1 lds
    buffer_load_dwordx4 v2, s[28:31], s72 offen offset:3072 sc1 lds
    s_add_u32 m0, s73, 86016
    s_add_u32 s72, s72, 4096
    buffer_load_dwordx4 v2, s[28:31], s72 offen offset:0 sc1 lds
    s_add_u32 s72, s72, 6144
    s_mul_i32 s62, s52, 5120
    v_add_u32 v5, s62, v20
    v_add_u32 v6, 61440, v5
    v_add_u32 v7, 122880, v5
    v_lshlrev_b32 v140, 16, v230
    v_and_b32 v141, 0xffff0000, v230
    v_lshlrev_b32 v142, 16, v231
    v_and_b32 v143, 0xffff0000, v231
    v_lshlrev_b32 v144, 16, v232
    v_and_b32 v145, 0xffff0000, v232
    v_lshlrev_b32 v146, 16, v233
    v_and_b32 v147, 0xffff0000, v233
    v_lshlrev_b32 v148, 16, v234
    v_and_b32 v149, 0xffff0000, v234
    v_lshlrev_b32 v150, 16, v235
    v_and_b32 v151, 0xffff0000, v235
    v_lshlrev_b32 v152, 16, v236
    v_and_b32 v153, 0xffff0000, v236
    v_lshlrev_b32 v154, 16, v237
    v_and_b32 v155, 0xffff0000, v237
    v_lshlrev_b32 v156, 16, v238
    v_and_b32 v157, 0xffff0000, v238
    v_lshlrev_b32 v158, 16, v239
    v_and_b32 v159, 0xffff0000, v239
    v_accvgpr_read_b32 v120, a80
    v_accvgpr_read_b32 v121, a81
    v_accvgpr_read_b32 v122, a82
    v_accvgpr_read_b32 v123, a83
    v_accvgpr_read_b32 v124, a84
    v_accvgpr_read_b32 v125, a85
    v_accvgpr_read_b32 v126, a86
    v_accvgpr_read_b32 v127, a87
    v_accvgpr_read_b32 v128, a88
    v_accvgpr_read_b32 v129, a89
    v_accvgpr_read_b32 v130, a90
    v_accvgpr_read_b32 v131, a91
    v_accvgpr_read_b32 v132, a92
    v_accvgpr_read_b32 v133, a93
    v_accvgpr_read_b32 v134, a94
    v_accvgpr_read_b32 v135, a95
    v_accvgpr_read_b32 v136, a96
    v_accvgpr_read_b32 v137, a97
    v_accvgpr_read_b32 v138, a98
    v_accvgpr_read_b32 v139, a99
    s_lshl_b32 s74, s44, 1
    s_add_u32 s74, s74, s50
    s_lshl_b32 s74, s74, 2
    s_add_u32 s74, s74, s46
    s_xor_b32 s75, s74, 1
    s_mul_i32 s62, s52, 24576
    s_add_u32 s62, s62, 16777216
    s_mul_i32 s74, s74, 49152
    s_add_u32 s74, s74, s62
    s_mul_i32 s75, s75, 49152
    s_add_u32 s75, s75, s62
    s_mov_b32 s32, s22
    s_mov_b32 s33, s23
    s_mov_b32 s34, 0x280000
    s_mov_b32 s35, 0x20000
    v_and_b32 v12, 15, v1
    v_mul_u32_u24 v12, 1280, v12
    v_lshrrev_b32 v15, 5, v1
    v_lshl_add_u32 v15, v15, 4, v12
    v_bfe_u32 v14, v1, 4, 1
    v_lshl_add_u32 v14, v14, 5, v15
    s_lshl_b32 s60, s44, 8
    s_add_u32 s60, s60, 20480
    v_and_b32 v3, 7, v1
    s_lshl_b32 s61, s52, 3
    v_add_u32 v3, s61, v3
    v_lshlrev_b32 v3, 4, v3
    s_lshl_b32 s61, s50, 1
    s_add_u32 s61, s61, s53
    s_lshl_b32 s61, s61, 2
    v_add_u32 v3, s61, v3
    s_mov_b32 s54, 32768
Lp41:
    buffer_load_dword v4, v3, s[28:31], s60 offen offset:0 sc1
    s_waitcnt vmcnt(0)
    v_cmp_ne_u32 vcc, s47, v4
    s_cbranch_vccz Lpd42
    s_sub_u32 s54, s54, 1
    s_cbranch_scc0 Lp41
Lpd42:
    s_cmp_eq_u32 s55, 0
    s_cbranch_scc1 Lacq43
Lacqj44:
    buffer_load_dwordx4 a[0:3], v2, s[28:31], s74 offen offset:0 sc1
    buffer_load_dwordx4 a[96:99], v2, s[28:31], s75 offen offset:0 sc1
    buffer_load_dwordx4 a[4:7], v2, s[28:31], s74 offen offset:1024 sc1
    buffer_load_dwordx4 a[100:103], v2, s[28:31], s75 offen offset:1024 sc1
    buffer_load_dwordx4 a[8:11], v2, s[28:31], s74 offen offset:2048 sc1
    buffer_load_dwordx4 a[104:107], v2, s[28:31], s75 offen offset:2048 sc1
    s_barrier
    ds_read_b64_tr_b16 v[80:81], v7 offset:20480
    ds_read_b64_tr_b16 v[82:83], v7 offset:23040
    ds_read_b64_tr_b16 v[84:85], v7 offset:20512
    ds_read_b64_tr_b16 v[86:87], v7 offset:23072
    ds_read_b64_tr_b16 v[88:89], v7 offset:20544
    ds_read_b64_tr_b16 v[90:91], v7 offset:23104
    ds_read_b64_tr_b16 v[92:93], v7 offset:20576
    ds_read_b64_tr_b16 v[94:95], v7 offset:23136
    ds_read_b64_tr_b16 v[96:97], v7 offset:20608
    ds_read_b64_tr_b16 v[98:99], v7 offset:23168
    s_waitcnt vmcnt(4) lgkmcnt(4)
    v_mfma_f32_16x16x32_bf16 v[40:43], v[80:83], a[0:3], 0
    ds_read_b64_tr_b16 v[100:101], v7 offset:30720
    buffer_load_dwordx4 a[12:15], v2, s[28:31], s74 offen offset:3072 sc1
    s_add_u32 s74, s74, 4096
    v_mfma_f32_16x16x32_bf16 v[60:63], v[80:83], a[96:99], 0
    ds_read_b64_tr_b16 v[102:103], v7 offset:33280
    v_mfma_f32_16x16x32_bf16 v[44:47], v[84:87], a[0:3], 0
    ds_read_b64_tr_b16 v[104:105], v7 offset:30752
    v_mfma_f32_16x16x32_bf16 v[64:67], v[84:87], a[96:99], 0
    ds_read_b64_tr_b16 v[106:107], v7 offset:33312
    buffer_load_dwordx4 a[108:111], v2, s[28:31], s75 offen offset:3072 sc1
    s_add_u32 s75, s75, 4096
    v_mfma_f32_16x16x32_bf16 v[48:51], v[88:91], a[0:3], 0
    ds_read_b64_tr_b16 v[108:109], v7 offset:30784
    v_mfma_f32_16x16x32_bf16 v[68:71], v[88:91], a[96:99], 0
    ds_read_b64_tr_b16 v[110:111], v7 offset:33344
    buffer_load_dwordx4 a[16:19], v2, s[28:31], s74 offen offset:0 sc1
    s_waitcnt lgkmcnt(6)
    v_mfma_f32_16x16x32_bf16 v[52:55], v[92:95], a[0:3], 0
    ds_read_b64_tr_b16 v[112:113], v7 offset:30816
    v_mfma_f32_16x16x32_bf16 v[72:75], v[92:95], a[96:99], 0
    ds_read_b64_tr_b16 v[114:115], v7 offset:33376
    v_mfma_f32_16x16x32_bf16 v[56:59], v[96:99], a[0:3], 0
    ds_read_b64_tr_b16 v[116:117], v7 offset:30848
    buffer_load_dwordx4 a[112:115], v2, s[28:31], s75 offen offset:0 sc1
    v_mfma_f32_16x16x32_bf16 v[76:79], v[96:99], a[96:99], 0
    ds_read_b64_tr_b16 v[118:119], v7 offset:33408
    s_waitcnt vmcnt(6) lgkmcnt(4)
    v_mfma_f32_16x16x32_bf16 v[40:43], v[100:103], a[4:7], v[40:43]
    ds_read_b64_tr_b16 v[80:81], v5 offset:0
    buffer_load_dwordx4 a[20:23], v2, s[28:31], s74 offen offset:1024 sc1
    v_mfma_f32_16x16x32_bf16 v[60:63], v[100:103], a[100:103], v[60:63]
    ds_read_b64_tr_b16 v[82:83], v5 offset:2560
    v_mfma_f32_16x16x32_bf16 v[44:47], v[104:107], a[4:7], v[44:47]
    ds_read_b64_tr_b16 v[84:85], v5 offset:32
    v_mfma_f32_16x16x32_bf16 v[64:67], v[104:107], a[100:103], v[64:67]
    ds_read_b64_tr_b16 v[86:87], v5 offset:2592
    buffer_load_dwordx4 a[116:119], v2, s[28:31], s75 offen offset:1024 sc1
    v_mfma_f32_16x16x32_bf16 v[48:51], v[108:111], a[4:7], v[48:51]
    ds_read_b64_tr_b16 v[88:89], v5 offset:64
    v_mfma_f32_16x16x32_bf16 v[68:71], v[108:111], a[100:103], v[68:71]
    ds_read_b64_tr_b16 v[90:91], v5 offset:2624
    buffer_load_dwordx4 a[24:27], v2, s[28:31], s74 offen offset:2048 sc1
    s_waitcnt lgkmcnt(6)
    v_mfma_f32_16x16x32_bf16 v[52:55], v[112:115], a[4:7], v[52:55]
    ds_read_b64_tr_b16 v[92:93], v5 offset:96
    v_mfma_f32_16x16x32_bf16 v[72:75], v[112:115], a[100:103], v[72:75]
    ds_read_b64_tr_b16 v[94:95], v5 offset:2656
    v_mfma_f32_16x16x32_bf16 v[56:59], v[116:119], a[4:7], v[56:59]
    ds_read_b64_tr_b16 v[96:97], v5 offset:128
    buffer_load_dwordx4 a[120:123], v2, s[28:31], s75 offen offset:2048 sc1
    v_mfma_f32_16x16x32_bf16 v[76:79], v[116:119], a[100:103], v[76:79]
    ds_read_b64_tr_b16 v[98:99], v5 offset:2688
    s_waitcnt vmcnt(8) lgkmcnt(4)
    v_mfma_f32_16x16x32_bf16 v[40:43], v[80:83], a[8:11], v[40:43]
    ds_read_b64_tr_b16 v[100:101], v5 offset:10240
    buffer_load_dwordx4 a[28:31], v2, s[28:31], s74 offen offset:3072 sc1
    s_add_u32 s74, s74, 4096
    v_mfma_f32_16x16x32_bf16 v[60:63], v[80:83], a[104:107], v[60:63]
    ds_read_b64_tr_b16 v[102:103], v5 offset:12800
    v_mfma_f32_16x16x32_bf16 v[44:47], v[84:87], a[8:11], v[44:47]
    ds_read_b64_tr_b16 v[104:105], v5 offset:10272
    v_mfma_f32_16x16x32_bf16 v[64:67], v[84:87], a[104:107], v[64:67]
    ds_read_b64_tr_b16 v[106:107], v5 offset:12832
    buffer_load_dwordx4 a[124:127], v2, s[28:31], s75 offen offset:3072 sc1
    s_add_u32 s75, s75, 4096
    v_mfma_f32_16x16x32_bf16 v[48:51], v[88:91], a[8:11], v[48:51]
    ds_read_b64_tr_b16 v[108:109], v5 offset:10304
    v_mfma_f32_16x16x32_bf16 v[68:71], v[88:91], a[104:107], v[68:71]
    ds_read_b64_tr_b16 v[110:111], v5 offset:12864
    buffer_load_dwordx4 a[32:35], v2, s[28:31], s74 offen offset:0 sc1
    s_waitcnt lgkmcnt(6)
    v_mfma_f32_16x16x32_bf16 v[52:55], v[92:95], a[8:11], v[52:55]
    ds_read_b64_tr_b16 v[112:113], v5 offset:10336
    v_mfma_f32_16x16x32_bf16 v[72:75], v[92:95], a[104:107], v[72:75]
    ds_read_b64_tr_b16 v[114:115], v5 offset:12896
    v_mfma_f32_16x16x32_bf16 v[56:59], v[96:99], a[8:11], v[56:59]
    ds_read_b64_tr_b16 v[116:117], v5 offset:10368
    buffer_load_dwordx4 a[128:131], v2, s[28:31], s75 offen offset:0 sc1
    v_mfma_f32_16x16x32_bf16 v[76:79], v[96:99], a[104:107], v[76:79]
    ds_read_b64_tr_b16 v[118:119], v5 offset:12928
    s_barrier
    s_waitcnt vmcnt(10) lgkmcnt(4)
    v_mfma_f32_16x16x32_bf16 v[40:43], v[100:103], a[12:15], v[40:43]
    ds_read_b64_tr_b16 v[80:81], v5 offset:20480
    s_add_u32 m0, s73, 102400
    s_nop 0
    buffer_load_dwordx4 v2, s[28:31], s72 offen offset:0 sc1 lds
    v_mfma_f32_16x16x32_bf16 v[60:63], v[100:103], a[108:111], v[60:63]
    ds_read_b64_tr_b16 v[82:83], v5 offset:23040
    v_mfma_f32_16x16x32_bf16 v[44:47], v[104:107], a[12:15], v[44:47]
    ds_read_b64_tr_b16 v[84:85], v5 offset:20512
    v_mfma_f32_16x16x32_bf16 v[64:67], v[104:107], a[108:111], v[64:67]
    ds_read_b64_tr_b16 v[86:87], v5 offset:23072
    buffer_load_dwordx4 v2, s[28:31], s72 offen offset:1024 sc1 lds
    v_mfma_f32_16x16x32_bf16 v[48:51], v[108:111], a[12:15], v[48:51]
    ds_read_b64_tr_b16 v[88:89], v5 offset:20544
    v_mfma_f32_16x16x32_bf16 v[68:71], v[108:111], a[108:111], v[68:71]
    ds_read_b64_tr_b16 v[90:91], v5 offset:23104
    buffer_load_dwordx4 v2, s[28:31], s72 offen offset:2048 sc1 lds
    s_waitcnt lgkmcnt(6)
    v_mfma_f32_16x16x32_bf16 v[52:55], v[112:115], a[12:15], v[52:55]
    ds_read_b64_tr_b16 v[92:93], v5 offset:20576
    v_mfma_f32_16x16x32_bf16 v[72:75], v[112:115], a[108:111], v[72:75]
    ds_read_b64_tr_b16 v[94:95], v5 offset:23136
    v_mfma_f32_16x16x32_bf16 v[56:59], v[116:119], a[12:15], v[56:59]
    ds_read_b64_tr_b16 v[96:97], v5 offset:20608
    buffer_load_dwordx4 v2, s[28:31], s72 offen offset:3072 sc1 lds
    v_mfma_f32_16x16x32_bf16 v[76:79], v[116:119], a[108:111], v[76:79]
    ds_read_b64_tr_b16 v[98:99], v5 offset:23168
    s_waitcnt vmcnt(12) lgkmcnt(4)
    v_mfma_f32_16x16x32_bf16 v[40:43], v[80:83], a[16:19], v[40:43]
    ds_read_b64_tr_b16 v[100:101], v5 offset:30720
    s_add_u32 m0, s73, 106496
    s_add_u32 s72, s72, 4096
    buffer_load_dwordx4 v2, s[28:31], s72 offen offset:0 sc1 lds
    s_add_u32 s72, s72, 6144
    v_mfma_f32_16x16x32_bf16 v[60:63], v[80:83], a[112:115], v[60:63]
    ds_read_b64_tr_b16 v[102:103], v5 offset:33280
    v_mfma_f32_16x16x32_bf16 v[44:47], v[84:87], a[16:19], v[44:47]
    ds_read_b64_tr_b16 v[104:105], v5 offset:30752
    v_mfma_f32_16x16x32_bf16 v[64:67], v[84:87], a[112:115], v[64:67]
    ds_read_b64_tr_b16 v[106:107], v5 offset:33312
    buffer_load_dwordx4 a[36:39], v2, s[28:31], s74 offen offset:1024 sc1
    v_mfma_f32_16x16x32_bf16 v[48:51], v[88:91], a[16:19], v[48:51]
    ds_read_b64_tr_b16 v[108:109], v5 offset:30784
    v_mfma_f32_16x16x32_bf16 v[68:71], v[88:91], a[112:115], v[68:71]
    ds_read_b64_tr_b16 v[110:111], v5 offset:33344
    buffer_load_dwordx4 a[132:135], v2, s[28:31], s75 offen offset:1024 sc1
    s_waitcnt lgkmcnt(6)
    v_mfma_f32_16x16x32_bf16 v[52:55], v[92:95], a[16:19], v[52:55]
    ds_read_b64_tr_b16 v[112:113], v5 offset:30816
    v_mfma_f32_16x16x32_bf16 v[72:75], v[92:95], a[112:115], v[72:75]
    ds_read_b64_tr_b16 v[114:115], v5 offset:33376
    v_mfma_f32_16x16x32_bf16 v[56:59], v[96:99], a[16:19], v[56:59]
    ds_read_b64_tr_b16 v[116:117], v5 offset:30848
    buffer_load_dwordx4 a[40:43], v2, s[28:31], s74 offen offset:2048 sc1
    v_mfma_f32_16x16x32_bf16 v[76:79], v[96:99], a[112:115], v[76:79]
    ds_read_b64_tr_b16 v[118:119], v5 offset:33408
    s_barrier
    s_waitcnt vmcnt(14) lgkmcnt(4)
    v_mfma_f32_16x16x32_bf16 v[40:43], v[100:103], a[20:23], v[40:43]
    ds_read_b64_tr_b16 v[80:81], v5 offset:40960
    buffer_load_dwordx4 a[136:139], v2, s[28:31], s75 offen offset:2048 sc1
    v_mfma_f32_16x16x32_bf16 v[60:63], v[100:103], a[116:119], v[60:63]
    ds_read_b64_tr_b16 v[82:83], v5 offset:43520
    v_mfma_f32_16x16x32_bf16 v[44:47], v[104:107], a[20:23], v[44:47]
    ds_read_b64_tr_b16 v[84:85], v5 offset:40992
    v_mfma_f32_16x16x32_bf16 v[64:67], v[104:107], a[116:119], v[64:67]
    ds_read_b64_tr_b16 v[86:87], v5 offset:43552
    s_add_u32 m0, s73, 122880
    s_nop 0
    buffer_load_dwordx4 v2, s[28:31], s72 offen offset:0 sc1 lds
    v_mfma_f32_16x16x32_bf16 v[48:51], v[108:111], a[20:23], v[48:51]
    ds_read_b64_tr_b16 v[88:89], v5 offset:41024
    v_mfma_f32_16x16x32_bf16 v[68:71], v[108:111], a[116:119], v[68:71]
    ds_read_b64_tr_b16 v[90:91], v5 offset:43584
    buffer_load_dwordx4 v2, s[28:31], s72 offen offset:1024 sc1 lds
    s_waitcnt lgkmcnt(6)
    v_mfma_f32_16x16x32_bf16 v[52:55], v[112:115], a[20:23], v[52:55]
    ds_read_b64_tr_b16 v[92:93], v5 offset:41056
    v_mfma_f32_16x16x32_bf16 v[72:75], v[112:115], a[116:119], v[72:75]
    ds_read_b64_tr_b16 v[94:95], v5 offset:43616
    v_mfma_f32_16x16x32_bf16 v[56:59], v[116:119], a[20:23], v[56:59]
    ds_read_b64_tr_b16 v[96:97], v5 offset:41088
    buffer_load_dwordx4 v2, s[28:31], s72 offen offset:2048 sc1 lds
    v_mfma_f32_16x16x32_bf16 v[76:79], v[116:119], a[116:119], v[76:79]
    ds_read_b64_tr_b16 v[98:99], v5 offset:43648
    s_waitcnt vmcnt(16) lgkmcnt(4)
    v_mfma_f32_16x16x32_bf16 v[40:43], v[80:83], a[24:27], v[40:43]
    ds_read_b64_tr_b16 v[100:101], v5 offset:51200
    buffer_load_dwordx4 v2, s[28:31], s72 offen offset:3072 sc1 lds
    v_mfma_f32_16x16x32_bf16 v[60:63], v[80:83], a[120:123], v[60:63]
    ds_read_b64_tr_b16 v[102:103], v5 offset:53760
    v_mfma_f32_16x16x32_bf16 v[44:47], v[84:87], a[24:27], v[44:47]
    ds_read_b64_tr_b16 v[104:105], v5 offset:51232
    v_mfma_f32_16x16x32_bf16 v[64:67], v[84:87], a[120:123], v[64:67]
    ds_read_b64_tr_b16 v[106:107], v5 offset:53792
    s_add_u32 m0, s73, 126976
    s_add_u32 s72, s72, 4096
    buffer_load_dwordx4 v2, s[28:31], s72 offen offset:0 sc1 lds
    s_add_u32 s72, s72, 6144
    v_mfma_f32_16x16x32_bf16 v[48:51], v[88:91], a[24:27], v[48:51]
    ds_read_b64_tr_b16 v[108:109], v5 offset:51264
    v_mfma_f32_16x16x32_bf16 v[68:71], v[88:91], a[120:123], v[68:71]
    ds_read_b64_tr_b16 v[110:111], v5 offset:53824
    buffer_load_dwordx4 a[44:47], v2, s[28:31], s74 offen offset:3072 sc1
    s_add_u32 s74, s74, 4096
    s_waitcnt lgkmcnt(6)
    v_mfma_f32_16x16x32_bf16 v[52:55], v[92:95], a[24:27], v[52:55]
    ds_read_b64_tr_b16 v[112:113], v5 offset:51296
    v_mfma_f32_16x16x32_bf16 v[72:75], v[92:95], a[120:123], v[72:75]
    ds_read_b64_tr_b16 v[114:115], v5 offset:53856
    v_mfma_f32_16x16x32_bf16 v[56:59], v[96:99], a[24:27], v[56:59]
    ds_read_b64_tr_b16 v[116:117], v5 offset:51328
    buffer_load_dwordx4 a[140:143], v2, s[28:31], s75 offen offset:3072 sc1
    s_add_u32 s75, s75, 4096
    v_mfma_f32_16x16x32_bf16 v[76:79], v[96:99], a[120:123], v[76:79]
    ds_read_b64_tr_b16 v[118:119], v5 offset:53888
    s_barrier
    s_waitcnt vmcnt(18) lgkmcnt(4)
    v_mfma_f32_16x16x32_bf16 v[40:43], v[100:103], a[28:31], v[40:43]
    ds_read_b64_tr_b16 v[80:81], v6 offset:0
    buffer_load_dwordx4 a[48:51], v2, s[28:31], s74 offen offset:0 sc1
    v_mfma_f32_16x16x32_bf16 v[60:63], v[100:103], a[124:127], v[60:63]
    ds_read_b64_tr_b16 v[82:83], v6 offset:2560
    v_mfma_f32_16x16x32_bf16 v[44:47], v[104:107], a[28:31], v[44:47]
    ds_read_b64_tr_b16 v[84:85], v6 offset:32
    v_mfma_f32_16x16x32_bf16 v[64:67], v[104:107], a[124:127], v[64:67]
    ds_read_b64_tr_b16 v[86:87], v6 offset:2592
    buffer_load_dwordx4 a[144:147], v2, s[28:31], s75 offen offset:0 sc1
    v_mfma_f32_16x16x32_bf16 v[48:51], v[108:111], a[28:31], v[48:51]
    ds_read_b64_tr_b16 v[88:89], v6 offset:64
    v_mfma_f32_16x16x32_bf16 v[68:71], v[108:111], a[124:127], v[68:71]
    ds_read_b64_tr_b16 v[90:91], v6 offset:2624
    s_add_u32 m0, s73, 143360
    s_nop 0
    buffer_load_dwordx4 v2, s[28:31], s72 offen offset:0 sc1 lds
    s_waitcnt lgkmcnt(6)
    v_mfma_f32_16x16x32_bf16 v[52:55], v[112:115], a[28:31], v[52:55]
    ds_read_b64_tr_b16 v[92:93], v6 offset:96
    v_mfma_f32_16x16x32_bf16 v[72:75], v[112:115], a[124:127], v[72:75]
    ds_read_b64_tr_b16 v[94:95], v6 offset:2656
    v_mfma_f32_16x16x32_bf16 v[56:59], v[116:119], a[28:31], v[56:59]
    ds_read_b64_tr_b16 v[96:97], v6 offset:128
    buffer_load_dwordx4 v2, s[28:31], s72 offen offset:1024 sc1 lds
    v_mfma_f32_16x16x32_bf16 v[76:79], v[116:119], a[124:127], v[76:79]
    ds_read_b64_tr_b16 v[98:99], v6 offset:2688
    s_waitcnt vmcnt(20) lgkmcnt(4)
    v_mfma_f32_16x16x32_bf16 v[40:43], v[80:83], a[32:35], v[40:43]
    ds_read_b64_tr_b16 v[100:101], v6 offset:10240
    buffer_load_dwordx4 v2, s[28:31], s72 offen offset:2048 sc1 lds
    v_mfma_f32_16x16x32_bf16 v[60:63], v[80:83], a[128:131], v[60:63]
    ds_read_b64_tr_b16 v[102:103], v6 offset:12800
    v_mfma_f32_16x16x32_bf16 v[44:47], v[84:87], a[32:35], v[44:47]
    ds_read_b64_tr_b16 v[104:105], v6 offset:10272
    v_mfma_f32_16x16x32_bf16 v[64:67], v[84:87], a[128:131], v[64:67]
    ds_read_b64_tr_b16 v[106:107], v6 offset:12832
    buffer_load_dwordx4 v2, s[28:31], s72 offen offset:3072 sc1 lds
    v_mfma_f32_16x16x32_bf16 v[48:51], v[88:91], a[32:35], v[48:51]
    ds_read_b64_tr_b16 v[108:109], v6 offset:10304
    v_mfma_f32_16x16x32_bf16 v[68:71], v[88:91], a[128:131], v[68:71]
    ds_read_b64_tr_b16 v[110:111], v6 offset:12864
    s_add_u32 m0, s73, 147456
    s_add_u32 s72, s72, 4096
    buffer_load_dwordx4 v2, s[28:31], s72 offen offset:0 sc1 lds
    s_add_u32 s72, s72, 6144
    s_waitcnt lgkmcnt(6)
    v_mfma_f32_16x16x32_bf16 v[52:55], v[92:95], a[32:35], v[52:55]
    ds_read_b64_tr_b16 v[112:113], v6 offset:10336
    v_mfma_f32_16x16x32_bf16 v[72:75], v[92:95], a[128:131], v[72:75]
    ds_read_b64_tr_b16 v[114:115], v6 offset:12896
    v_mfma_f32_16x16x32_bf16 v[56:59], v[96:99], a[32:35], v[56:59]
    ds_read_b64_tr_b16 v[116:117], v6 offset:10368
    buffer_load_dwordx4 a[52:55], v2, s[28:31], s74 offen offset:1024 sc1
    v_mfma_f32_16x16x32_bf16 v[76:79], v[96:99], a[128:131], v[76:79]
    ds_read_b64_tr_b16 v[118:119], v6 offset:12928
    s_barrier
    s_waitcnt vmcnt(17) lgkmcnt(4)
    v_mfma_f32_16x16x32_bf16 v[40:43], v[100:103], a[36:39], v[40:43]
    ds_read_b64_tr_b16 v[80:81], v6 offset:20480
    buffer_load_dwordx4 a[148:151], v2, s[28:31], s75 offen offset:1024 sc1
    v_mfma_f32_16x16x32_bf16 v[60:63], v[100:103], a[132:135], v[60:63]
    ds_read_b64_tr_b16 v[82:83], v6 offset:23040
    v_mfma_f32_16x16x32_bf16 v[44:47], v[104:107], a[36:39], v[44:47]
    ds_read_b64_tr_b16 v[84:85], v6 offset:20512
    v_mfma_f32_16x16x32_bf16 v[64:67], v[104:107], a[132:135], v[64:67]
    ds_read_b64_tr_b16 v[86:87], v6 offset:23072
    buffer_load_dwordx4 a[56:59], v2, s[28:31], s74 offen offset:2048 sc1
    v_mfma_f32_16x16x32_bf16 v[48:51], v[108:111], a[36:39], v[48:51]
    ds_read_b64_tr_b16 v[88:89], v6 offset:20544
    v_mfma_f32_16x16x32_bf16 v[68:71], v[108:111], a[132:135], v[68:71]
    ds_read_b64_tr_b16 v[90:91], v6 offset:23104
    buffer_load_dwordx4 a[152:155], v2, s[28:31], s75 offen offset:2048 sc1
    s_waitcnt lgkmcnt(6)
    v_mfma_f32_16x16x32_bf16 v[52:55], v[112:115], a[36:39], v[52:55]
    ds_read_b64_tr_b16 v[92:93], v6 offset:20576
    v_mfma_f32_16x16x32_bf16 v[72:75], v[112:115], a[132:135], v[72:75]
    ds_read_b64_tr_b16 v[94:95], v6 offset:23136
    v_mfma_f32_16x16x32_bf16 v[56:59], v[116:119], a[36:39], v[56:59]
    ds_read_b64_tr_b16 v[96:97], v6 offset:20608
    s_add_u32 m0, s73, 0
    s_nop 0
    buffer_load_dwordx4 v2, s[28:31], s72 offen offset:0 sc1 lds
    v_mfma_f32_16x16x32_bf16 v[76:79], v[116:119], a[132:135], v[76:79]
    ds_read_b64_tr_b16 v[98:99], v6 offset:23168
    s_waitcnt vmcnt(19) lgkmcnt(4)
    v_mfma_f32_16x16x32_bf16 v[40:43], v[80:83], a[40:43], v[40:43]
    ds_read_b64_tr_b16 v[100:101], v6 offset:30720
    buffer_load_dwordx4 v2, s[28:31], s72 offen offset:1024 sc1 lds
    v_mfma_f32_16x16x32_bf16 v[60:63], v[80:83], a[136:139], v[60:63]
    ds_read_b64_tr_b16 v[102:103], v6 offset:33280
    v_mfma_f32_16x16x32_bf16 v[44:47], v[84:87], a[40:43], v[44:47]
    ds_read_b64_tr_b16 v[104:105], v6 offset:30752
    v_mfma_f32_16x16x32_bf16 v[64:67], v[84:87], a[136:139], v[64:67]
    ds_read_b64_tr_b16 v[106:107], v6 offset:33312
    buffer_load_dwordx4 v2, s[28:31], s72 offen offset:2048 sc1 lds
    v_mfma_f32_16x16x32_bf16 v[48:51], v[88:91], a[40:43], v[48:51]
    ds_read_b64_tr_b16 v[108:109], v6 offset:30784
    v_mfma_f32_16x16x32_bf16 v[68:71], v[88:91], a[136:139], v[68:71]
    ds_read_b64_tr_b16 v[110:111], v6 offset:33344
    buffer_load_dwordx4 v2, s[28:31], s72 offen offset:3072 sc1 lds
    s_waitcnt lgkmcnt(6)
    v_mfma_f32_16x16x32_bf16 v[52:55], v[92:95], a[40:43], v[52:55]
    ds_read_b64_tr_b16 v[112:113], v6 offset:30816
    v_mfma_f32_16x16x32_bf16 v[72:75], v[92:95], a[136:139], v[72:75]
    ds_read_b64_tr_b16 v[114:115], v6 offset:33376
    v_mfma_f32_16x16x32_bf16 v[56:59], v[96:99], a[40:43], v[56:59]
    ds_read_b64_tr_b16 v[116:117], v6 offset:30848
    s_add_u32 m0, s73, 4096
    s_add_u32 s72, s72, 4096
    buffer_load_dwordx4 v2, s[28:31], s72 offen offset:0 sc1 lds
    s_add_u32 s72, s72, 6144
    v_mfma_f32_16x16x32_bf16 v[76:79], v[96:99], a[136:139], v[76:79]
    ds_read_b64_tr_b16 v[118:119], v6 offset:33408
    s_barrier
    s_waitcnt vmcnt(16) lgkmcnt(4)
    v_mfma_f32_16x16x32_bf16 v[40:43], v[100:103], a[44:47], v[40:43]
    ds_read_b64_tr_b16 v[80:81], v6 offset:40960
    buffer_load_dwordx4 a[60:63], v2, s[28:31], s74 offen offset:3072 sc1
    s_add_u32 s74, s74, 4096
    v_mfma_f32_16x16x32_bf16 v[60:63], v[100:103], a[140:143], v[60:63]
    ds_read_b64_tr_b16 v[82:83], v6 offset:43520
    v_mfma_f32_16x16x32_bf16 v[44:47], v[104:107], a[44:47], v[44:47]
    ds_read_b64_tr_b16 v[84:85], v6 offset:40992
    v_mfma_f32_16x16x32_bf16 v[64:67], v[104:107], a[140:143], v[64:67]
    ds_read_b64_tr_b16 v[86:87], v6 offset:43552
    buffer_load_dwordx4 a[156:159], v2, s[28:31], s75 offen offset:3072 sc1
    s_add_u32 s75, s75, 4096
    v_mfma_f32_16x16x32_bf16 v[48:51], v[108:111], a[44:47], v[48:51]
    ds_read_b64_tr_b16 v[88:89], v6 offset:41024
    v_mfma_f32_16x16x32_bf16 v[68:71], v[108:111], a[140:143], v[68:71]
    ds_read_b64_tr_b16 v[90:91], v6 offset:43584
    buffer_load_dwordx4 a[64:67], v2, s[28:31], s74 offen offset:0 sc1
    s_waitcnt lgkmcnt(6)
    v_mfma_f32_16x16x32_bf16 v[52:55], v[112:115], a[44:47], v[52:55]
    ds_read_b64_tr_b16 v[92:93], v6 offset:41056
    v_mfma_f32_16x16x32_bf16 v[72:75], v[112:115], a[140:143], v[72:75]
    ds_read_b64_tr_b16 v[94:95], v6 offset:43616
    v_mfma_f32_16x16x32_bf16 v[56:59], v[116:119], a[44:47], v[56:59]
    ds_read_b64_tr_b16 v[96:97], v6 offset:41088
    buffer_load_dwordx4 a[160:163], v2, s[28:31], s75 offen offset:0 sc1
    v_mfma_f32_16x16x32_bf16 v[76:79], v[116:119], a[140:143], v[76:79]
    ds_read_b64_tr_b16 v[98:99], v6 offset:43648
    s_waitcnt vmcnt(18) lgkmcnt(4)
    v_mfma_f32_16x16x32_bf16 v[40:43], v[80:83], a[48:51], v[40:43]
    ds_read_b64_tr_b16 v[100:101], v6 offset:51200
    s_add_u32 m0, s73, 20480
    s_nop 0
    buffer_load_dwordx4 v2, s[28:31], s72 offen offset:0 sc1 lds
    v_mfma_f32_16x16x32_bf16 v[60:63], v[80:83], a[144:147], v[60:63]
    ds_read_b64_tr_b16 v[102:103], v6 offset:53760
    v_mfma_f32_16x16x32_bf16 v[44:47], v[84:87], a[48:51], v[44:47]
    ds_read_b64_tr_b16 v[104:105], v6 offset:51232
    v_mfma_f32_16x16x32_bf16 v[64:67], v[84:87], a[144:147], v[64:67]
    ds_read_b64_tr_b16 v[106:107], v6 offset:53792
    buffer_load_dwordx4 v2, s[28:31], s72 offen offset:1024 sc1 lds
    v_mfma_f32_16x16x32_bf16 v[48:51], v[88:91], a[48:51], v[48:51]
    ds_read_b64_tr_b16 v[108:109], v6 offset:51264
    v_mfma_f32_16x16x32_bf16 v[68:71], v[88:91], a[144:147], v[68:71]
    ds_read_b64_tr_b16 v[110:111], v6 offset:53824
    buffer_load_dwordx4 v2, s[28:31], s72 offen offset:2048 sc1 lds
    s_waitcnt lgkmcnt(6)
    v_mfma_f32_16x16x32_bf16 v[52:55], v[92:95], a[48:51], v[52:55]
    ds_read_b64_tr_b16 v[112:113], v6 offset:51296
    v_mfma_f32_16x16x32_bf16 v[72:75], v[92:95], a[144:147], v[72:75]
    ds_read_b64_tr_b16 v[114:115], v6 offset:53856
    v_mfma_f32_16x16x32_bf16 v[56:59], v[96:99], a[48:51], v[56:59]
    ds_read_b64_tr_b16 v[116:117], v6 offset:51328
    buffer_load_dwordx4 v2, s[28:31], s72 offen offset:3072 sc1 lds
    v_mfma_f32_16x16x32_bf16 v[76:79], v[96:99], a[144:147], v[76:79]
    ds_read_b64_tr_b16 v[118:119], v6 offset:53888
    s_barrier
    s_waitcnt vmcnt(15) lgkmcnt(4)
    v_mfma_f32_16x16x32_bf16 v[40:43], v[100:103], a[52:55], v[40:43]
    ds_read_b64_tr_b16 v[80:81], v7 offset:0
    s_add_u32 m0, s73, 24576
    s_add_u32 s72, s72, 4096
    buffer_load_dwordx4 v2, s[28:31], s72 offen offset:0 sc1 lds
    s_add_u32 s72, s72, 6144
    v_mfma_f32_16x16x32_bf16 v[60:63], v[100:103], a[148:151], v[60:63]
    ds_read_b64_tr_b16 v[82:83], v7 offset:2560
    v_mfma_f32_16x16x32_bf16 v[44:47], v[104:107], a[52:55], v[44:47]
    ds_read_b64_tr_b16 v[84:85], v7 offset:32
    v_mfma_f32_16x16x32_bf16 v[64:67], v[104:107], a[148:151], v[64:67]
    ds_read_b64_tr_b16 v[86:87], v7 offset:2592
    buffer_load_dwordx4 a[68:71], v2, s[28:31], s74 offen offset:1024 sc1
    v_mfma_f32_16x16x32_bf16 v[48:51], v[108:111], a[52:55], v[48:51]
    ds_read_b64_tr_b16 v[88:89], v7 offset:64
    v_mfma_f32_16x16x32_bf16 v[68:71], v[108:111], a[148:151], v[68:71]
    ds_read_b64_tr_b16 v[90:91], v7 offset:2624
    buffer_load_dwordx4 a[164:167], v2, s[28:31], s75 offen offset:1024 sc1
    s_waitcnt lgkmcnt(6)
    v_mfma_f32_16x16x32_bf16 v[52:55], v[112:115], a[52:55], v[52:55]
    ds_read_b64_tr_b16 v[92:93], v7 offset:96
    v_mfma_f32_16x16x32_bf16 v[72:75], v[112:115], a[148:151], v[72:75]
    ds_read_b64_tr_b16 v[94:95], v7 offset:2656
    v_mfma_f32_16x16x32_bf16 v[56:59], v[116:119], a[52:55], v[56:59]
    ds_read_b64_tr_b16 v[96:97], v7 offset:128
    buffer_load_dwordx4 a[72:75], v2, s[28:31], s74 offen offset:2048 sc1
    v_mfma_f32_16x16x32_bf16 v[76:79], v[116:119], a[148:151], v[76:79]
    ds_read_b64_tr_b16 v[98:99], v7 offset:2688
    s_waitcnt vmcnt(17) lgkmcnt(4)
    v_mfma_f32_16x16x32_bf16 v[40:43], v[80:83], a[56:59], v[40:43]
    ds_read_b64_tr_b16 v[100:101], v7 offset:10240
    buffer_load_dwordx4 a[168:171], v2, s[28:31], s75 offen offset:2048 sc1
    v_mfma_f32_16x16x32_bf16 v[60:63], v[80:83], a[152:155], v[60:63]
    ds_read_b64_tr_b16 v[102:103], v7 offset:12800
    v_mfma_f32_16x16x32_bf16 v[44:47], v[84:87], a[56:59], v[44:47]
    ds_read_b64_tr_b16 v[104:105], v7 offset:10272
    v_mfma_f32_16x16x32_bf16 v[64:67], v[84:87], a[152:155], v[64:67]
    ds_read_b64_tr_b16 v[106:107], v7 offset:12832
    s_add_u32 m0, s73, 40960
    s_nop 0
    buffer_load_dwordx4 v2, s[28:31], s72 offen offset:0 sc1 lds
    v_mfma_f32_16x16x32_bf16 v[48:51], v[88:91], a[56:59], v[48:51]
    ds_read_b64_tr_b16 v[108:109], v7 offset:10304
    v_mfma_f32_16x16x32_bf16 v[68:71], v[88:91], a[152:155], v[68:71]
    ds_read_b64_tr_b16 v[110:111], v7 offset:12864
    buffer_load_dwordx4 v2, s[28:31], s72 offen offset:1024 sc1 lds
    s_waitcnt lgkmcnt(6)
    v_mfma_f32_16x16x32_bf16 v[52:55], v[92:95], a[56:59], v[52:55]
    ds_read_b64_tr_b16 v[112:113], v7 offset:10336
    v_mfma_f32_16x16x32_bf16 v[72:75], v[92:95], a[152:155], v[72:75]
    ds_read_b64_tr_b16 v[114:115], v7 offset:12896
    v_mfma_f32_16x16x32_bf16 v[56:59], v[96:99], a[56:59], v[56:59]
    ds_read_b64_tr_b16 v[116:117], v7 offset:10368
    buffer_load_dwordx4 v2, s[28:31], s72 offen offset:2048 sc1 lds
    v_mfma_f32_16x16x32_bf16 v[76:79], v[96:99], a[152:155], v[76:79]
    ds_read_b64_tr_b16 v[118:119], v7 offset:12928
    s_barrier
    s_waitcnt vmcnt(14) lgkmcnt(4)
    v_mfma_f32_16x16x32_bf16 v[40:43], v[100:103], a[60:63], v[40:43]
    ds_read_b64_tr_b16 v[80:81], v7 offset:20480
    buffer_load_dwordx4 v2, s[28:31], s72 offen offset:3072 sc1 lds
    v_mfma_f32_16x16x32_bf16 v[60:63], v[100:103], a[156:159], v[60:63]
    ds_read_b64_tr_b16 v[82:83], v7 offset:23040
    v_mfma_f32_16x16x32_bf16 v[44:47], v[104:107], a[60:63], v[44:47]
    ds_read_b64_tr_b16 v[84:85], v7 offset:20512
    v_mfma_f32_16x16x32_bf16 v[64:67], v[104:107], a[156:159], v[64:67]
    ds_read_b64_tr_b16 v[86:87], v7 offset:23072
    s_add_u32 m0, s73, 45056
    s_add_u32 s72, s72, 4096
    buffer_load_dwordx4 v2, s[28:31], s72 offen offset:0 sc1 lds
    s_add_u32 s72, s72, 6144
    v_mfma_f32_16x16x32_bf16 v[48:51], v[108:111], a[60:63], v[48:51]
    ds_read_b64_tr_b16 v[88:89], v7 offset:20544
    v_mfma_f32_16x16x32_bf16 v[68:71], v[108:111], a[156:159], v[68:71]
    ds_read_b64_tr_b16 v[90:91], v7 offset:23104
    buffer_load_dwordx4 a[76:79], v2, s[28:31], s74 offen offset:3072 sc1
    s_add_u32 s74, s74, 4096
    s_waitcnt lgkmcnt(6)
    v_mfma_f32_16x16x32_bf16 v[52:55], v[112:115], a[60:63], v[52:55]
    ds_read_b64_tr_b16 v[92:93], v7 offset:20576
    v_mfma_f32_16x16x32_bf16 v[72:75], v[112:115], a[156:159], v[72:75]
    ds_read_b64_tr_b16 v[94:95], v7 offset:23136
    v_mfma_f32_16x16x32_bf16 v[56:59], v[116:119], a[60:63], v[56:59]
    ds_read_b64_tr_b16 v[96:97], v7 offset:20608
    buffer_load_dwordx4 a[172:175], v2, s[28:31], s75 offen offset:3072 sc1
    s_add_u32 s75, s75, 4096
    v_mfma_f32_16x16x32_bf16 v[76:79], v[116:119], a[156:159], v[76:79]
    ds_read_b64_tr_b16 v[98:99], v7 offset:23168
    s_waitcnt vmcnt(16) lgkmcnt(4)
    v_mfma_f32_16x16x32_bf16 v[40:43], v[80:83], a[64:67], v[40:43]
    ds_read_b64_tr_b16 v[100:101], v7 offset:30720
    buffer_load_dwordx4 a[80:83], v2, s[28:31], s74 offen offset:0 sc1
    v_mfma_f32_16x16x32_bf16 v[60:63], v[80:83], a[160:163], v[60:63]
    ds_read_b64_tr_b16 v[102:103], v7 offset:33280
    v_mfma_f32_16x16x32_bf16 v[44:47], v[84:87], a[64:67], v[44:47]
    ds_read_b64_tr_b16 v[104:105], v7 offset:30752
    v_mfma_f32_16x16x32_bf16 v[64:67], v[84:87], a[160:163], v[64:67]
    ds_read_b64_tr_b16 v[106:107], v7 offset:33312
    buffer_load_dwordx4 a[176:179], v2, s[28:31], s75 offen offset:0 sc1
    v_mfma_f32_16x16x32_bf16 v[48:51], v[88:91], a[64:67], v[48:51]
    ds_read_b64_tr_b16 v[108:109], v7 offset:30784
    v_mfma_f32_16x16x32_bf16 v[68:71], v[88:91], a[160:163], v[68:71]
    ds_read_b64_tr_b16 v[110:111], v7 offset:33344
    buffer_load_dwordx4 a[84:87], v2, s[28:31], s74 offen offset:1024 sc1
    s_waitcnt lgkmcnt(6)
    v_mfma_f32_16x16x32_bf16 v[52:55], v[92:95], a[64:67], v[52:55]
    ds_read_b64_tr_b16 v[112:113], v7 offset:30816
    v_mfma_f32_16x16x32_bf16 v[72:75], v[92:95], a[160:163], v[72:75]
    ds_read_b64_tr_b16 v[114:115], v7 offset:33376
    v_mfma_f32_16x16x32_bf16 v[56:59], v[96:99], a[64:67], v[56:59]
    ds_read_b64_tr_b16 v[116:117], v7 offset:30848
    buffer_load_dwordx4 a[180:183], v2, s[28:31], s75 offen offset:1024 sc1
    v_mfma_f32_16x16x32_bf16 v[76:79], v[96:99], a[160:163], v[76:79]
    ds_read_b64_tr_b16 v[118:119], v7 offset:33408
    s_barrier
    s_waitcnt vmcnt(13) lgkmcnt(4)
    v_mfma_f32_16x16x32_bf16 v[40:43], v[100:103], a[68:71], v[40:43]
    ds_read_b64_tr_b16 v[80:81], v5 offset:0
    buffer_load_dwordx4 a[88:91], v2, s[28:31], s74 offen offset:2048 sc1
    v_mfma_f32_16x16x32_bf16 v[60:63], v[100:103], a[164:167], v[60:63]
    ds_read_b64_tr_b16 v[82:83], v5 offset:2560
    v_mfma_f32_16x16x32_bf16 v[44:47], v[104:107], a[68:71], v[44:47]
    ds_read_b64_tr_b16 v[84:85], v5 offset:32
    v_mfma_f32_16x16x32_bf16 v[64:67], v[104:107], a[164:167], v[64:67]
    ds_read_b64_tr_b16 v[86:87], v5 offset:2592
    buffer_load_dwordx4 a[184:187], v2, s[28:31], s75 offen offset:2048 sc1
    v_mfma_f32_16x16x32_bf16 v[48:51], v[108:111], a[68:71], v[48:51]
    ds_read_b64_tr_b16 v[88:89], v5 offset:64
    v_mfma_f32_16x16x32_bf16 v[68:71], v[108:111], a[164:167], v[68:71]
    ds_read_b64_tr_b16 v[90:91], v5 offset:2624
    buffer_load_dwordx4 a[92:95], v2, s[28:31], s74 offen offset:3072 sc1
    s_waitcnt lgkmcnt(6)
    v_mfma_f32_16x16x32_bf16 v[52:55], v[112:115], a[68:71], v[52:55]
    ds_read_b64_tr_b16 v[92:93], v5 offset:96
    v_mfma_f32_16x16x32_bf16 v[72:75], v[112:115], a[164:167], v[72:75]
    ds_read_b64_tr_b16 v[94:95], v5 offset:2656
    v_mfma_f32_16x16x32_bf16 v[56:59], v[116:119], a[68:71], v[56:59]
    ds_read_b64_tr_b16 v[96:97], v5 offset:128
    buffer_load_dwordx4 a[188:191], v2, s[28:31], s75 offen offset:3072 sc1
    v_mfma_f32_16x16x32_bf16 v[76:79], v[116:119], a[164:167], v[76:79]
    ds_read_b64_tr_b16 v[98:99], v5 offset:2688
    s_waitcnt vmcnt(15) lgkmcnt(4)
    v_mfma_f32_16x16x32_bf16 v[40:43], v[80:83], a[72:75], v[40:43]
    ds_read_b64_tr_b16 v[100:101], v5 offset:10240
    v_mfma_f32_16x16x32_bf16 v[60:63], v[80:83], a[168:171], v[60:63]
    ds_read_b64_tr_b16 v[102:103], v5 offset:12800
    v_mfma_f32_16x16x32_bf16 v[44:47], v[84:87], a[72:75], v[44:47]
    ds_read_b64_tr_b16 v[104:105], v5 offset:10272
    v_mfma_f32_16x16x32_bf16 v[64:67], v[84:87], a[168:171], v[64:67]
    ds_read_b64_tr_b16 v[106:107], v5 offset:12832
    v_mfma_f32_16x16x32_bf16 v[48:51], v[88:91], a[72:75], v[48:51]
    ds_read_b64_tr_b16 v[108:109], v5 offset:10304
    v_mfma_f32_16x16x32_bf16 v[68:71], v[88:91], a[168:171], v[68:71]
    ds_read_b64_tr_b16 v[110:111], v5 offset:12864
    s_waitcnt lgkmcnt(6)
    v_mfma_f32_16x16x32_bf16 v[52:55], v[92:95], a[72:75], v[52:55]
    ds_read_b64_tr_b16 v[112:113], v5 offset:10336
    v_mfma_f32_16x16x32_bf16 v[72:75], v[92:95], a[168:171], v[72:75]
    ds_read_b64_tr_b16 v[114:115], v5 offset:12896
    v_mfma_f32_16x16x32_bf16 v[56:59], v[96:99], a[72:75], v[56:59]
    ds_read_b64_tr_b16 v[116:117], v5 offset:10368
    v_mfma_f32_16x16x32_bf16 v[76:79], v[96:99], a[168:171], v[76:79]
    ds_read_b64_tr_b16 v[118:119], v5 offset:12928
    s_barrier
    s_waitcnt vmcnt(8) lgkmcnt(4)
    v_mfma_f32_16x16x32_bf16 v[40:43], v[100:103], a[76:79], v[40:43]
    ds_read_b64_tr_b16 v[80:81], v5 offset:20480
    v_mfma_f32_16x16x32_bf16 v[60:63], v[100:103], a[172:175], v[60:63]
    ds_read_b64_tr_b16 v[82:83], v5 offset:23040
    v_mfma_f32_16x16x32_bf16 v[44:47], v[104:107], a[76:79], v[44:47]
    ds_read_b64_tr_b16 v[84:85], v5 offset:20512
    v_mfma_f32_16x16x32_bf16 v[64:67], v[104:107], a[172:175], v[64:67]
    ds_read_b64_tr_b16 v[86:87], v5 offset:23072
    v_mfma_f32_16x16x32_bf16 v[48:51], v[108:111], a[76:79], v[48:51]
    ds_read_b64_tr_b16 v[88:89], v5 offset:20544
    v_mfma_f32_16x16x32_bf16 v[68:71], v[108:111], a[172:175], v[68:71]
    ds_read_b64_tr_b16 v[90:91], v5 offset:23104
    s_waitcnt lgkmcnt(6)
    v_mfma_f32_16x16x32_bf16 v[52:55], v[112:115], a[76:79], v[52:55]
    ds_read_b64_tr_b16 v[92:93], v5 offset:20576
    v_mfma_f32_16x16x32_bf16 v[72:75], v[112:115], a[172:175], v[72:75]
    ds_read_b64_tr_b16 v[94:95], v5 offset:23136
    v_mfma_f32_16x16x32_bf16 v[56:59], v[116:119], a[76:79], v[56:59]
    ds_read_b64_tr_b16 v[96:97], v5 offset:20608
    v_mfma_f32_16x16x32_bf16 v[76:79], v[116:119], a[172:175], v[76:79]
    ds_read_b64_tr_b16 v[98:99], v5 offset:23168
    s_waitcnt vmcnt(6) lgkmcnt(4)
    v_mfma_f32_16x16x32_bf16 v[40:43], v[80:83], a[80:83], v[40:43]
    ds_read_b64_tr_b16 v[100:101], v5 offset:30720
    v_mfma_f32_16x16x32_bf16 v[60:63], v[80:83], a[176:179], v[60:63]
    ds_read_b64_tr_b16 v[102:103], v5 offset:33280
    v_mfma_f32_16x16x32_bf16 v[44:47], v[84:87], a[80:83], v[44:47]
    ds_read_b64_tr_b16 v[104:105], v5 offset:30752
    v_mfma_f32_16x16x32_bf16 v[64:67], v[84:87], a[176:179], v[64:67]
    ds_read_b64_tr_b16 v[106:107], v5 offset:33312
    v_mfma_f32_16x16x32_bf16 v[48:51], v[88:91], a[80:83], v[48:51]
    ds_read_b64_tr_b16 v[108:109], v5 offset:30784
    v_mfma_f32_16x16x32_bf16 v[68:71], v[88:91], a[176:179], v[68:71]
    ds_read_b64_tr_b16 v[110:111], v5 offset:33344
    s_waitcnt lgkmcnt(6)
    v_mfma_f32_16x16x32_bf16 v[52:55], v[92:95], a[80:83], v[52:55]
    ds_read_b64_tr_b16 v[112:113], v5 offset:30816
    v_mfma_f32_16x16x32_bf16 v[72:75], v[92:95], a[176:179], v[72:75]
    ds_read_b64_tr_b16 v[114:115], v5 offset:33376
    v_mfma_f32_16x16x32_bf16 v[56:59], v[96:99], a[80:83], v[56:59]
    ds_read_b64_tr_b16 v[116:117], v5 offset:30848
    v_mfma_f32_16x16x32_bf16 v[76:79], v[96:99], a[176:179], v[76:79]
    ds_read_b64_tr_b16 v[118:119], v5 offset:33408
    s_barrier
    s_waitcnt vmcnt(4) lgkmcnt(4)
    v_mfma_f32_16x16x32_bf16 v[40:43], v[100:103], a[84:87], v[40:43]
    ds_read_b64_tr_b16 v[80:81], v5 offset:40960
    v_mfma_f32_16x16x32_bf16 v[60:63], v[100:103], a[180:183], v[60:63]
    ds_read_b64_tr_b16 v[82:83], v5 offset:43520
    v_mfma_f32_16x16x32_bf16 v[44:47], v[104:107], a[84:87], v[44:47]
    ds_read_b64_tr_b16 v[84:85], v5 offset:40992
    v_mfma_f32_16x16x32_bf16 v[64:67], v[104:107], a[180:183], v[64:67]
    ds_read_b64_tr_b16 v[86:87], v5 offset:43552
    v_mfma_f32_16x16x32_bf16 v[48:51], v[108:111], a[84:87], v[48:51]
    ds_read_b64_tr_b16 v[88:89], v5 offset:41024
    v_mfma_f32_16x16x32_bf16 v[68:71], v[108:111], a[180:183], v[68:71]
    ds_read_b64_tr_b16 v[90:91], v5 offset:43584
    s_waitcnt lgkmcnt(6)
    v_mfma_f32_16x16x32_bf16 v[52:55], v[112:115], a[84:87], v[52:55]
    ds_read_b64_tr_b16 v[92:93], v5 offset:41056
    v_mfma_f32_16x16x32_bf16 v[72:75], v[112:115], a[180:183], v[72:75]
    ds_read_b64_tr_b16 v[94:95], v5 offset:43616
    v_mfma_f32_16x16x32_bf16 v[56:59], v[116:119], a[84:87], v[56:59]
    ds_read_b64_tr_b16 v[96:97], v5 offset:41088
    v_mfma_f32_16x16x32_bf16 v[76:79], v[116:119], a[180:183], v[76:79]
    ds_read_b64_tr_b16 v[98:99], v5 offset:43648
    s_waitcnt vmcnt(2) lgkmcnt(4)
    v_mfma_f32_16x16x32_bf16 v[40:43], v[80:83], a[88:91], v[40:43]
    ds_read_b64_tr_b16 v[100:101], v5 offset:51200
    v_mfma_f32_16x16x32_bf16 v[60:63], v[80:83], a[184:187], v[60:63]
    ds_read_b64_tr_b16 v[102:103], v5 offset:53760
    v_mfma_f32_16x16x32_bf16 v[44:47], v[84:87], a[88:91], v[44:47]
    ds_read_b64_tr_b16 v[104:105], v5 offset:51232
    v_mfma_f32_16x16x32_bf16 v[64:67], v[84:87], a[184:187], v[64:67]
    ds_read_b64_tr_b16 v[106:107], v5 offset:53792
    v_mfma_f32_16x16x32_bf16 v[48:51], v[88:91], a[88:91], v[48:51]
    ds_read_b64_tr_b16 v[108:109], v5 offset:51264
    v_mfma_f32_16x16x32_bf16 v[68:71], v[88:91], a[184:187], v[68:71]
    ds_read_b64_tr_b16 v[110:111], v5 offset:53824
    s_waitcnt lgkmcnt(6)
    v_mfma_f32_16x16x32_bf16 v[52:55], v[92:95], a[88:91], v[52:55]
    ds_read_b64_tr_b16 v[112:113], v5 offset:51296
    v_mfma_f32_16x16x32_bf16 v[72:75], v[92:95], a[184:187], v[72:75]
    ds_read_b64_tr_b16 v[114:115], v5 offset:53856
    v_mfma_f32_16x16x32_bf16 v[56:59], v[96:99], a[88:91], v[56:59]
    ds_read_b64_tr_b16 v[116:117], v5 offset:51328
    v_mfma_f32_16x16x32_bf16 v[76:79], v[96:99], a[184:187], v[76:79]
    ds_read_b64_tr_b16 v[118:119], v5 offset:53888
    s_waitcnt vmcnt(0) lgkmcnt(4)
    v_mfma_f32_16x16x32_bf16 v[40:43], v[100:103], a[92:95], v[40:43]
    v_mfma_f32_16x16x32_bf16 v[60:63], v[100:103], a[188:191], v[60:63]
    v_mfma_f32_16x16x32_bf16 v[44:47], v[104:107], a[92:95], v[44:47]
    v_mfma_f32_16x16x32_bf16 v[64:67], v[104:107], a[188:191], v[64:67]
    v_mfma_f32_16x16x32_bf16 v[48:51], v[108:111], a[92:95], v[48:51]
    v_mfma_f32_16x16x32_bf16 v[68:71], v[108:111], a[188:191], v[68:71]
    s_waitcnt lgkmcnt(0)
    v_mfma_f32_16x16x32_bf16 v[52:55], v[112:115], a[92:95], v[52:55]
    v_mfma_f32_16x16x32_bf16 v[72:75], v[112:115], a[188:191], v[72:75]
    v_mfma_f32_16x16x32_bf16 v[56:59], v[116:119], a[92:95], v[56:59]
    v_mfma_f32_16x16x32_bf16 v[76:79], v[116:119], a[188:191], v[76:79]
    s_mul_i32 s60, s46, 5120
    s_add_u32 s60, s60, 81920
    v_add_u32 v3, s60, v2
    s_xor_b32 s61, s46, 1
    s_mul_i32 s61, s61, 5120
    s_add_u32 s61, s61, 81920
    v_add_u32 v4, s61, v2
    ds_write_b128 v3, v[60:63] offset:0
    ds_write_b128 v3, v[64:67] offset:1024
    ds_write_b128 v3, v[68:71] offset:2048
    ds_write_b128 v3, v[72:75] offset:3072
    ds_write_b128 v3, v[76:79] offset:4096
    s_waitcnt lgkmcnt(0)
    s_barrier
    ds_read_b128 v[60:63], v4 offset:0
    ds_read_b128 v[64:67], v4 offset:1024
    ds_read_b128 v[68:71], v4 offset:2048
    ds_read_b128 v[72:75], v4 offset:3072
    ds_read_b128 v[76:79], v4 offset:4096
    s_waitcnt lgkmcnt(4)
    v_pk_add_f32 v[40:41], v[40:41], v[60:61]
    v_pk_fma_f32 v[140:141], v[40:41], v[120:121], v[140:141]
    v_pk_add_f32 v[42:43], v[42:43], v[62:63]
    v_pk_fma_f32 v[142:143], v[42:43], v[122:123], v[142:143]
    s_waitcnt lgkmcnt(3)
    v_pk_add_f32 v[44:45], v[44:45], v[64:65]
    v_pk_fma_f32 v[144:145], v[44:45], v[124:125], v[144:145]
    v_pk_add_f32 v[46:47], v[46:47], v[66:67]
    v_pk_fma_f32 v[146:147], v[46:47], v[126:127], v[146:147]
    s_waitcnt lgkmcnt(2)
    v_pk_add_f32 v[48:49], v[48:49], v[68:69]
    v_pk_fma_f32 v[148:149], v[48:49], v[128:129], v[148:149]
    v_pk_add_f32 v[50:51], v[50:51], v[70:71]
    v_pk_fma_f32 v[150:151], v[50:51], v[130:131], v[150:151]
    s_waitcnt lgkmcnt(1)
    v_pk_add_f32 v[52:53], v[52:53], v[72:73]
    v_pk_fma_f32 v[152:153], v[52:53], v[132:133], v[152:153]
    v_pk_add_f32 v[54:55], v[54:55], v[74:75]
    v_pk_fma_f32 v[154:155], v[54:55], v[134:135], v[154:155]
    s_waitcnt lgkmcnt(0)
    v_pk_add_f32 v[56:57], v[56:57], v[76:77]
    v_pk_fma_f32 v[156:157], v[56:57], v[136:137], v[156:157]
    v_pk_add_f32 v[58:59], v[58:59], v[78:79]
    v_pk_fma_f32 v[158:159], v[58:59], v[138:139], v[158:159]
    v_cvt_pk_bf16_f32 v40, v140, v141
    v_cvt_pk_bf16_f32 v41, v142, v143
    v_cvt_pk_bf16_f32 v42, v144, v145
    v_cvt_pk_bf16_f32 v43, v146, v147
    v_cvt_pk_bf16_f32 v44, v148, v149
    v_cvt_pk_bf16_f32 v45, v150, v151
    v_cvt_pk_bf16_f32 v46, v152, v153
    v_cvt_pk_bf16_f32 v47, v154, v155
    v_cvt_pk_bf16_f32 v48, v156, v157
    v_cvt_pk_bf16_f32 v49, v158, v159
    v_mov_b32 v50, v48
    v_mov_b32 v51, v49
    v_permlane16_swap_b32 v40, v42
    v_permlane16_swap_b32 v41, v43
    v_permlane16_swap_b32 v44, v46
    v_permlane16_swap_b32 v45, v47
    v_permlane16_swap_b32 v48, v50
    v_permlane16_swap_b32 v49, v51
    buffer_store_dwordx4 v[40:43], v14, s[32:35], s71 offen
    buffer_store_dwordx4 v[44:47], v14, s[32:35], s71 offen offset:64
    buffer_store_dwordx4 v[48:51], v15, s[32:35], s71 offen offset:128
    s_waitcnt vmcnt(0) lgkmcnt(0)
L_end:
    s_endpgm
Lslow5:
    buffer_wbl2 sc1
    s_waitcnt vmcnt(0)
    buffer_store_dword v9, v8, s[28:31], s60 offen sc1
    s_branch Ljoin6
Lacq11:
    buffer_inv sc1
    s_waitcnt vmcnt(0)
    s_branch Lacqj12
Lrs17:
    s_mov_b32 s54, 32768
Lrl45:
    buffer_load_dword v36, v35, s[28:31], s70 offen sc1
    s_waitcnt vmcnt(0)
    v_cmp_ne_u32 vcc, s47, v36
    s_cbranch_vccz Lrj18
    s_sub_u32 s54, s54, 1
    s_cbranch_scc0 Lrl45
    s_branch Lrj18
Lvs19:
    s_mov_b32 s54, 32768
Lvl46:
    s_add_u32 s66, s65, 0
    buffer_load_dwordx4 v[160:163], v26, s[28:31], s66 offen sc1
    s_add_u32 s66, s65, 10240
    buffer_load_dwordx4 v[164:167], v26, s[28:31], s66 offen sc1
    s_add_u32 s66, s65, 20480
    buffer_load_dwordx4 v[168:171], v26, s[28:31], s66 offen sc1
    s_add_u32 s66, s65, 30720
    buffer_load_dwordx4 v[172:175], v26, s[28:31], s66 offen sc1
    s_add_u32 s66, s65, 40960
    buffer_load_dwordx4 v[176:179], v26, s[28:31], s66 offen sc1
    s_waitcnt vmcnt(0)
    v_xor_b32 v160, s40, v160
    v_xor_b32 v161, s41, v161
    v_xor_b32 v162, s42, v162
    v_xor_b32 v163, s43, v163
    v_or_b32 v180, v160, v161
    v_or3_b32 v180, v162, v163, v180
    v_xor_b32 v164, s40, v164
    v_xor_b32 v165, s41, v165
    v_xor_b32 v166, s42, v166
    v_xor_b32 v167, s43, v167
    v_or3_b32 v180, v164, v165, v180
    v_or3_b32 v180, v166, v167, v180
    v_xor_b32 v168, s40, v168
    v_xor_b32 v169, s41, v169
    v_xor_b32 v170, s42, v170
    v_xor_b32 v171, s43, v171
    v_or3_b32 v180, v168, v169, v180
    v_or3_b32 v180, v170, v171, v180
    v_xor_b32 v172, s40, v172
    v_xor_b32 v173, s41, v173
    v_xor_b32 v174, s42, v174
    v_xor_b32 v175, s43, v175
    v_or3_b32 v180, v172, v173, v180
    v_or3_b32 v180, v174, v175, v180
    v_xor_b32 v176, s40, v176
    v_xor_b32 v177, s41, v177
    v_xor_b32 v178, s42, v178
    v_xor_b32 v179, s43, v179
    v_or3_b32 v180, v176, v177, v180
    v_or3_b32 v180, v178, v179, v180
    v_and_b32 v180, 0xff, v180
    v_cmp_ne_u32 vcc, 0, v180
    s_cbranch_vccz Lvj20
    s_sub_u32 s54, s54, 1
    s_cbranch_scc0 Lvl46
    s_branch Lvj20
Lslow21:
    buffer_wbl2 sc1
    s_waitcnt vmcnt(0)
    buffer_store_dword v9, v8, s[28:31], s60 offen sc1
    s_branch Ljoin22
Lacq25:
    buffer_inv sc1
    s_waitcnt vmcnt(0)
    s_branch Lacqj26
Lslow27:
    buffer_store_dwordx4 v[8:11], v12, s[28:31], s65 offen sc1
    s_branch Ljoin28
Lslow31:
    buffer_wbl2 sc1
    s_waitcnt vmcnt(0)
    buffer_store_dword v9, v8, s[28:31], s60 offen sc1
    s_branch Ljoin32
Lacq35:
    buffer_inv sc1
    s_waitcnt vmcnt(0)
    s_branch Lacqj36
Lslow39:
    buffer_wbl2 sc1
    s_waitcnt vmcnt(0)
    buffer_store_dword v9, v8, s[28:31], s60 offen sc1
    s_branch Ljoin40
Lacq43:
    buffer_inv sc1
    s_waitcnt vmcnt(0)
    s_branch Lacqj44
L_last:
    s_endpgm
.section .rodata,"a"
.p2align 6
.amdhsa_kernel adaLN_cond__sliding_block__glu_gated_glu__prompt_kernel
  .amdhsa_next_free_vgpr 512
  .amdhsa_next_free_sgpr 102
  .amdhsa_accum_offset 256
  .amdhsa_group_segment_fixed_size 0
  .amdhsa_kernarg_size 96
  .amdhsa_user_sgpr_count 2
  .amdhsa_user_sgpr_kernarg_segment_ptr 1
  .amdhsa_system_sgpr_workgroup_id_x 1
.end_amdhsa_kernel
```
